```python
import torch

def _softmax(x, axis=-1):
    return torch.softmax(x, dim=axis)
def _gelu(x):
    return torch.nn.functional.gelu(x, approximate="tanh")
def _silu(x):
    return torch.nn.functional.silu(x)
def _sigmoid(x):
    return torch.sigmoid(x)
def _layernorm(x, axis=-1, eps=1e-5):
    m = x.mean(dim=axis, keepdim=True)
    v = x.var(dim=axis, keepdim=True, unbiased=False)
    return (x - m) / torch.sqrt(v + eps)
def _scatter_add(tgt, idx, src, axis=0):
    return tgt.clone().index_add_(axis, idx, src)
def _segment_sum(src, seg, n):
    out = torch.zeros((n,) + src.shape[1:], dtype=src.dtype)
    return out.index_add_(0, seg, src)
def _pad(x, pw):
    flat = tuple(v for pair in reversed(pw) for v in pair)
    return torch.nn.functional.pad(x, flat)

kernel_name = 'parallel_sum__softmax_full_mha__glu_gated_bilinear__prompt'

def setup_inputs():

    _w = (lambda a: (lambda t: t.to(torch.bfloat16) if t.is_floating_point() else t)(torch.as_tensor(a)))
    def _A_setup():
        B, S, D = 1, 2048, 1024
        return {
            "x": _w((lambda *s: torch.randn(*s, dtype=torch.bfloat16) * 0.05)(B, S, D)),
            "wqkv": _w((lambda *s: torch.randn(*s, dtype=torch.bfloat16) * 0.05)(D, 3 * D)),
            "wo": _w((lambda *s: torch.randn(*s, dtype=torch.bfloat16) * 0.05)(D, D)),
        }
    _A_in = _A_setup()

    def _B_setup():
        B, S, D, F = 1, 2048, 1024, 3584
        return {
            "x": _w((lambda *s: torch.randn(*s, dtype=torch.bfloat16) * 0.05)(B, S, D)),
            "w_gate": _w((lambda *s: torch.randn(*s, dtype=torch.bfloat16) * 0.8)(D, F) * (D ** -0.5)),
            "w_up": _w((lambda *s: torch.randn(*s, dtype=torch.bfloat16) * 0.8)(D, F) * (D ** -0.5)),
            "w_down": _w((lambda *s: torch.randn(*s, dtype=torch.bfloat16) * 0.8)(F, D) * (F ** -0.5)),
        }
    _B_in = _B_setup()

    return {
        "A_x": _A_in["x"],
        "A_wqkv": _A_in["wqkv"],
        "A_wo": _A_in["wo"],
        "B_x": _B_in["x"],
        "B_w_gate": _B_in["w_gate"],
        "B_w_up": _B_in["w_up"],
        "B_w_down": _B_in["w_down"],
    }

def reference(A_x, A_wqkv, A_wo, B_x, B_w_gate, B_w_up, B_w_down):
    def _A_ref(x, wqkv, wo):
        B, S, D = x.shape
        H = 32; Dh = D // H
        qkv = (lambda x, *d: x.permute(*d))((x @ wqkv).reshape(B, S, 3, H, Dh), 2, 0, 3, 1, 4)
        q, k, v = qkv[0], qkv[1], qkv[2]
        scale = Dh ** -0.5
        scores = torch.einsum("bhqd,bhkd->bhqk", q, k) * scale
        p = _softmax(scores, axis=-1)
        o = torch.einsum("bhqk,bhkd->bhqd", p, v)
        return (lambda x, *d: x.permute(*d))(o, 0, 2, 1, 3).reshape(B, S, D) @ wo

    def _B_ref(x, w_gate, w_up, w_down):
        g = torch.einsum("bsd,df->bsf", x, w_gate)
        u = torch.einsum("bsd,df->bsf", x, w_up)
        h = g * u
        return torch.einsum("bsf,fd->bsd", h, w_down)

    x = A_x
    xn = _layernorm(x, axis=-1)
    return x + _A_ref(xn, A_wqkv, A_wo) + _B_ref(xn, B_w_gate, B_w_up, B_w_down)
```

```asm
; @launch kernel=gemm1_kernel grid=(256,1,1) block=(256,1,1) lds=147456
; @launch kernel=parallel_sum__softmax_full_mha__glu_gated_bilinear__prompt_kernel grid=(256,1,1) block=(512,1,1) lds=163840
.amdgcn_target "amdgcn-amd-amdhsa--gfx950"
.text
.globl gemm1_kernel
.p2align 8
.type gemm1_kernel,@function
gemm1_kernel:
    s_cmp_ge_u32 s2, 256
    s_cbranch_scc1 L_gemm1_kernel_end
    s_load_dwordx2 s[4:5], s[0:1], 8
    s_load_dwordx4 s[48:51], s[0:1], 32
    s_load_dwordx2 s[6:7], s[0:1], 72
    s_load_dwordx2 s[70:71], s[0:1], 48
    s_load_dwordx2 s[76:77], s[0:1], 0
    s_load_dwordx2 s[78:79], s[0:1], 64
    s_and_b32 s60, s2, 7
    s_lshr_b32 s61, s2, 3
    s_and_b32 s62, s61, 3
    s_lshr_b32 s63, s61, 2
    v_lshrrev_b32 v18, 6, v0
    v_and_b32 v0, 63, v0
    v_readfirstlane_b32 s64, v18
    v_lshrrev_b32 v19, 4, v0
    v_and_b32 v20, 15, v0
    s_lshr_b32 s65, s64, 1
    s_and_b32 s66, s64, 1
    s_lshl_b32 s44, s64, 12
    s_mul_i32 s45, s64, 5120
    s_add_u32 s45, s45, 16384
    v_and_b32 v21, 7, v0
    v_lshrrev_b32 v22, 3, v0
    v_lshlrev_b32 v23, 11, v21
    v_lshl_add_u32 v23, v22, 4, v23
    v_lshl_add_u32 v23, v18, 7, v23
    s_lshl_b32 s43, s2, 14
    v_lshlrev_b32 v93, 4, v21
    v_lshl_add_u32 v92, v18, 2, v93
    v_lshrrev_b32 v91, 2, v22
    v_lshl_add_u32 v91, v18, 1, v91
    v_lshlrev_b32 v91, 17, v91
    v_and_b32 v22, 3, v22
    v_lshl_add_u32 v91, v22, 8, v91
    v_add_u32 v91, v91, v93
    s_waitcnt lgkmcnt(0)
    s_add_u32 s36, s6, 42991616
    s_addc_u32 s37, s7, 0
    s_load_dword s69, s[36:37], 32768
    s_mov_b32 s32, s76
    s_mov_b32 s33, s77
    s_mov_b32 s34, 4194304
    s_mov_b32 s35, 0x20000
    buffer_load_dwordx4 v[24:27], v23, s[32:35], s43 offen offset:0
    buffer_load_dwordx4 v[28:31], v23, s[32:35], s43 offen offset:512
    buffer_load_dwordx4 v[32:35], v23, s[32:35], s43 offen offset:1024
    buffer_load_dwordx4 v[36:39], v23, s[32:35], s43 offen offset:1536
    s_mov_b32 s38, 65536
    s_mov_b32 s39, 0x20000
    s_lshr_b32 s43, s2, 1
    s_lshl_b32 s43, s43, 10
    s_and_b32 s57, s2, 1
    s_lshl_b32 s57, s57, 7
    s_add_u32 s43, s43, s57
    v_lshlrev_b32 v15, 4, v0
    v_add_u32 v15, s44, v15
    v_lshrrev_b32 v21, 3, v0
    v_bfe_u32 v22, v0, 4, 1
    v_lshl_or_b32 v22, s66, 1, v22
    v_bfe_u32 v23, v0, 1, 2
    v_xor_b32 v22, v22, v23
    v_lshlrev_b32 v22, 5, v22
    v_and_b32 v23, 1, v0
    v_lshl_or_b32 v22, v23, 4, v22
    v_lshl_add_u32 v21, s64, 3, v21
    v_mul_u32_u24 v16, 6144, v21
    v_add_u32 v16, v16, v22
    v_mul_u32_u24 v17, 7168, v21
    v_add_u32 v17, v17, v22
    s_lshl_b32 s40, s63, 14
    s_mov_b32 s41, 0
    s_mov_b32 s42, 0
    s_lshl_b32 s52, s60, 8
    s_mul_i32 s53, s60, 896
    s_cmp_eq_u32 s62, 3
    s_cbranch_scc1 L_gemm1_kernel_setB
    s_lshl_b32 s54, s62, 7
    s_cmp_eq_u32 s62, 2
    s_cselect_b32 s54, 2048, s54
    s_add_u32 s52, s52, s54
    s_lshl_b32 s54, s62, 8
    s_add_u32 s53, s53, s54
    s_waitcnt lgkmcnt(0)
    s_add_u32 s57, s52, 0
    s_add_u32 s12, s4, s57
    s_addc_u32 s13, s5, 0
    s_sub_u32 s14, 6291456, s57
    s_mov_b32 s15, 0x20000
    s_add_u32 s57, s53, 0
    s_add_u32 s16, s48, s57
    s_addc_u32 s17, s49, 0
    s_sub_u32 s16, s16, 1024
    s_subb_u32 s17, s17, 0
    s_sub_u32 s18, 7341056, s57
    s_mov_b32 s19, 0x20000
    s_add_u32 s57, s53, 0
    s_add_u32 s20, s50, s57
    s_addc_u32 s21, s51, 0
    s_sub_u32 s20, s20, 2048
    s_subb_u32 s21, s21, 0
    s_sub_u32 s22, 7342080, s57
    s_mov_b32 s23, 0x20000
    s_add_u32 s57, s53, 128
    s_add_u32 s24, s48, s57
    s_addc_u32 s25, s49, 0
    s_sub_u32 s24, s24, 3072
    s_subb_u32 s25, s25, 0
    s_sub_u32 s26, 7343104, s57
    s_mov_b32 s27, 0x20000
    s_add_u32 s57, s53, 128
    s_add_u32 s28, s50, s57
    s_addc_u32 s29, s51, 0
    s_sub_u32 s30, 7340032, s57
    s_mov_b32 s31, 0x20000
    s_branch L_gemm1_kernel_setdone
L_gemm1_kernel_setB:
    s_waitcnt lgkmcnt(0)
    s_add_u32 s57, s52, 4096
    s_add_u32 s12, s4, s57
    s_addc_u32 s13, s5, 0
    s_sub_u32 s14, 6291456, s57
    s_mov_b32 s15, 0x20000
    s_add_u32 s57, s52, 4224
    s_add_u32 s16, s4, s57
    s_addc_u32 s17, s5, 0
    s_sub_u32 s16, s16, 1024
    s_subb_u32 s17, s17, 0
    s_sub_u32 s18, 6292480, s57
    s_mov_b32 s19, 0x20000
    s_add_u32 s57, s52, 2176
    s_add_u32 s20, s4, s57
    s_addc_u32 s21, s5, 0
    s_sub_u32 s20, s20, 2048
    s_subb_u32 s21, s21, 0
    s_sub_u32 s22, 6293504, s57
    s_mov_b32 s23, 0x20000
    s_add_u32 s57, s53, 768
    s_add_u32 s24, s48, s57
    s_addc_u32 s25, s49, 0
    s_sub_u32 s24, s24, 3072
    s_subb_u32 s25, s25, 0
    s_sub_u32 s26, 7343104, s57
    s_mov_b32 s27, 0x20000
    s_add_u32 s57, s53, 768
    s_add_u32 s28, s50, s57
    s_addc_u32 s29, s51, 0
    s_sub_u32 s30, 7340032, s57
    s_mov_b32 s31, 0x20000
L_gemm1_kernel_setdone:
    s_mov_b32 s8, s6
    s_mov_b32 s9, s7
    s_mov_b32 s10, 4194304
    s_mov_b32 s11, 0x20000
    v_lshlrev_b32 v1, 4, v0
    s_lshl_b32 s57, s65, 13
    v_add_u32 v1, s57, v1
    v_add_u32 v2, 73728, v1
    v_mul_u32_u24 v21, 5120, v19
    v_lshrrev_b32 v22, 2, v20
    v_lshl_add_u32 v21, v22, 7, v21
    v_and_b32 v22, 3, v0
    v_lshl_add_u32 v21, v22, 3, v21
    v_add_u32 v21, 16384, v21
    v_bfe_u32 v22, v0, 3, 1
    v_and_b32 v23, 1, v19
    v_lshl_or_b32 v22, v23, 1, v22
    s_lshl_b32 s57, s66, 1
    s_lshl_b32 s58, s66, 11
    s_add_u32 s59, s57, 0
    v_xor_b32 v23, s59, v22
    v_lshl_add_u32 v3, v23, 5, v21
    v_add_u32 v5, 73728, v3
    s_add_u32 s59, s57, 1
    v_xor_b32 v23, s59, v22
    v_lshl_add_u32 v4, v23, 5, v21
    v_add_u32 v6, 73728, v4
    v_add_u32 v21, s58, v21
    v_xor_b32 v23, 0, v22
    v_lshl_add_u32 v7, v23, 5, v21
    v_add_u32 v11, 73728, v7
    v_xor_b32 v23, 1, v22
    v_lshl_add_u32 v8, v23, 5, v21
    v_add_u32 v12, 73728, v8
    v_xor_b32 v23, 2, v22
    v_lshl_add_u32 v9, v23, 5, v21
    v_add_u32 v13, 73728, v9
    v_xor_b32 v23, 3, v22
    v_lshl_add_u32 v10, v23, 5, v21
    v_add_u32 v14, 73728, v10
    s_mov_b32 s72, s70
    s_mov_b32 s73, s71
    s_mov_b32 s74, 7340032
    s_mov_b32 s75, 0x20000
    s_lshl_b32 s47, s2, 2
    s_add_u32 s47, s47, s64
    s_lshl_b32 s47, s47, 10
    v_lshlrev_b32 v21, 4, v0
    s_mov_b32 s76, s78
    s_mov_b32 s77, s79
    s_mov_b32 s78, 256
    s_mov_b32 s79, 0x20000
    s_add_u32 s80, s6, 41943040
    s_addc_u32 s81, s7, 0
    s_mov_b32 s82, 131072
    s_mov_b32 s83, 0x20000
    s_lshl_b32 s59, s2, 2
    s_add_u32 s59, s59, s64
    s_lshl_b32 s59, s59, 7
    s_waitcnt lgkmcnt(0)
    s_cmp_eq_u32 s62, 3
    s_cbranch_scc1 L_gemm1_kernel_B
    s_add_u32 m0, s45, 0
    s_nop 0
    buffer_load_dwordx4 v16, s[12:15], s41 offen lds
    buffer_load_dwordx4 v17, s[16:19], s42 offen offset:1024 lds
    buffer_load_dwordx4 v17, s[20:23], s42 offen offset:2048 lds
    buffer_load_dwordx4 v17, s[24:27], s42 offen offset:3072 lds
    s_add_u32 m0, s45, 4096
    s_nop 0
    s_add_u32 s41, s41, 196608
    buffer_load_dwordx4 v17, s[28:31], s42 offen lds
    s_add_u32 s42, s42, 229376
    s_mov_b32 s57, 0x3f803f80
    v_mov_b32 v90, s57
    v_mov_b32 v72, 0
    v_mov_b32 v73, 0
    v_mov_b32 v74, 0
    v_mov_b32 v75, 0
    v_mov_b32 v76, 0
    v_mov_b32 v77, 0
    v_mov_b32 v78, 0
    v_mov_b32 v79, 0
    s_waitcnt vmcnt(8)
    v_dot2_f32_bf16 v72, v24, v90, v72
    v_dot2_f32_bf16 v76, v24, v24, v76
    v_dot2_f32_bf16 v73, v25, v90, v73
    v_dot2_f32_bf16 v77, v25, v25, v77
    v_dot2_f32_bf16 v74, v26, v90, v74
    v_dot2_f32_bf16 v78, v26, v26, v78
    v_dot2_f32_bf16 v75, v27, v90, v75
    v_dot2_f32_bf16 v79, v27, v27, v79
    s_waitcnt vmcnt(7)
    v_dot2_f32_bf16 v72, v28, v90, v72
    v_dot2_f32_bf16 v76, v28, v28, v76
    v_dot2_f32_bf16 v73, v29, v90, v73
    v_dot2_f32_bf16 v77, v29, v29, v77
    v_dot2_f32_bf16 v74, v30, v90, v74
    v_dot2_f32_bf16 v78, v30, v30, v78
    v_dot2_f32_bf16 v75, v31, v90, v75
    v_dot2_f32_bf16 v79, v31, v31, v79
    s_waitcnt vmcnt(6)
    v_dot2_f32_bf16 v72, v32, v90, v72
    v_dot2_f32_bf16 v76, v32, v32, v76
    v_dot2_f32_bf16 v73, v33, v90, v73
    v_dot2_f32_bf16 v77, v33, v33, v77
    v_dot2_f32_bf16 v74, v34, v90, v74
    v_dot2_f32_bf16 v78, v34, v34, v78
    v_dot2_f32_bf16 v75, v35, v90, v75
    v_dot2_f32_bf16 v79, v35, v35, v79
    s_waitcnt vmcnt(5)
    v_dot2_f32_bf16 v72, v36, v90, v72
    v_dot2_f32_bf16 v76, v36, v36, v76
    v_dot2_f32_bf16 v73, v37, v90, v73
    v_dot2_f32_bf16 v77, v37, v37, v77
    v_dot2_f32_bf16 v74, v38, v90, v74
    v_dot2_f32_bf16 v78, v38, v38, v78
    v_dot2_f32_bf16 v75, v39, v90, v75
    v_dot2_f32_bf16 v79, v39, v39, v79
    v_lshlrev_b32 v40, 16, v24
    v_and_b32 v41, 0xffff0000, v24
    v_lshlrev_b32 v42, 16, v25
    v_pk_add_f32 v[72:73], v[72:73], v[74:75]
    v_pk_add_f32 v[76:77], v[76:77], v[78:79]
    v_and_b32 v43, 0xffff0000, v25
    v_add_f32 v72, v72, v73
    v_add_f32 v73, v76, v77
    v_mov_b32 v74, v72
    v_mov_b32 v75, v73
    v_lshlrev_b32 v44, 16, v26
    v_and_b32 v45, 0xffff0000, v26
    v_permlane32_swap_b32 v72, v74
    v_permlane32_swap_b32 v73, v75
    v_lshlrev_b32 v46, 16, v27
    v_and_b32 v47, 0xffff0000, v27
    v_pk_add_f32 v[72:73], v[72:73], v[74:75]
    v_mov_b32 v74, v72
    v_mov_b32 v75, v73
    v_lshlrev_b32 v48, 16, v28
    v_and_b32 v49, 0xffff0000, v28
    v_permlane16_swap_b32 v72, v74
    v_permlane16_swap_b32 v73, v75
    v_lshlrev_b32 v50, 16, v29
    v_and_b32 v51, 0xffff0000, v29
    v_pk_add_f32 v[72:73], v[72:73], v[74:75]
    v_lshlrev_b32 v52, 16, v30
    v_and_b32 v53, 0xffff0000, v30
    v_add_f32_dpp v72, v72, v72 row_ror:8 row_mask:0xf bank_mask:0xf
    v_add_f32_dpp v73, v73, v73 row_ror:8 row_mask:0xf bank_mask:0xf
    ds_write_b32 v92, v72
    ds_write_b32 v92, v73 offset:256
    v_lshlrev_b32 v54, 16, v31
    v_and_b32 v55, 0xffff0000, v31
    v_lshlrev_b32 v56, 16, v32
    v_and_b32 v57, 0xffff0000, v32
    v_lshlrev_b32 v58, 16, v33
    v_and_b32 v59, 0xffff0000, v33
    v_lshlrev_b32 v60, 16, v34
    v_and_b32 v61, 0xffff0000, v34
    v_lshlrev_b32 v62, 16, v35
    v_and_b32 v63, 0xffff0000, v35
    s_waitcnt lgkmcnt(0)
    s_barrier
    ds_read_b128 v[72:75], v93
    ds_read_b128 v[76:79], v93 offset:256
    v_lshlrev_b32 v64, 16, v36
    v_and_b32 v65, 0xffff0000, v36
    v_lshlrev_b32 v66, 16, v37
    v_and_b32 v67, 0xffff0000, v37
    v_lshlrev_b32 v68, 16, v38
    v_and_b32 v69, 0xffff0000, v38
    v_lshlrev_b32 v70, 16, v39
    v_and_b32 v71, 0xffff0000, v39
    s_waitcnt lgkmcnt(0)
    v_pk_add_f32 v[72:73], v[72:73], v[74:75]
    v_pk_add_f32 v[76:77], v[76:77], v[78:79]
    v_add_f32 v88, v72, v73
    v_add_f32 v89, v76, v77
    v_mul_f32 v88, 0x3a800000, v88
    v_mul_f32 v89, 0x3a800000, v89
    v_fma_f32 v89, -v88, v88, v89
    v_max_f32 v89, 0, v89
    v_cvt_pk_bf16_f32 v89, v89, v88
    v_and_b32 v88, 0xffff0000, v89
    v_lshlrev_b32 v89, 16, v89
    v_add_f32 v89, 0x3727c5ac, v89
    v_cvt_pk_bf16_f32 v89, v89, v89
    v_lshlrev_b32 v89, 16, v89
    v_sqrt_f32 v89, v89
    v_xor_b32 v88, 0x80000000, v88
    v_cvt_pk_bf16_f32 v89, v89, v89
    v_lshlrev_b32 v89, 16, v89
    v_rcp_f32 v89, v89
    s_nop 0
    v_pk_add_f32 v[40:41], v[40:41], v[88:89] op_sel_hi:[1,0]
    v_pk_add_f32 v[42:43], v[42:43], v[88:89] op_sel_hi:[1,0]
    v_pk_add_f32 v[44:45], v[44:45], v[88:89] op_sel_hi:[1,0]
    v_pk_add_f32 v[46:47], v[46:47], v[88:89] op_sel_hi:[1,0]
    v_cvt_pk_bf16_f32 v24, v40, v41
    v_cvt_pk_bf16_f32 v25, v42, v43
    v_cvt_pk_bf16_f32 v26, v44, v45
    v_cvt_pk_bf16_f32 v27, v46, v47
    v_lshlrev_b32 v40, 16, v24
    v_and_b32 v41, 0xffff0000, v24
    v_lshlrev_b32 v42, 16, v25
    v_and_b32 v43, 0xffff0000, v25
    v_lshlrev_b32 v44, 16, v26
    v_and_b32 v45, 0xffff0000, v26
    v_lshlrev_b32 v46, 16, v27
    v_and_b32 v47, 0xffff0000, v27
    v_pk_mul_f32 v[40:41], v[40:41], v[88:89] op_sel:[0,1] op_sel_hi:[1,1]
    v_pk_mul_f32 v[42:43], v[42:43], v[88:89] op_sel:[0,1] op_sel_hi:[1,1]
    v_pk_mul_f32 v[44:45], v[44:45], v[88:89] op_sel:[0,1] op_sel_hi:[1,1]
    v_pk_mul_f32 v[46:47], v[46:47], v[88:89] op_sel:[0,1] op_sel_hi:[1,1]
    v_cvt_pk_bf16_f32 v24, v40, v41
    v_cvt_pk_bf16_f32 v25, v42, v43
    v_cvt_pk_bf16_f32 v26, v44, v45
    v_cvt_pk_bf16_f32 v27, v46, v47
    buffer_store_dwordx4 v[24:27], v91, s[8:11], s43 offen sc0 sc1
    s_add_u32 s43, s43, 1048576
    v_pk_add_f32 v[48:49], v[48:49], v[88:89] op_sel_hi:[1,0]
    v_pk_add_f32 v[50:51], v[50:51], v[88:89] op_sel_hi:[1,0]
    v_pk_add_f32 v[52:53], v[52:53], v[88:89] op_sel_hi:[1,0]
    v_pk_add_f32 v[54:55], v[54:55], v[88:89] op_sel_hi:[1,0]
    v_cvt_pk_bf16_f32 v28, v48, v49
    v_cvt_pk_bf16_f32 v29, v50, v51
    v_cvt_pk_bf16_f32 v30, v52, v53
    v_cvt_pk_bf16_f32 v31, v54, v55
    v_lshlrev_b32 v48, 16, v28
    v_and_b32 v49, 0xffff0000, v28
    v_lshlrev_b32 v50, 16, v29
    v_and_b32 v51, 0xffff0000, v29
    v_lshlrev_b32 v52, 16, v30
    v_and_b32 v53, 0xffff0000, v30
    v_lshlrev_b32 v54, 16, v31
    v_and_b32 v55, 0xffff0000, v31
    v_pk_mul_f32 v[48:49], v[48:49], v[88:89] op_sel:[0,1] op_sel_hi:[1,1]
    v_pk_mul_f32 v[50:51], v[50:51], v[88:89] op_sel:[0,1] op_sel_hi:[1,1]
    v_pk_mul_f32 v[52:53], v[52:53], v[88:89] op_sel:[0,1] op_sel_hi:[1,1]
    v_pk_mul_f32 v[54:55], v[54:55], v[88:89] op_sel:[0,1] op_sel_hi:[1,1]
    v_cvt_pk_bf16_f32 v28, v48, v49
    v_cvt_pk_bf16_f32 v29, v50, v51
    v_cvt_pk_bf16_f32 v30, v52, v53
    v_cvt_pk_bf16_f32 v31, v54, v55
    buffer_store_dwordx4 v[28:31], v91, s[8:11], s43 offen sc0 sc1
    s_add_u32 s43, s43, 1048576
    v_pk_add_f32 v[56:57], v[56:57], v[88:89] op_sel_hi:[1,0]
    v_pk_add_f32 v[58:59], v[58:59], v[88:89] op_sel_hi:[1,0]
    v_pk_add_f32 v[60:61], v[60:61], v[88:89] op_sel_hi:[1,0]
    v_pk_add_f32 v[62:63], v[62:63], v[88:89] op_sel_hi:[1,0]
    v_cvt_pk_bf16_f32 v32, v56, v57
    v_cvt_pk_bf16_f32 v33, v58, v59
    v_cvt_pk_bf16_f32 v34, v60, v61
    v_cvt_pk_bf16_f32 v35, v62, v63
    v_lshlrev_b32 v56, 16, v32
    v_and_b32 v57, 0xffff0000, v32
    v_lshlrev_b32 v58, 16, v33
    v_and_b32 v59, 0xffff0000, v33
    v_lshlrev_b32 v60, 16, v34
    v_and_b32 v61, 0xffff0000, v34
    v_lshlrev_b32 v62, 16, v35
    v_and_b32 v63, 0xffff0000, v35
    v_pk_mul_f32 v[56:57], v[56:57], v[88:89] op_sel:[0,1] op_sel_hi:[1,1]
    v_pk_mul_f32 v[58:59], v[58:59], v[88:89] op_sel:[0,1] op_sel_hi:[1,1]
    v_pk_mul_f32 v[60:61], v[60:61], v[88:89] op_sel:[0,1] op_sel_hi:[1,1]
    v_pk_mul_f32 v[62:63], v[62:63], v[88:89] op_sel:[0,1] op_sel_hi:[1,1]
    v_cvt_pk_bf16_f32 v32, v56, v57
    v_cvt_pk_bf16_f32 v33, v58, v59
    v_cvt_pk_bf16_f32 v34, v60, v61
    v_cvt_pk_bf16_f32 v35, v62, v63
    buffer_store_dwordx4 v[32:35], v91, s[8:11], s43 offen sc0 sc1
    s_add_u32 s43, s43, 1048576
    v_pk_add_f32 v[64:65], v[64:65], v[88:89] op_sel_hi:[1,0]
    v_pk_add_f32 v[66:67], v[66:67], v[88:89] op_sel_hi:[1,0]
    v_pk_add_f32 v[68:69], v[68:69], v[88:89] op_sel_hi:[1,0]
    v_pk_add_f32 v[70:71], v[70:71], v[88:89] op_sel_hi:[1,0]
    v_cvt_pk_bf16_f32 v36, v64, v65
    v_cvt_pk_bf16_f32 v37, v66, v67
    v_cvt_pk_bf16_f32 v38, v68, v69
    v_cvt_pk_bf16_f32 v39, v70, v71
    v_lshlrev_b32 v64, 16, v36
    v_and_b32 v65, 0xffff0000, v36
    v_lshlrev_b32 v66, 16, v37
    v_and_b32 v67, 0xffff0000, v37
    v_lshlrev_b32 v68, 16, v38
    v_and_b32 v69, 0xffff0000, v38
    v_lshlrev_b32 v70, 16, v39
    v_and_b32 v71, 0xffff0000, v39
    v_pk_mul_f32 v[64:65], v[64:65], v[88:89] op_sel:[0,1] op_sel_hi:[1,1]
    v_pk_mul_f32 v[66:67], v[66:67], v[88:89] op_sel:[0,1] op_sel_hi:[1,1]
    v_pk_mul_f32 v[68:69], v[68:69], v[88:89] op_sel:[0,1] op_sel_hi:[1,1]
    v_pk_mul_f32 v[70:71], v[70:71], v[88:89] op_sel:[0,1] op_sel_hi:[1,1]
    v_cvt_pk_bf16_f32 v36, v64, v65
    v_cvt_pk_bf16_f32 v37, v66, v67
    v_cvt_pk_bf16_f32 v38, v68, v69
    v_cvt_pk_bf16_f32 v39, v70, v71
    buffer_store_dwordx4 v[36:39], v91, s[8:11], s43 offen sc0 sc1
    s_add_u32 s69, s69, 1
    s_lshl_b32 s57, s2, 7
    v_mov_b32 v22, 0
    v_mov_b32 v23, s69
    s_waitcnt vmcnt(0)
    s_barrier
    s_cmp_lg_u32 s64, 0
    s_cbranch_scc1 L_gemm1_kernel_nfA
    s_mov_b64 exec, 1
    buffer_store_dword v23, v22, s[36:39], s57 offen sc0 sc1
    s_mov_b64 exec, -1
L_gemm1_kernel_nfA:
    s_add_u32 m0, s45, 36864
    s_nop 0
    buffer_load_dwordx4 v16, s[12:15], s41 offen lds
    buffer_load_dwordx4 v17, s[16:19], s42 offen offset:1024 lds
    buffer_load_dwordx4 v17, s[20:23], s42 offen offset:2048 lds
    buffer_load_dwordx4 v17, s[24:27], s42 offen offset:3072 lds
    s_add_u32 m0, s45, 40960
    s_nop 0
    s_add_u32 s41, s41, 196608
    buffer_load_dwordx4 v17, s[28:31], s42 offen lds
    s_add_u32 s42, s42, 229376
    s_add_u32 m0, s45, 73728
    s_nop 0
    buffer_load_dwordx4 v16, s[12:15], s41 offen lds
    buffer_load_dwordx4 v17, s[16:19], s42 offen offset:1024 lds
    buffer_load_dwordx4 v17, s[20:23], s42 offen offset:2048 lds
    buffer_load_dwordx4 v17, s[24:27], s42 offen offset:3072 lds
    s_add_u32 m0, s45, 77824
    s_nop 0
    s_add_u32 s41, s41, 196608
    buffer_load_dwordx4 v17, s[28:31], s42 offen lds
    s_add_u32 s42, s42, 229376
    v_and_b32 v23, 31, v0
    v_lshlrev_b32 v23, 7, v23
    s_lshl_b32 s57, s63, 12
    buffer_load_dword v22, v23, s[36:39], s57 offen sc0 sc1
    v_mov_b32 v24, 0
    v_mov_b32 v25, 0
    v_mov_b32 v26, 0
    v_mov_b32 v27, 0
    v_mov_b32 v28, 0
    v_mov_b32 v29, 0
    v_mov_b32 v30, 0
    v_mov_b32 v31, 0
    v_mov_b32 v32, 0
    v_mov_b32 v33, 0
    v_mov_b32 v34, 0
    v_mov_b32 v35, 0
    v_mov_b32 v36, 0
    v_mov_b32 v37, 0
    v_mov_b32 v38, 0
    v_mov_b32 v39, 0
    v_mov_b32 v40, 0
    v_mov_b32 v41, 0
    v_mov_b32 v42, 0
    v_mov_b32 v43, 0
    v_mov_b32 v44, 0
    v_mov_b32 v45, 0
    v_mov_b32 v46, 0
    v_mov_b32 v47, 0
    v_mov_b32 v48, 0
    v_mov_b32 v49, 0
    v_mov_b32 v50, 0
    v_mov_b32 v51, 0
    v_mov_b32 v52, 0
    v_mov_b32 v53, 0
    v_mov_b32 v54, 0
    v_mov_b32 v55, 0
    v_mov_b32 v56, 0
    v_mov_b32 v57, 0
    v_mov_b32 v58, 0
    v_mov_b32 v59, 0
    v_mov_b32 v60, 0
    v_mov_b32 v61, 0
    v_mov_b32 v62, 0
    v_mov_b32 v63, 0
    v_mov_b32 v64, 0
    v_mov_b32 v65, 0
    v_mov_b32 v66, 0
    v_mov_b32 v67, 0
    v_mov_b32 v68, 0
    v_mov_b32 v69, 0
    v_mov_b32 v70, 0
    v_mov_b32 v71, 0
    v_mov_b32 v72, 0
    v_mov_b32 v73, 0
    v_mov_b32 v74, 0
    v_mov_b32 v75, 0
    v_mov_b32 v76, 0
    v_mov_b32 v77, 0
    v_mov_b32 v78, 0
    v_mov_b32 v79, 0
    v_mov_b32 v80, 0
    v_mov_b32 v81, 0
    v_mov_b32 v82, 0
    v_mov_b32 v83, 0
    v_mov_b32 v84, 0
    v_mov_b32 v85, 0
    v_mov_b32 v86, 0
    v_mov_b32 v87, 0
    v_mov_b32 v88, 0
    v_mov_b32 v89, 0
    v_mov_b32 v90, 0
    v_mov_b32 v91, 0
    v_mov_b32 v92, 0
    v_mov_b32 v93, 0
    v_mov_b32 v94, 0
    v_mov_b32 v95, 0
    v_mov_b32 v96, 0
    v_mov_b32 v97, 0
    v_mov_b32 v98, 0
    v_mov_b32 v99, 0
    v_mov_b32 v100, 0
    v_mov_b32 v101, 0
    v_mov_b32 v102, 0
    v_mov_b32 v103, 0
    v_mov_b32 v104, 0
    v_mov_b32 v105, 0
    v_mov_b32 v106, 0
    v_mov_b32 v107, 0
    v_mov_b32 v108, 0
    v_mov_b32 v109, 0
    v_mov_b32 v110, 0
    v_mov_b32 v111, 0
    v_mov_b32 v112, 0
    v_mov_b32 v113, 0
    v_mov_b32 v114, 0
    v_mov_b32 v115, 0
    v_mov_b32 v116, 0
    v_mov_b32 v117, 0
    v_mov_b32 v118, 0
    v_mov_b32 v119, 0
    v_mov_b32 v120, 0
    v_mov_b32 v121, 0
    v_mov_b32 v122, 0
    v_mov_b32 v123, 0
    v_mov_b32 v124, 0
    v_mov_b32 v125, 0
    v_mov_b32 v126, 0
    v_mov_b32 v127, 0
    v_mov_b32 v128, 0
    v_mov_b32 v129, 0
    v_mov_b32 v130, 0
    v_mov_b32 v131, 0
    v_mov_b32 v132, 0
    v_mov_b32 v133, 0
    v_mov_b32 v134, 0
    v_mov_b32 v135, 0
    v_mov_b32 v136, 0
    v_mov_b32 v137, 0
    v_mov_b32 v138, 0
    v_mov_b32 v139, 0
    v_mov_b32 v140, 0
    v_mov_b32 v141, 0
    v_mov_b32 v142, 0
    v_mov_b32 v143, 0
    v_mov_b32 v144, 0
    v_mov_b32 v145, 0
    v_mov_b32 v146, 0
    v_mov_b32 v147, 0
    v_mov_b32 v148, 0
    v_mov_b32 v149, 0
    v_mov_b32 v150, 0
    v_mov_b32 v151, 0
    v_mov_b32 v216, 0
    v_mov_b32 v217, 0
    v_mov_b32 v218, 0
    v_mov_b32 v219, 0
    v_mov_b32 v220, 0
    v_mov_b32 v221, 0
    v_mov_b32 v222, 0
    v_mov_b32 v223, 0
    v_mov_b32 v224, 0
    v_mov_b32 v225, 0
    v_mov_b32 v226, 0
    v_mov_b32 v227, 0
    v_mov_b32 v228, 0
    v_mov_b32 v229, 0
    v_mov_b32 v230, 0
    v_mov_b32 v231, 0
    v_mov_b32 v232, 0
    v_mov_b32 v233, 0
    v_mov_b32 v234, 0
    v_mov_b32 v235, 0
    v_mov_b32 v236, 0
    v_mov_b32 v237, 0
    v_mov_b32 v238, 0
    v_mov_b32 v239, 0
    v_mov_b32 v240, 0
    v_mov_b32 v241, 0
    v_mov_b32 v242, 0
    v_mov_b32 v243, 0
    v_mov_b32 v244, 0
    v_mov_b32 v245, 0
    v_mov_b32 v246, 0
    v_mov_b32 v247, 0
    v_mov_b32 v248, 0
    v_mov_b32 v249, 0
    v_mov_b32 v250, 0
    v_mov_b32 v251, 0
    v_mov_b32 v252, 0
    v_mov_b32 v253, 0
    v_mov_b32 v254, 0
    v_mov_b32 v255, 0
    v_accvgpr_write_b32 a144, 0
    v_accvgpr_write_b32 a145, 0
    v_accvgpr_write_b32 a146, 0
    v_accvgpr_write_b32 a147, 0
    v_accvgpr_write_b32 a148, 0
    v_accvgpr_write_b32 a149, 0
    v_accvgpr_write_b32 a150, 0
    v_accvgpr_write_b32 a151, 0
    v_accvgpr_write_b32 a152, 0
    v_accvgpr_write_b32 a153, 0
    v_accvgpr_write_b32 a154, 0
    v_accvgpr_write_b32 a155, 0
    v_accvgpr_write_b32 a156, 0
    v_accvgpr_write_b32 a157, 0
    v_accvgpr_write_b32 a158, 0
    v_accvgpr_write_b32 a159, 0
    v_accvgpr_write_b32 a160, 0
    v_accvgpr_write_b32 a161, 0
    v_accvgpr_write_b32 a162, 0
    v_accvgpr_write_b32 a163, 0
    v_accvgpr_write_b32 a164, 0
    v_accvgpr_write_b32 a165, 0
    v_accvgpr_write_b32 a166, 0
    v_accvgpr_write_b32 a167, 0
    v_mov_b32 v152, 0
    v_mov_b32 v153, 0
    v_mov_b32 v154, 0
    v_mov_b32 v155, 0
    v_mov_b32 v156, 0
    v_mov_b32 v157, 0
    v_mov_b32 v158, 0
    v_mov_b32 v159, 0
    v_mov_b32 v160, 0
    v_mov_b32 v161, 0
    v_mov_b32 v162, 0
    v_mov_b32 v163, 0
    v_mov_b32 v164, 0
    v_mov_b32 v165, 0
    v_mov_b32 v166, 0
    v_mov_b32 v167, 0
    v_mov_b32 v168, 0
    v_mov_b32 v169, 0
    v_mov_b32 v170, 0
    v_mov_b32 v171, 0
    v_mov_b32 v172, 0
    v_mov_b32 v173, 0
    v_mov_b32 v174, 0
    v_mov_b32 v175, 0
    v_mov_b32 v176, 0
    v_mov_b32 v177, 0
    v_mov_b32 v178, 0
    v_mov_b32 v179, 0
    v_mov_b32 v180, 0
    v_mov_b32 v181, 0
    v_mov_b32 v182, 0
    v_mov_b32 v183, 0
    v_mov_b32 v184, 0
    v_mov_b32 v185, 0
    v_mov_b32 v186, 0
    v_mov_b32 v187, 0
    v_mov_b32 v188, 0
    v_mov_b32 v189, 0
    v_mov_b32 v190, 0
    v_mov_b32 v191, 0
    v_mov_b32 v192, 0
    v_mov_b32 v193, 0
    v_mov_b32 v194, 0
    v_mov_b32 v195, 0
    v_mov_b32 v196, 0
    v_mov_b32 v197, 0
    v_mov_b32 v198, 0
    v_mov_b32 v199, 0
    v_mov_b32 v200, 0
    v_mov_b32 v201, 0
    v_mov_b32 v202, 0
    v_mov_b32 v203, 0
    v_mov_b32 v204, 0
    v_mov_b32 v205, 0
    v_mov_b32 v206, 0
    v_mov_b32 v207, 0
    v_mov_b32 v208, 0
    v_mov_b32 v209, 0
    v_mov_b32 v210, 0
    v_mov_b32 v211, 0
    v_mov_b32 v212, 0
    v_mov_b32 v213, 0
    v_mov_b32 v214, 0
    v_mov_b32 v215, 0
    v_accvgpr_write_b32 a168, 0
    v_accvgpr_write_b32 a169, 0
    v_accvgpr_write_b32 a170, 0
    v_accvgpr_write_b32 a171, 0
    v_accvgpr_write_b32 a172, 0
    v_accvgpr_write_b32 a173, 0
    v_accvgpr_write_b32 a174, 0
    v_accvgpr_write_b32 a175, 0
    v_accvgpr_write_b32 a176, 0
    v_accvgpr_write_b32 a177, 0
    v_accvgpr_write_b32 a178, 0
    v_accvgpr_write_b32 a179, 0
    v_accvgpr_write_b32 a180, 0
    v_accvgpr_write_b32 a181, 0
    v_accvgpr_write_b32 a182, 0
    v_accvgpr_write_b32 a183, 0
    v_accvgpr_write_b32 a184, 0
    v_accvgpr_write_b32 a185, 0
    v_accvgpr_write_b32 a186, 0
    v_accvgpr_write_b32 a187, 0
    v_accvgpr_write_b32 a188, 0
    v_accvgpr_write_b32 a189, 0
    v_accvgpr_write_b32 a190, 0
    v_accvgpr_write_b32 a191, 0
    v_accvgpr_write_b32 a192, 0
    v_accvgpr_write_b32 a193, 0
    v_accvgpr_write_b32 a194, 0
    v_accvgpr_write_b32 a195, 0
    v_accvgpr_write_b32 a196, 0
    v_accvgpr_write_b32 a197, 0
    v_accvgpr_write_b32 a198, 0
    v_accvgpr_write_b32 a199, 0
    v_accvgpr_write_b32 a200, 0
    v_accvgpr_write_b32 a201, 0
    v_accvgpr_write_b32 a202, 0
    v_accvgpr_write_b32 a203, 0
    v_accvgpr_write_b32 a204, 0
    v_accvgpr_write_b32 a205, 0
    v_accvgpr_write_b32 a206, 0
    v_accvgpr_write_b32 a207, 0
    v_accvgpr_write_b32 a208, 0
    v_accvgpr_write_b32 a209, 0
    v_accvgpr_write_b32 a210, 0
    v_accvgpr_write_b32 a211, 0
    v_accvgpr_write_b32 a212, 0
    v_accvgpr_write_b32 a213, 0
    v_accvgpr_write_b32 a214, 0
    v_accvgpr_write_b32 a215, 0
    v_accvgpr_write_b32 a216, 0
    v_accvgpr_write_b32 a217, 0
    v_accvgpr_write_b32 a218, 0
    v_accvgpr_write_b32 a219, 0
    v_accvgpr_write_b32 a220, 0
    v_accvgpr_write_b32 a221, 0
    v_accvgpr_write_b32 a222, 0
    v_accvgpr_write_b32 a223, 0
    v_accvgpr_write_b32 a224, 0
    v_accvgpr_write_b32 a225, 0
    v_accvgpr_write_b32 a226, 0
    v_accvgpr_write_b32 a227, 0
    v_accvgpr_write_b32 a228, 0
    v_accvgpr_write_b32 a229, 0
    v_accvgpr_write_b32 a230, 0
    v_accvgpr_write_b32 a231, 0
    s_mov_b32 s58, 0x40000
L_gemm1_kernel_spinA:
    s_waitcnt vmcnt(0)
    v_cmp_ne_u32 vcc, s69, v22
    s_sub_u32 s58, s58, 1
    s_cbranch_vccz L_gemm1_kernel_goA
    s_cbranch_scc1 L_gemm1_kernel_goA
    buffer_load_dword v22, v23, s[36:39], s57 offen sc0 sc1
    s_branch L_gemm1_kernel_spinA
L_gemm1_kernel_goA:
    s_add_u32 m0, s44, 0
    s_nop 0
    buffer_load_dwordx4 v15, s[8:11], s40 offen offset:0 lds
    buffer_load_dwordx4 v15, s[8:11], s40 offen offset:1024 lds
    buffer_load_dwordx4 v15, s[8:11], s40 offen offset:2048 lds
    buffer_load_dwordx4 v15, s[8:11], s40 offen offset:3072 lds
    s_add_u32 s40, s40, 131072
    s_add_u32 m0, s44, 36864
    s_nop 0
    buffer_load_dwordx4 v15, s[8:11], s40 offen offset:0 lds
    buffer_load_dwordx4 v15, s[8:11], s40 offen offset:1024 lds
    buffer_load_dwordx4 v15, s[8:11], s40 offen offset:2048 lds
    buffer_load_dwordx4 v15, s[8:11], s40 offen offset:3072 lds
    s_add_u32 s40, s40, 131072
    s_add_u32 m0, s44, 73728
    s_nop 0
    buffer_load_dwordx4 v15, s[8:11], s40 offen offset:0 lds
    buffer_load_dwordx4 v15, s[8:11], s40 offen offset:1024 lds
    buffer_load_dwordx4 v15, s[8:11], s40 offen offset:2048 lds
    buffer_load_dwordx4 v15, s[8:11], s40 offen offset:3072 lds
    s_add_u32 s40, s40, 131072
    s_add_u32 m0, s44, 110592
    s_nop 0
    buffer_load_dwordx4 v15, s[8:11], s40 offen offset:0 lds
    buffer_load_dwordx4 v15, s[8:11], s40 offen offset:1024 lds
    buffer_load_dwordx4 v15, s[8:11], s40 offen offset:2048 lds
    buffer_load_dwordx4 v15, s[8:11], s40 offen offset:3072 lds
    s_add_u32 s40, s40, 131072
    s_add_u32 m0, s45, 110592
    s_nop 0
    buffer_load_dwordx4 v16, s[12:15], s41 offen lds
    buffer_load_dwordx4 v17, s[16:19], s42 offen offset:1024 lds
    buffer_load_dwordx4 v17, s[20:23], s42 offen offset:2048 lds
    buffer_load_dwordx4 v17, s[24:27], s42 offen offset:3072 lds
    s_add_u32 m0, s45, 114688
    s_nop 0
    s_add_u32 s41, s41, 196608
    buffer_load_dwordx4 v17, s[28:31], s42 offen lds
    s_add_u32 s42, s42, 229376
    s_mov_b32 s46, 7
    s_waitcnt vmcnt(17)
    s_barrier
    ds_read_b64_tr_b16 a[64:65], v3 offset:0
    ds_read_b64_tr_b16 a[66:67], v3 offset:512
    ds_read_b128 a[0:3], v1 offset:0
    ds_read_b128 a[4:7], v1 offset:1024
    ds_read_b128 a[8:11], v1 offset:2048
    ds_read_b128 a[12:15], v1 offset:3072
    ds_read_b64_tr_b16 a[68:69], v4 offset:0
    ds_read_b64_tr_b16 a[70:71], v4 offset:512
    ds_read_b128 a[16:19], v1 offset:4096
    ds_read_b128 a[20:23], v1 offset:5120
    ds_read_b128 a[24:27], v1 offset:6144
    ds_read_b128 a[28:31], v1 offset:7168
    ds_read_b64_tr_b16 a[72:73], v7 offset:1024
    ds_read_b64_tr_b16 a[74:75], v7 offset:1536
    ds_read_b64_tr_b16 a[76:77], v8 offset:1024
    ds_read_b64_tr_b16 a[78:79], v8 offset:1536
    ds_read_b64_tr_b16 a[80:81], v9 offset:1024
    ds_read_b64_tr_b16 a[82:83], v9 offset:1536
    ds_read_b64_tr_b16 a[84:85], v10 offset:1024
    ds_read_b64_tr_b16 a[86:87], v10 offset:1536
    ds_read_b64_tr_b16 a[88:89], v7 offset:2048
    ds_read_b64_tr_b16 a[90:91], v7 offset:2560
    ds_read_b64_tr_b16 a[92:93], v8 offset:2048
    ds_read_b64_tr_b16 a[94:95], v8 offset:2560
    ds_read_b64_tr_b16 a[96:97], v9 offset:2048
    ds_read_b64_tr_b16 a[98:99], v9 offset:2560
    ds_read_b64_tr_b16 a[100:101], v10 offset:2048
    ds_read_b64_tr_b16 a[102:103], v10 offset:2560
    s_waitcnt lgkmcnt(0)
    v_mfma_f32_16x16x32_bf16 v[24:27], a[64:67], a[0:3], v[24:27]
    v_mfma_f32_16x16x32_bf16 v[28:31], a[64:67], a[4:7], v[28:31]
    v_mfma_f32_16x16x32_bf16 v[32:35], a[64:67], a[8:11], v[32:35]
    v_mfma_f32_16x16x32_bf16 v[36:39], a[64:67], a[12:15], v[36:39]
    v_mfma_f32_16x16x32_bf16 v[40:43], a[64:67], a[16:19], v[40:43]
    v_mfma_f32_16x16x32_bf16 v[44:47], a[64:67], a[20:23], v[44:47]
    v_mfma_f32_16x16x32_bf16 v[48:51], a[64:67], a[24:27], v[48:51]
    v_mfma_f32_16x16x32_bf16 v[52:55], a[64:67], a[28:31], v[52:55]
    v_mfma_f32_16x16x32_bf16 v[56:59], a[68:71], a[0:3], v[56:59]
    s_waitcnt vmcnt(13)
    v_mfma_f32_16x16x32_bf16 v[60:63], a[68:71], a[4:7], v[60:63]
    s_barrier
    v_mfma_f32_16x16x32_bf16 v[64:67], a[68:71], a[8:11], v[64:67]
    s_add_u32 m0, s44, 0
    v_mfma_f32_16x16x32_bf16 v[68:71], a[68:71], a[12:15], v[68:71]
    ds_read_b64_tr_b16 a[104:105], v3 offset:36864
    v_mfma_f32_16x16x32_bf16 v[72:75], a[68:71], a[16:19], v[72:75]
    ds_read_b64_tr_b16 a[106:107], v3 offset:37376
    v_mfma_f32_16x16x32_bf16 v[76:79], a[68:71], a[20:23], v[76:79]
    v_mfma_f32_16x16x32_bf16 v[80:83], a[68:71], a[24:27], v[80:83]
    buffer_load_dwordx4 v15, s[8:11], s40 offen offset:0 lds
    v_mfma_f32_16x16x32_bf16 v[84:87], a[68:71], a[28:31], v[84:87]
    ds_read_b128 a[32:35], v1 offset:36864
    v_mfma_f32_16x16x32_bf16 v[88:91], a[72:75], a[0:3], v[88:91]
    v_mfma_f32_16x16x32_bf16 v[92:95], a[72:75], a[4:7], v[92:95]
    ds_read_b128 a[36:39], v1 offset:37888
    v_mfma_f32_16x16x32_bf16 v[96:99], a[72:75], a[8:11], v[96:99]
    buffer_load_dwordx4 v15, s[8:11], s40 offen offset:1024 lds
    v_mfma_f32_16x16x32_bf16 v[100:103], a[72:75], a[12:15], v[100:103]
    v_mfma_f32_16x16x32_bf16 v[104:107], a[72:75], a[16:19], v[104:107]
    ds_read_b128 a[40:43], v1 offset:38912
    v_mfma_f32_16x16x32_bf16 v[108:111], a[72:75], a[20:23], v[108:111]
    ds_read_b128 a[44:47], v1 offset:39936
    v_mfma_f32_16x16x32_bf16 v[112:115], a[72:75], a[24:27], v[112:115]
    v_mfma_f32_16x16x32_bf16 v[116:119], a[72:75], a[28:31], v[116:119]
    buffer_load_dwordx4 v15, s[8:11], s40 offen offset:2048 lds
    v_mfma_f32_16x16x32_bf16 v[120:123], a[76:79], a[0:3], v[120:123]
    ds_read_b64_tr_b16 a[108:109], v4 offset:36864
    v_mfma_f32_16x16x32_bf16 v[124:127], a[76:79], a[4:7], v[124:127]
    v_mfma_f32_16x16x32_bf16 v[128:131], a[76:79], a[8:11], v[128:131]
    ds_read_b64_tr_b16 a[110:111], v4 offset:37376
    v_mfma_f32_16x16x32_bf16 v[132:135], a[76:79], a[12:15], v[132:135]
    buffer_load_dwordx4 v15, s[8:11], s40 offen offset:3072 lds
    v_mfma_f32_16x16x32_bf16 v[136:139], a[76:79], a[16:19], v[136:139]
    v_mfma_f32_16x16x32_bf16 v[140:143], a[76:79], a[20:23], v[140:143]
    ds_read_b128 a[48:51], v1 offset:40960
    v_mfma_f32_16x16x32_bf16 v[144:147], a[76:79], a[24:27], v[144:147]
    ds_read_b128 a[52:55], v1 offset:41984
    v_mfma_f32_16x16x32_bf16 v[148:151], a[76:79], a[28:31], v[148:151]
    s_add_u32 m0, s45, 0
    v_mfma_f32_16x16x32_bf16 v[216:219], a[80:83], a[0:3], v[216:219]
    v_mfma_f32_16x16x32_bf16 v[220:223], a[80:83], a[4:7], v[220:223]
    ds_read_b128 a[56:59], v1 offset:43008
    v_mfma_f32_16x16x32_bf16 v[224:227], a[80:83], a[8:11], v[224:227]
    ds_read_b128 a[60:63], v1 offset:44032
    v_mfma_f32_16x16x32_bf16 v[228:231], a[80:83], a[12:15], v[228:231]
    v_mfma_f32_16x16x32_bf16 v[232:235], a[80:83], a[16:19], v[232:235]
    s_add_u32 s40, s40, 131072
    v_mfma_f32_16x16x32_bf16 v[236:239], a[80:83], a[20:23], v[236:239]
    ds_read_b64_tr_b16 a[112:113], v7 offset:37888
    v_mfma_f32_16x16x32_bf16 v[240:243], a[80:83], a[24:27], v[240:243]
    v_mfma_f32_16x16x32_bf16 v[244:247], a[80:83], a[28:31], v[244:247]
    ds_read_b64_tr_b16 a[114:115], v7 offset:38400
    v_mfma_f32_16x16x32_bf16 v[248:251], a[84:87], a[0:3], v[248:251]
    buffer_load_dwordx4 v16, s[12:15], s41 offen lds
    v_mfma_f32_16x16x32_bf16 v[252:255], a[84:87], a[4:7], v[252:255]
    v_mfma_f32_16x16x32_bf16 a[144:147], a[84:87], a[8:11], a[144:147]
    ds_read_b64_tr_b16 a[116:117], v8 offset:37888
    v_mfma_f32_16x16x32_bf16 a[148:151], a[84:87], a[12:15], a[148:151]
    buffer_load_dwordx4 v17, s[16:19], s42 offen offset:1024 lds
    v_mfma_f32_16x16x32_bf16 a[152:155], a[84:87], a[16:19], a[152:155]
    v_mfma_f32_16x16x32_bf16 a[156:159], a[84:87], a[20:23], a[156:159]
    ds_read_b64_tr_b16 a[118:119], v8 offset:38400
    v_mfma_f32_16x16x32_bf16 a[160:163], a[84:87], a[24:27], a[160:163]
    ds_read_b64_tr_b16 a[120:121], v9 offset:37888
    v_mfma_f32_16x16x32_bf16 a[164:167], a[84:87], a[28:31], a[164:167]
    v_mfma_f32_16x16x32_bf16 v[152:155], a[88:91], a[0:3], v[152:155]
    buffer_load_dwordx4 v17, s[20:23], s42 offen offset:2048 lds
    v_mfma_f32_16x16x32_bf16 v[156:159], a[88:91], a[4:7], v[156:159]
    ds_read_b64_tr_b16 a[122:123], v9 offset:38400
    v_mfma_f32_16x16x32_bf16 v[160:163], a[88:91], a[8:11], v[160:163]
    v_mfma_f32_16x16x32_bf16 v[164:167], a[88:91], a[12:15], v[164:167]
    ds_read_b64_tr_b16 a[124:125], v10 offset:37888
    v_mfma_f32_16x16x32_bf16 v[168:171], a[88:91], a[16:19], v[168:171]
    buffer_load_dwordx4 v17, s[24:27], s42 offen offset:3072 lds
    v_mfma_f32_16x16x32_bf16 v[172:175], a[88:91], a[20:23], v[172:175]
    ds_read_b64_tr_b16 a[126:127], v10 offset:38400
    v_mfma_f32_16x16x32_bf16 v[176:179], a[88:91], a[24:27], v[176:179]
    v_mfma_f32_16x16x32_bf16 v[180:183], a[88:91], a[28:31], v[180:183]
    ds_read_b64_tr_b16 a[128:129], v7 offset:38912
    v_mfma_f32_16x16x32_bf16 v[184:187], a[92:95], a[0:3], v[184:187]
    s_add_u32 m0, s45, 4096
    v_mfma_f32_16x16x32_bf16 v[188:191], a[92:95], a[4:7], v[188:191]
    v_mfma_f32_16x16x32_bf16 v[192:195], a[92:95], a[8:11], v[192:195]
    ds_read_b64_tr_b16 a[130:131], v7 offset:39424
    v_mfma_f32_16x16x32_bf16 v[196:199], a[92:95], a[12:15], v[196:199]
    ds_read_b64_tr_b16 a[132:133], v8 offset:38912
    v_mfma_f32_16x16x32_bf16 v[200:203], a[92:95], a[16:19], v[200:203]
    v_mfma_f32_16x16x32_bf16 v[204:207], a[92:95], a[20:23], v[204:207]
    s_add_u32 s41, s41, 196608
    v_mfma_f32_16x16x32_bf16 v[208:211], a[92:95], a[24:27], v[208:211]
    ds_read_b64_tr_b16 a[134:135], v8 offset:39424
    v_mfma_f32_16x16x32_bf16 v[212:215], a[92:95], a[28:31], v[212:215]
    v_mfma_f32_16x16x32_bf16 a[168:171], a[96:99], a[0:3], a[168:171]
    ds_read_b64_tr_b16 a[136:137], v9 offset:38912
    v_mfma_f32_16x16x32_bf16 a[172:175], a[96:99], a[4:7], a[172:175]
    buffer_load_dwordx4 v17, s[28:31], s42 offen lds
    v_mfma_f32_16x16x32_bf16 a[176:179], a[96:99], a[8:11], a[176:179]
    v_mfma_f32_16x16x32_bf16 a[180:183], a[96:99], a[12:15], a[180:183]
    ds_read_b64_tr_b16 a[138:139], v9 offset:39424
    v_mfma_f32_16x16x32_bf16 a[184:187], a[96:99], a[16:19], a[184:187]
    ds_read_b64_tr_b16 a[140:141], v10 offset:38912
    v_mfma_f32_16x16x32_bf16 a[188:191], a[96:99], a[20:23], a[188:191]
    v_mfma_f32_16x16x32_bf16 a[192:195], a[96:99], a[24:27], a[192:195]
    s_add_u32 s42, s42, 229376
    v_mfma_f32_16x16x32_bf16 a[196:199], a[96:99], a[28:31], a[196:199]
    ds_read_b64_tr_b16 a[142:143], v10 offset:39424
    v_mfma_f32_16x16x32_bf16 a[200:203], a[100:103], a[0:3], a[200:203]
    v_mfma_f32_16x16x32_bf16 a[204:207], a[100:103], a[4:7], a[204:207]
    v_mfma_f32_16x16x32_bf16 a[208:211], a[100:103], a[8:11], a[208:211]
    v_mfma_f32_16x16x32_bf16 a[212:215], a[100:103], a[12:15], a[212:215]
    v_mfma_f32_16x16x32_bf16 a[216:219], a[100:103], a[16:19], a[216:219]
    v_mfma_f32_16x16x32_bf16 a[220:223], a[100:103], a[20:23], a[220:223]
    v_mfma_f32_16x16x32_bf16 a[224:227], a[100:103], a[24:27], a[224:227]
    v_mfma_f32_16x16x32_bf16 a[228:231], a[100:103], a[28:31], a[228:231]
    s_waitcnt lgkmcnt(0)
    v_mfma_f32_16x16x32_bf16 v[24:27], a[104:107], a[32:35], v[24:27]
    v_mfma_f32_16x16x32_bf16 v[28:31], a[104:107], a[36:39], v[28:31]
    v_mfma_f32_16x16x32_bf16 v[32:35], a[104:107], a[40:43], v[32:35]
    v_mfma_f32_16x16x32_bf16 v[36:39], a[104:107], a[44:47], v[36:39]
    v_mfma_f32_16x16x32_bf16 v[40:43], a[104:107], a[48:51], v[40:43]
    v_mfma_f32_16x16x32_bf16 v[44:47], a[104:107], a[52:55], v[44:47]
    v_mfma_f32_16x16x32_bf16 v[48:51], a[104:107], a[56:59], v[48:51]
    v_mfma_f32_16x16x32_bf16 v[52:55], a[104:107], a[60:63], v[52:55]
    v_mfma_f32_16x16x32_bf16 v[56:59], a[108:111], a[32:35], v[56:59]
    s_waitcnt vmcnt(18)
    v_mfma_f32_16x16x32_bf16 v[60:63], a[108:111], a[36:39], v[60:63]
    s_barrier
    v_mfma_f32_16x16x32_bf16 v[64:67], a[108:111], a[40:43], v[64:67]
    s_add_u32 m0, s44, 36864
    v_mfma_f32_16x16x32_bf16 v[68:71], a[108:111], a[44:47], v[68:71]
    ds_read_b64_tr_b16 a[64:65], v5 offset:0
    v_mfma_f32_16x16x32_bf16 v[72:75], a[108:111], a[48:51], v[72:75]
    ds_read_b64_tr_b16 a[66:67], v5 offset:512
    v_mfma_f32_16x16x32_bf16 v[76:79], a[108:111], a[52:55], v[76:79]
    v_mfma_f32_16x16x32_bf16 v[80:83], a[108:111], a[56:59], v[80:83]
    buffer_load_dwordx4 v15, s[8:11], s40 offen offset:0 lds
    v_mfma_f32_16x16x32_bf16 v[84:87], a[108:111], a[60:63], v[84:87]
    ds_read_b128 a[0:3], v2 offset:0
    v_mfma_f32_16x16x32_bf16 v[88:91], a[112:115], a[32:35], v[88:91]
    v_mfma_f32_16x16x32_bf16 v[92:95], a[112:115], a[36:39], v[92:95]
    ds_read_b128 a[4:7], v2 offset:1024
    v_mfma_f32_16x16x32_bf16 v[96:99], a[112:115], a[40:43], v[96:99]
    buffer_load_dwordx4 v15, s[8:11], s40 offen offset:1024 lds
    v_mfma_f32_16x16x32_bf16 v[100:103], a[112:115], a[44:47], v[100:103]
    v_mfma_f32_16x16x32_bf16 v[104:107], a[112:115], a[48:51], v[104:107]
    ds_read_b128 a[8:11], v2 offset:2048
    v_mfma_f32_16x16x32_bf16 v[108:111], a[112:115], a[52:55], v[108:111]
    ds_read_b128 a[12:15], v2 offset:3072
    v_mfma_f32_16x16x32_bf16 v[112:115], a[112:115], a[56:59], v[112:115]
    v_mfma_f32_16x16x32_bf16 v[116:119], a[112:115], a[60:63], v[116:119]
    buffer_load_dwordx4 v15, s[8:11], s40 offen offset:2048 lds
    v_mfma_f32_16x16x32_bf16 v[120:123], a[116:119], a[32:35], v[120:123]
    ds_read_b64_tr_b16 a[68:69], v6 offset:0
    v_mfma_f32_16x16x32_bf16 v[124:127], a[116:119], a[36:39], v[124:127]
    v_mfma_f32_16x16x32_bf16 v[128:131], a[116:119], a[40:43], v[128:131]
    ds_read_b64_tr_b16 a[70:71], v6 offset:512
    v_mfma_f32_16x16x32_bf16 v[132:135], a[116:119], a[44:47], v[132:135]
    buffer_load_dwordx4 v15, s[8:11], s40 offen offset:3072 lds
    v_mfma_f32_16x16x32_bf16 v[136:139], a[116:119], a[48:51], v[136:139]
    v_mfma_f32_16x16x32_bf16 v[140:143], a[116:119], a[52:55], v[140:143]
    ds_read_b128 a[16:19], v2 offset:4096
    v_mfma_f32_16x16x32_bf16 v[144:147], a[116:119], a[56:59], v[144:147]
    ds_read_b128 a[20:23], v2 offset:5120
    v_mfma_f32_16x16x32_bf16 v[148:151], a[116:119], a[60:63], v[148:151]
    s_add_u32 m0, s45, 36864
    v_mfma_f32_16x16x32_bf16 v[216:219], a[120:123], a[32:35], v[216:219]
    v_mfma_f32_16x16x32_bf16 v[220:223], a[120:123], a[36:39], v[220:223]
    ds_read_b128 a[24:27], v2 offset:6144
    v_mfma_f32_16x16x32_bf16 v[224:227], a[120:123], a[40:43], v[224:227]
    ds_read_b128 a[28:31], v2 offset:7168
    v_mfma_f32_16x16x32_bf16 v[228:231], a[120:123], a[44:47], v[228:231]
    v_mfma_f32_16x16x32_bf16 v[232:235], a[120:123], a[48:51], v[232:235]
    s_add_u32 s40, s40, 131072
    v_mfma_f32_16x16x32_bf16 v[236:239], a[120:123], a[52:55], v[236:239]
    ds_read_b64_tr_b16 a[72:73], v11 offset:1024
    v_mfma_f32_16x16x32_bf16 v[240:243], a[120:123], a[56:59], v[240:243]
    v_mfma_f32_16x16x32_bf16 v[244:247], a[120:123], a[60:63], v[244:247]
    ds_read_b64_tr_b16 a[74:75], v11 offset:1536
    v_mfma_f32_16x16x32_bf16 v[248:251], a[124:127], a[32:35], v[248:251]
    buffer_load_dwordx4 v16, s[12:15], s41 offen lds
    v_mfma_f32_16x16x32_bf16 v[252:255], a[124:127], a[36:39], v[252:255]
    v_mfma_f32_16x16x32_bf16 a[144:147], a[124:127], a[40:43], a[144:147]
    ds_read_b64_tr_b16 a[76:77], v12 offset:1024
    v_mfma_f32_16x16x32_bf16 a[148:151], a[124:127], a[44:47], a[148:151]
    buffer_load_dwordx4 v17, s[16:19], s42 offen offset:1024 lds
    v_mfma_f32_16x16x32_bf16 a[152:155], a[124:127], a[48:51], a[152:155]
    v_mfma_f32_16x16x32_bf16 a[156:159], a[124:127], a[52:55], a[156:159]
    ds_read_b64_tr_b16 a[78:79], v12 offset:1536
    v_mfma_f32_16x16x32_bf16 a[160:163], a[124:127], a[56:59], a[160:163]
    ds_read_b64_tr_b16 a[80:81], v13 offset:1024
    v_mfma_f32_16x16x32_bf16 a[164:167], a[124:127], a[60:63], a[164:167]
    v_mfma_f32_16x16x32_bf16 v[152:155], a[128:131], a[32:35], v[152:155]
    buffer_load_dwordx4 v17, s[20:23], s42 offen offset:2048 lds
    v_mfma_f32_16x16x32_bf16 v[156:159], a[128:131], a[36:39], v[156:159]
    ds_read_b64_tr_b16 a[82:83], v13 offset:1536
    v_mfma_f32_16x16x32_bf16 v[160:163], a[128:131], a[40:43], v[160:163]
    v_mfma_f32_16x16x32_bf16 v[164:167], a[128:131], a[44:47], v[164:167]
    ds_read_b64_tr_b16 a[84:85], v14 offset:1024
    v_mfma_f32_16x16x32_bf16 v[168:171], a[128:131], a[48:51], v[168:171]
    buffer_load_dwordx4 v17, s[24:27], s42 offen offset:3072 lds
    v_mfma_f32_16x16x32_bf16 v[172:175], a[128:131], a[52:55], v[172:175]
    ds_read_b64_tr_b16 a[86:87], v14 offset:1536
    v_mfma_f32_16x16x32_bf16 v[176:179], a[128:131], a[56:59], v[176:179]
    v_mfma_f32_16x16x32_bf16 v[180:183], a[128:131], a[60:63], v[180:183]
    ds_read_b64_tr_b16 a[88:89], v11 offset:2048
    v_mfma_f32_16x16x32_bf16 v[184:187], a[132:135], a[32:35], v[184:187]
    s_add_u32 m0, s45, 40960
    v_mfma_f32_16x16x32_bf16 v[188:191], a[132:135], a[36:39], v[188:191]
    v_mfma_f32_16x16x32_bf16 v[192:195], a[132:135], a[40:43], v[192:195]
    ds_read_b64_tr_b16 a[90:91], v11 offset:2560
    v_mfma_f32_16x16x32_bf16 v[196:199], a[132:135], a[44:47], v[196:199]
    ds_read_b64_tr_b16 a[92:93], v12 offset:2048
    v_mfma_f32_16x16x32_bf16 v[200:203], a[132:135], a[48:51], v[200:203]
    v_mfma_f32_16x16x32_bf16 v[204:207], a[132:135], a[52:55], v[204:207]
    s_add_u32 s41, s41, 196608
    v_mfma_f32_16x16x32_bf16 v[208:211], a[132:135], a[56:59], v[208:211]
    ds_read_b64_tr_b16 a[94:95], v12 offset:2560
    v_mfma_f32_16x16x32_bf16 v[212:215], a[132:135], a[60:63], v[212:215]
    v_mfma_f32_16x16x32_bf16 a[168:171], a[136:139], a[32:35], a[168:171]
    ds_read_b64_tr_b16 a[96:97], v13 offset:2048
    v_mfma_f32_16x16x32_bf16 a[172:175], a[136:139], a[36:39], a[172:175]
    buffer_load_dwordx4 v17, s[28:31], s42 offen lds
    v_mfma_f32_16x16x32_bf16 a[176:179], a[136:139], a[40:43], a[176:179]
    v_mfma_f32_16x16x32_bf16 a[180:183], a[136:139], a[44:47], a[180:183]
    ds_read_b64_tr_b16 a[98:99], v13 offset:2560
    v_mfma_f32_16x16x32_bf16 a[184:187], a[136:139], a[48:51], a[184:187]
    ds_read_b64_tr_b16 a[100:101], v14 offset:2048
    v_mfma_f32_16x16x32_bf16 a[188:191], a[136:139], a[52:55], a[188:191]
    v_mfma_f32_16x16x32_bf16 a[192:195], a[136:139], a[56:59], a[192:195]
    s_add_u32 s42, s42, 229376
    v_mfma_f32_16x16x32_bf16 a[196:199], a[136:139], a[60:63], a[196:199]
    ds_read_b64_tr_b16 a[102:103], v14 offset:2560
    v_mfma_f32_16x16x32_bf16 a[200:203], a[140:143], a[32:35], a[200:203]
    v_mfma_f32_16x16x32_bf16 a[204:207], a[140:143], a[36:39], a[204:207]
    v_mfma_f32_16x16x32_bf16 a[208:211], a[140:143], a[40:43], a[208:211]
    v_mfma_f32_16x16x32_bf16 a[212:215], a[140:143], a[44:47], a[212:215]
    v_mfma_f32_16x16x32_bf16 a[216:219], a[140:143], a[48:51], a[216:219]
    v_mfma_f32_16x16x32_bf16 a[220:223], a[140:143], a[52:55], a[220:223]
    v_mfma_f32_16x16x32_bf16 a[224:227], a[140:143], a[56:59], a[224:227]
    v_mfma_f32_16x16x32_bf16 a[228:231], a[140:143], a[60:63], a[228:231]
    s_branch L_gemm1_kernel_midA
L_gemm1_kernel_loopA:
    s_waitcnt lgkmcnt(0)
    v_mfma_f32_16x16x32_bf16 v[24:27], a[64:67], a[0:3], v[24:27]
    v_mfma_f32_16x16x32_bf16 v[28:31], a[64:67], a[4:7], v[28:31]
    v_mfma_f32_16x16x32_bf16 v[32:35], a[64:67], a[8:11], v[32:35]
    v_mfma_f32_16x16x32_bf16 v[36:39], a[64:67], a[12:15], v[36:39]
    v_mfma_f32_16x16x32_bf16 v[40:43], a[64:67], a[16:19], v[40:43]
    v_mfma_f32_16x16x32_bf16 v[44:47], a[64:67], a[20:23], v[44:47]
    v_mfma_f32_16x16x32_bf16 v[48:51], a[64:67], a[24:27], v[48:51]
    v_mfma_f32_16x16x32_bf16 v[52:55], a[64:67], a[28:31], v[52:55]
    v_mfma_f32_16x16x32_bf16 v[56:59], a[68:71], a[0:3], v[56:59]
    s_waitcnt vmcnt(18)
    v_mfma_f32_16x16x32_bf16 v[60:63], a[68:71], a[4:7], v[60:63]
    s_barrier
    v_mfma_f32_16x16x32_bf16 v[64:67], a[68:71], a[8:11], v[64:67]
    s_add_u32 m0, s44, 0
    v_mfma_f32_16x16x32_bf16 v[68:71], a[68:71], a[12:15], v[68:71]
    ds_read_b64_tr_b16 a[104:105], v3 offset:36864
    v_mfma_f32_16x16x32_bf16 v[72:75], a[68:71], a[16:19], v[72:75]
    ds_read_b64_tr_b16 a[106:107], v3 offset:37376
    v_mfma_f32_16x16x32_bf16 v[76:79], a[68:71], a[20:23], v[76:79]
    v_mfma_f32_16x16x32_bf16 v[80:83], a[68:71], a[24:27], v[80:83]
    buffer_load_dwordx4 v15, s[8:11], s40 offen offset:0 lds
    v_mfma_f32_16x16x32_bf16 v[84:87], a[68:71], a[28:31], v[84:87]
    ds_read_b128 a[32:35], v1 offset:36864
    v_mfma_f32_16x16x32_bf16 v[88:91], a[72:75], a[0:3], v[88:91]
    v_mfma_f32_16x16x32_bf16 v[92:95], a[72:75], a[4:7], v[92:95]
    ds_read_b128 a[36:39], v1 offset:37888
    v_mfma_f32_16x16x32_bf16 v[96:99], a[72:75], a[8:11], v[96:99]
    buffer_load_dwordx4 v15, s[8:11], s40 offen offset:1024 lds
    v_mfma_f32_16x16x32_bf16 v[100:103], a[72:75], a[12:15], v[100:103]
    v_mfma_f32_16x16x32_bf16 v[104:107], a[72:75], a[16:19], v[104:107]
    ds_read_b128 a[40:43], v1 offset:38912
    v_mfma_f32_16x16x32_bf16 v[108:111], a[72:75], a[20:23], v[108:111]
    ds_read_b128 a[44:47], v1 offset:39936
    v_mfma_f32_16x16x32_bf16 v[112:115], a[72:75], a[24:27], v[112:115]
    v_mfma_f32_16x16x32_bf16 v[116:119], a[72:75], a[28:31], v[116:119]
    buffer_load_dwordx4 v15, s[8:11], s40 offen offset:2048 lds
    v_mfma_f32_16x16x32_bf16 v[120:123], a[76:79], a[0:3], v[120:123]
    ds_read_b64_tr_b16 a[108:109], v4 offset:36864
    v_mfma_f32_16x16x32_bf16 v[124:127], a[76:79], a[4:7], v[124:127]
    v_mfma_f32_16x16x32_bf16 v[128:131], a[76:79], a[8:11], v[128:131]
    ds_read_b64_tr_b16 a[110:111], v4 offset:37376
    v_mfma_f32_16x16x32_bf16 v[132:135], a[76:79], a[12:15], v[132:135]
    buffer_load_dwordx4 v15, s[8:11], s40 offen offset:3072 lds
    v_mfma_f32_16x16x32_bf16 v[136:139], a[76:79], a[16:19], v[136:139]
    v_mfma_f32_16x16x32_bf16 v[140:143], a[76:79], a[20:23], v[140:143]
    ds_read_b128 a[48:51], v1 offset:40960
    v_mfma_f32_16x16x32_bf16 v[144:147], a[76:79], a[24:27], v[144:147]
    ds_read_b128 a[52:55], v1 offset:41984
    v_mfma_f32_16x16x32_bf16 v[148:151], a[76:79], a[28:31], v[148:151]
    s_add_u32 m0, s45, 0
    v_mfma_f32_16x16x32_bf16 v[216:219], a[80:83], a[0:3], v[216:219]
    v_mfma_f32_16x16x32_bf16 v[220:223], a[80:83], a[4:7], v[220:223]
    ds_read_b128 a[56:59], v1 offset:43008
    v_mfma_f32_16x16x32_bf16 v[224:227], a[80:83], a[8:11], v[224:227]
    ds_read_b128 a[60:63], v1 offset:44032
    v_mfma_f32_16x16x32_bf16 v[228:231], a[80:83], a[12:15], v[228:231]
    v_mfma_f32_16x16x32_bf16 v[232:235], a[80:83], a[16:19], v[232:235]
    s_add_u32 s40, s40, 131072
    v_mfma_f32_16x16x32_bf16 v[236:239], a[80:83], a[20:23], v[236:239]
    ds_read_b64_tr_b16 a[112:113], v7 offset:37888
    v_mfma_f32_16x16x32_bf16 v[240:243], a[80:83], a[24:27], v[240:243]
    v_mfma_f32_16x16x32_bf16 v[244:247], a[80:83], a[28:31], v[244:247]
    ds_read_b64_tr_b16 a[114:115], v7 offset:38400
    v_mfma_f32_16x16x32_bf16 v[248:251], a[84:87], a[0:3], v[248:251]
    buffer_load_dwordx4 v16, s[12:15], s41 offen lds
    v_mfma_f32_16x16x32_bf16 v[252:255], a[84:87], a[4:7], v[252:255]
    v_mfma_f32_16x16x32_bf16 a[144:147], a[84:87], a[8:11], a[144:147]
    ds_read_b64_tr_b16 a[116:117], v8 offset:37888
    v_mfma_f32_16x16x32_bf16 a[148:151], a[84:87], a[12:15], a[148:151]
    buffer_load_dwordx4 v17, s[16:19], s42 offen offset:1024 lds
    v_mfma_f32_16x16x32_bf16 a[152:155], a[84:87], a[16:19], a[152:155]
    v_mfma_f32_16x16x32_bf16 a[156:159], a[84:87], a[20:23], a[156:159]
    ds_read_b64_tr_b16 a[118:119], v8 offset:38400
    v_mfma_f32_16x16x32_bf16 a[160:163], a[84:87], a[24:27], a[160:163]
    ds_read_b64_tr_b16 a[120:121], v9 offset:37888
    v_mfma_f32_16x16x32_bf16 a[164:167], a[84:87], a[28:31], a[164:167]
    v_mfma_f32_16x16x32_bf16 v[152:155], a[88:91], a[0:3], v[152:155]
    buffer_load_dwordx4 v17, s[20:23], s42 offen offset:2048 lds
    v_mfma_f32_16x16x32_bf16 v[156:159], a[88:91], a[4:7], v[156:159]
    ds_read_b64_tr_b16 a[122:123], v9 offset:38400
    v_mfma_f32_16x16x32_bf16 v[160:163], a[88:91], a[8:11], v[160:163]
    v_mfma_f32_16x16x32_bf16 v[164:167], a[88:91], a[12:15], v[164:167]
    ds_read_b64_tr_b16 a[124:125], v10 offset:37888
    v_mfma_f32_16x16x32_bf16 v[168:171], a[88:91], a[16:19], v[168:171]
    buffer_load_dwordx4 v17, s[24:27], s42 offen offset:3072 lds
    v_mfma_f32_16x16x32_bf16 v[172:175], a[88:91], a[20:23], v[172:175]
    ds_read_b64_tr_b16 a[126:127], v10 offset:38400
    v_mfma_f32_16x16x32_bf16 v[176:179], a[88:91], a[24:27], v[176:179]
    v_mfma_f32_16x16x32_bf16 v[180:183], a[88:91], a[28:31], v[180:183]
    ds_read_b64_tr_b16 a[128:129], v7 offset:38912
    v_mfma_f32_16x16x32_bf16 v[184:187], a[92:95], a[0:3], v[184:187]
    s_add_u32 m0, s45, 4096
    v_mfma_f32_16x16x32_bf16 v[188:191], a[92:95], a[4:7], v[188:191]
    v_mfma_f32_16x16x32_bf16 v[192:195], a[92:95], a[8:11], v[192:195]
    ds_read_b64_tr_b16 a[130:131], v7 offset:39424
    v_mfma_f32_16x16x32_bf16 v[196:199], a[92:95], a[12:15], v[196:199]
    ds_read_b64_tr_b16 a[132:133], v8 offset:38912
    v_mfma_f32_16x16x32_bf16 v[200:203], a[92:95], a[16:19], v[200:203]
    v_mfma_f32_16x16x32_bf16 v[204:207], a[92:95], a[20:23], v[204:207]
    s_add_u32 s41, s41, 196608
    v_mfma_f32_16x16x32_bf16 v[208:211], a[92:95], a[24:27], v[208:211]
    ds_read_b64_tr_b16 a[134:135], v8 offset:39424
    v_mfma_f32_16x16x32_bf16 v[212:215], a[92:95], a[28:31], v[212:215]
    v_mfma_f32_16x16x32_bf16 a[168:171], a[96:99], a[0:3], a[168:171]
    ds_read_b64_tr_b16 a[136:137], v9 offset:38912
    v_mfma_f32_16x16x32_bf16 a[172:175], a[96:99], a[4:7], a[172:175]
    buffer_load_dwordx4 v17, s[28:31], s42 offen lds
    v_mfma_f32_16x16x32_bf16 a[176:179], a[96:99], a[8:11], a[176:179]
    v_mfma_f32_16x16x32_bf16 a[180:183], a[96:99], a[12:15], a[180:183]
    ds_read_b64_tr_b16 a[138:139], v9 offset:39424
    v_mfma_f32_16x16x32_bf16 a[184:187], a[96:99], a[16:19], a[184:187]
    ds_read_b64_tr_b16 a[140:141], v10 offset:38912
    v_mfma_f32_16x16x32_bf16 a[188:191], a[96:99], a[20:23], a[188:191]
    v_mfma_f32_16x16x32_bf16 a[192:195], a[96:99], a[24:27], a[192:195]
    s_add_u32 s42, s42, 229376
    v_mfma_f32_16x16x32_bf16 a[196:199], a[96:99], a[28:31], a[196:199]
    ds_read_b64_tr_b16 a[142:143], v10 offset:39424
    v_mfma_f32_16x16x32_bf16 a[200:203], a[100:103], a[0:3], a[200:203]
    v_mfma_f32_16x16x32_bf16 a[204:207], a[100:103], a[4:7], a[204:207]
    v_mfma_f32_16x16x32_bf16 a[208:211], a[100:103], a[8:11], a[208:211]
    v_mfma_f32_16x16x32_bf16 a[212:215], a[100:103], a[12:15], a[212:215]
    v_mfma_f32_16x16x32_bf16 a[216:219], a[100:103], a[16:19], a[216:219]
    v_mfma_f32_16x16x32_bf16 a[220:223], a[100:103], a[20:23], a[220:223]
    v_mfma_f32_16x16x32_bf16 a[224:227], a[100:103], a[24:27], a[224:227]
    v_mfma_f32_16x16x32_bf16 a[228:231], a[100:103], a[28:31], a[228:231]
    s_waitcnt lgkmcnt(0)
    v_mfma_f32_16x16x32_bf16 v[24:27], a[104:107], a[32:35], v[24:27]
    v_mfma_f32_16x16x32_bf16 v[28:31], a[104:107], a[36:39], v[28:31]
    v_mfma_f32_16x16x32_bf16 v[32:35], a[104:107], a[40:43], v[32:35]
    v_mfma_f32_16x16x32_bf16 v[36:39], a[104:107], a[44:47], v[36:39]
    v_mfma_f32_16x16x32_bf16 v[40:43], a[104:107], a[48:51], v[40:43]
    v_mfma_f32_16x16x32_bf16 v[44:47], a[104:107], a[52:55], v[44:47]
    v_mfma_f32_16x16x32_bf16 v[48:51], a[104:107], a[56:59], v[48:51]
    v_mfma_f32_16x16x32_bf16 v[52:55], a[104:107], a[60:63], v[52:55]
    v_mfma_f32_16x16x32_bf16 v[56:59], a[108:111], a[32:35], v[56:59]
    s_waitcnt vmcnt(18)
    v_mfma_f32_16x16x32_bf16 v[60:63], a[108:111], a[36:39], v[60:63]
    s_barrier
    v_mfma_f32_16x16x32_bf16 v[64:67], a[108:111], a[40:43], v[64:67]
    s_add_u32 m0, s44, 36864
    v_mfma_f32_16x16x32_bf16 v[68:71], a[108:111], a[44:47], v[68:71]
    ds_read_b64_tr_b16 a[64:65], v5 offset:0
    v_mfma_f32_16x16x32_bf16 v[72:75], a[108:111], a[48:51], v[72:75]
    ds_read_b64_tr_b16 a[66:67], v5 offset:512
    v_mfma_f32_16x16x32_bf16 v[76:79], a[108:111], a[52:55], v[76:79]
    v_mfma_f32_16x16x32_bf16 v[80:83], a[108:111], a[56:59], v[80:83]
    buffer_load_dwordx4 v15, s[8:11], s40 offen offset:0 lds
    v_mfma_f32_16x16x32_bf16 v[84:87], a[108:111], a[60:63], v[84:87]
    ds_read_b128 a[0:3], v2 offset:0
    v_mfma_f32_16x16x32_bf16 v[88:91], a[112:115], a[32:35], v[88:91]
    v_mfma_f32_16x16x32_bf16 v[92:95], a[112:115], a[36:39], v[92:95]
    ds_read_b128 a[4:7], v2 offset:1024
    v_mfma_f32_16x16x32_bf16 v[96:99], a[112:115], a[40:43], v[96:99]
    buffer_load_dwordx4 v15, s[8:11], s40 offen offset:1024 lds
    v_mfma_f32_16x16x32_bf16 v[100:103], a[112:115], a[44:47], v[100:103]
    v_mfma_f32_16x16x32_bf16 v[104:107], a[112:115], a[48:51], v[104:107]
    ds_read_b128 a[8:11], v2 offset:2048
    v_mfma_f32_16x16x32_bf16 v[108:111], a[112:115], a[52:55], v[108:111]
    ds_read_b128 a[12:15], v2 offset:3072
    v_mfma_f32_16x16x32_bf16 v[112:115], a[112:115], a[56:59], v[112:115]
    v_mfma_f32_16x16x32_bf16 v[116:119], a[112:115], a[60:63], v[116:119]
    buffer_load_dwordx4 v15, s[8:11], s40 offen offset:2048 lds
    v_mfma_f32_16x16x32_bf16 v[120:123], a[116:119], a[32:35], v[120:123]
    ds_read_b64_tr_b16 a[68:69], v6 offset:0
    v_mfma_f32_16x16x32_bf16 v[124:127], a[116:119], a[36:39], v[124:127]
    v_mfma_f32_16x16x32_bf16 v[128:131], a[116:119], a[40:43], v[128:131]
    ds_read_b64_tr_b16 a[70:71], v6 offset:512
    v_mfma_f32_16x16x32_bf16 v[132:135], a[116:119], a[44:47], v[132:135]
    buffer_load_dwordx4 v15, s[8:11], s40 offen offset:3072 lds
    v_mfma_f32_16x16x32_bf16 v[136:139], a[116:119], a[48:51], v[136:139]
    v_mfma_f32_16x16x32_bf16 v[140:143], a[116:119], a[52:55], v[140:143]
    ds_read_b128 a[16:19], v2 offset:4096
    v_mfma_f32_16x16x32_bf16 v[144:147], a[116:119], a[56:59], v[144:147]
    ds_read_b128 a[20:23], v2 offset:5120
    v_mfma_f32_16x16x32_bf16 v[148:151], a[116:119], a[60:63], v[148:151]
    s_add_u32 m0, s45, 36864
    v_mfma_f32_16x16x32_bf16 v[216:219], a[120:123], a[32:35], v[216:219]
    v_mfma_f32_16x16x32_bf16 v[220:223], a[120:123], a[36:39], v[220:223]
    ds_read_b128 a[24:27], v2 offset:6144
    v_mfma_f32_16x16x32_bf16 v[224:227], a[120:123], a[40:43], v[224:227]
    ds_read_b128 a[28:31], v2 offset:7168
    v_mfma_f32_16x16x32_bf16 v[228:231], a[120:123], a[44:47], v[228:231]
    v_mfma_f32_16x16x32_bf16 v[232:235], a[120:123], a[48:51], v[232:235]
    s_add_u32 s40, s40, 131072
    v_mfma_f32_16x16x32_bf16 v[236:239], a[120:123], a[52:55], v[236:239]
    ds_read_b64_tr_b16 a[72:73], v11 offset:1024
    v_mfma_f32_16x16x32_bf16 v[240:243], a[120:123], a[56:59], v[240:243]
    v_mfma_f32_16x16x32_bf16 v[244:247], a[120:123], a[60:63], v[244:247]
    ds_read_b64_tr_b16 a[74:75], v11 offset:1536
    v_mfma_f32_16x16x32_bf16 v[248:251], a[124:127], a[32:35], v[248:251]
    buffer_load_dwordx4 v16, s[12:15], s41 offen lds
    v_mfma_f32_16x16x32_bf16 v[252:255], a[124:127], a[36:39], v[252:255]
    v_mfma_f32_16x16x32_bf16 a[144:147], a[124:127], a[40:43], a[144:147]
    ds_read_b64_tr_b16 a[76:77], v12 offset:1024
    v_mfma_f32_16x16x32_bf16 a[148:151], a[124:127], a[44:47], a[148:151]
    buffer_load_dwordx4 v17, s[16:19], s42 offen offset:1024 lds
    v_mfma_f32_16x16x32_bf16 a[152:155], a[124:127], a[48:51], a[152:155]
    v_mfma_f32_16x16x32_bf16 a[156:159], a[124:127], a[52:55], a[156:159]
    ds_read_b64_tr_b16 a[78:79], v12 offset:1536
    v_mfma_f32_16x16x32_bf16 a[160:163], a[124:127], a[56:59], a[160:163]
    ds_read_b64_tr_b16 a[80:81], v13 offset:1024
    v_mfma_f32_16x16x32_bf16 a[164:167], a[124:127], a[60:63], a[164:167]
    v_mfma_f32_16x16x32_bf16 v[152:155], a[128:131], a[32:35], v[152:155]
    buffer_load_dwordx4 v17, s[20:23], s42 offen offset:2048 lds
    v_mfma_f32_16x16x32_bf16 v[156:159], a[128:131], a[36:39], v[156:159]
    ds_read_b64_tr_b16 a[82:83], v13 offset:1536
    v_mfma_f32_16x16x32_bf16 v[160:163], a[128:131], a[40:43], v[160:163]
    v_mfma_f32_16x16x32_bf16 v[164:167], a[128:131], a[44:47], v[164:167]
    ds_read_b64_tr_b16 a[84:85], v14 offset:1024
    v_mfma_f32_16x16x32_bf16 v[168:171], a[128:131], a[48:51], v[168:171]
    buffer_load_dwordx4 v17, s[24:27], s42 offen offset:3072 lds
    v_mfma_f32_16x16x32_bf16 v[172:175], a[128:131], a[52:55], v[172:175]
    ds_read_b64_tr_b16 a[86:87], v14 offset:1536
    v_mfma_f32_16x16x32_bf16 v[176:179], a[128:131], a[56:59], v[176:179]
    v_mfma_f32_16x16x32_bf16 v[180:183], a[128:131], a[60:63], v[180:183]
    ds_read_b64_tr_b16 a[88:89], v11 offset:2048
    v_mfma_f32_16x16x32_bf16 v[184:187], a[132:135], a[32:35], v[184:187]
    s_add_u32 m0, s45, 40960
    v_mfma_f32_16x16x32_bf16 v[188:191], a[132:135], a[36:39], v[188:191]
    v_mfma_f32_16x16x32_bf16 v[192:195], a[132:135], a[40:43], v[192:195]
    ds_read_b64_tr_b16 a[90:91], v11 offset:2560
    v_mfma_f32_16x16x32_bf16 v[196:199], a[132:135], a[44:47], v[196:199]
    ds_read_b64_tr_b16 a[92:93], v12 offset:2048
    v_mfma_f32_16x16x32_bf16 v[200:203], a[132:135], a[48:51], v[200:203]
    v_mfma_f32_16x16x32_bf16 v[204:207], a[132:135], a[52:55], v[204:207]
    s_add_u32 s41, s41, 196608
    v_mfma_f32_16x16x32_bf16 v[208:211], a[132:135], a[56:59], v[208:211]
    ds_read_b64_tr_b16 a[94:95], v12 offset:2560
    v_mfma_f32_16x16x32_bf16 v[212:215], a[132:135], a[60:63], v[212:215]
    v_mfma_f32_16x16x32_bf16 a[168:171], a[136:139], a[32:35], a[168:171]
    ds_read_b64_tr_b16 a[96:97], v13 offset:2048
    v_mfma_f32_16x16x32_bf16 a[172:175], a[136:139], a[36:39], a[172:175]
    buffer_load_dwordx4 v17, s[28:31], s42 offen lds
    v_mfma_f32_16x16x32_bf16 a[176:179], a[136:139], a[40:43], a[176:179]
    v_mfma_f32_16x16x32_bf16 a[180:183], a[136:139], a[44:47], a[180:183]
    ds_read_b64_tr_b16 a[98:99], v13 offset:2560
    v_mfma_f32_16x16x32_bf16 a[184:187], a[136:139], a[48:51], a[184:187]
    ds_read_b64_tr_b16 a[100:101], v14 offset:2048
    v_mfma_f32_16x16x32_bf16 a[188:191], a[136:139], a[52:55], a[188:191]
    v_mfma_f32_16x16x32_bf16 a[192:195], a[136:139], a[56:59], a[192:195]
    s_add_u32 s42, s42, 229376
    v_mfma_f32_16x16x32_bf16 a[196:199], a[136:139], a[60:63], a[196:199]
    ds_read_b64_tr_b16 a[102:103], v14 offset:2560
    v_mfma_f32_16x16x32_bf16 a[200:203], a[140:143], a[32:35], a[200:203]
    v_mfma_f32_16x16x32_bf16 a[204:207], a[140:143], a[36:39], a[204:207]
    v_mfma_f32_16x16x32_bf16 a[208:211], a[140:143], a[40:43], a[208:211]
    v_mfma_f32_16x16x32_bf16 a[212:215], a[140:143], a[44:47], a[212:215]
    v_mfma_f32_16x16x32_bf16 a[216:219], a[140:143], a[48:51], a[216:219]
    v_mfma_f32_16x16x32_bf16 a[220:223], a[140:143], a[52:55], a[220:223]
    v_mfma_f32_16x16x32_bf16 a[224:227], a[140:143], a[56:59], a[224:227]
    v_mfma_f32_16x16x32_bf16 a[228:231], a[140:143], a[60:63], a[228:231]
L_gemm1_kernel_midA:
    s_waitcnt lgkmcnt(0)
    v_mfma_f32_16x16x32_bf16 v[24:27], a[64:67], a[0:3], v[24:27]
    v_mfma_f32_16x16x32_bf16 v[28:31], a[64:67], a[4:7], v[28:31]
    v_mfma_f32_16x16x32_bf16 v[32:35], a[64:67], a[8:11], v[32:35]
    v_mfma_f32_16x16x32_bf16 v[36:39], a[64:67], a[12:15], v[36:39]
    v_mfma_f32_16x16x32_bf16 v[40:43], a[64:67], a[16:19], v[40:43]
    v_mfma_f32_16x16x32_bf16 v[44:47], a[64:67], a[20:23], v[44:47]
    v_mfma_f32_16x16x32_bf16 v[48:51], a[64:67], a[24:27], v[48:51]
    v_mfma_f32_16x16x32_bf16 v[52:55], a[64:67], a[28:31], v[52:55]
    v_mfma_f32_16x16x32_bf16 v[56:59], a[68:71], a[0:3], v[56:59]
    s_waitcnt vmcnt(18)
    v_mfma_f32_16x16x32_bf16 v[60:63], a[68:71], a[4:7], v[60:63]
    s_barrier
    v_mfma_f32_16x16x32_bf16 v[64:67], a[68:71], a[8:11], v[64:67]
    s_add_u32 m0, s44, 73728
    v_mfma_f32_16x16x32_bf16 v[68:71], a[68:71], a[12:15], v[68:71]
    ds_read_b64_tr_b16 a[104:105], v5 offset:36864
    v_mfma_f32_16x16x32_bf16 v[72:75], a[68:71], a[16:19], v[72:75]
    ds_read_b64_tr_b16 a[106:107], v5 offset:37376
    v_mfma_f32_16x16x32_bf16 v[76:79], a[68:71], a[20:23], v[76:79]
    v_mfma_f32_16x16x32_bf16 v[80:83], a[68:71], a[24:27], v[80:83]
    buffer_load_dwordx4 v15, s[8:11], s40 offen offset:0 lds
    v_mfma_f32_16x16x32_bf16 v[84:87], a[68:71], a[28:31], v[84:87]
    ds_read_b128 a[32:35], v2 offset:36864
    v_mfma_f32_16x16x32_bf16 v[88:91], a[72:75], a[0:3], v[88:91]
    v_mfma_f32_16x16x32_bf16 v[92:95], a[72:75], a[4:7], v[92:95]
    ds_read_b128 a[36:39], v2 offset:37888
    v_mfma_f32_16x16x32_bf16 v[96:99], a[72:75], a[8:11], v[96:99]
    buffer_load_dwordx4 v15, s[8:11], s40 offen offset:1024 lds
    v_mfma_f32_16x16x32_bf16 v[100:103], a[72:75], a[12:15], v[100:103]
    v_mfma_f32_16x16x32_bf16 v[104:107], a[72:75], a[16:19], v[104:107]
    ds_read_b128 a[40:43], v2 offset:38912
    v_mfma_f32_16x16x32_bf16 v[108:111], a[72:75], a[20:23], v[108:111]
    ds_read_b128 a[44:47], v2 offset:39936
    v_mfma_f32_16x16x32_bf16 v[112:115], a[72:75], a[24:27], v[112:115]
    v_mfma_f32_16x16x32_bf16 v[116:119], a[72:75], a[28:31], v[116:119]
    buffer_load_dwordx4 v15, s[8:11], s40 offen offset:2048 lds
    v_mfma_f32_16x16x32_bf16 v[120:123], a[76:79], a[0:3], v[120:123]
    ds_read_b64_tr_b16 a[108:109], v6 offset:36864
    v_mfma_f32_16x16x32_bf16 v[124:127], a[76:79], a[4:7], v[124:127]
    v_mfma_f32_16x16x32_bf16 v[128:131], a[76:79], a[8:11], v[128:131]
    ds_read_b64_tr_b16 a[110:111], v6 offset:37376
    v_mfma_f32_16x16x32_bf16 v[132:135], a[76:79], a[12:15], v[132:135]
    buffer_load_dwordx4 v15, s[8:11], s40 offen offset:3072 lds
    v_mfma_f32_16x16x32_bf16 v[136:139], a[76:79], a[16:19], v[136:139]
    v_mfma_f32_16x16x32_bf16 v[140:143], a[76:79], a[20:23], v[140:143]
    ds_read_b128 a[48:51], v2 offset:40960
    v_mfma_f32_16x16x32_bf16 v[144:147], a[76:79], a[24:27], v[144:147]
    ds_read_b128 a[52:55], v2 offset:41984
    v_mfma_f32_16x16x32_bf16 v[148:151], a[76:79], a[28:31], v[148:151]
    s_add_u32 m0, s45, 73728
    v_mfma_f32_16x16x32_bf16 v[216:219], a[80:83], a[0:3], v[216:219]
    v_mfma_f32_16x16x32_bf16 v[220:223], a[80:83], a[4:7], v[220:223]
    ds_read_b128 a[56:59], v2 offset:43008
    v_mfma_f32_16x16x32_bf16 v[224:227], a[80:83], a[8:11], v[224:227]
    ds_read_b128 a[60:63], v2 offset:44032
    v_mfma_f32_16x16x32_bf16 v[228:231], a[80:83], a[12:15], v[228:231]
    v_mfma_f32_16x16x32_bf16 v[232:235], a[80:83], a[16:19], v[232:235]
    s_add_u32 s40, s40, 131072
    v_mfma_f32_16x16x32_bf16 v[236:239], a[80:83], a[20:23], v[236:239]
    ds_read_b64_tr_b16 a[112:113], v11 offset:37888
    v_mfma_f32_16x16x32_bf16 v[240:243], a[80:83], a[24:27], v[240:243]
    v_mfma_f32_16x16x32_bf16 v[244:247], a[80:83], a[28:31], v[244:247]
    ds_read_b64_tr_b16 a[114:115], v11 offset:38400
    v_mfma_f32_16x16x32_bf16 v[248:251], a[84:87], a[0:3], v[248:251]
    buffer_load_dwordx4 v16, s[12:15], s41 offen lds
    v_mfma_f32_16x16x32_bf16 v[252:255], a[84:87], a[4:7], v[252:255]
    v_mfma_f32_16x16x32_bf16 a[144:147], a[84:87], a[8:11], a[144:147]
    ds_read_b64_tr_b16 a[116:117], v12 offset:37888
    v_mfma_f32_16x16x32_bf16 a[148:151], a[84:87], a[12:15], a[148:151]
    buffer_load_dwordx4 v17, s[16:19], s42 offen offset:1024 lds
    v_mfma_f32_16x16x32_bf16 a[152:155], a[84:87], a[16:19], a[152:155]
    v_mfma_f32_16x16x32_bf16 a[156:159], a[84:87], a[20:23], a[156:159]
    ds_read_b64_tr_b16 a[118:119], v12 offset:38400
    v_mfma_f32_16x16x32_bf16 a[160:163], a[84:87], a[24:27], a[160:163]
    ds_read_b64_tr_b16 a[120:121], v13 offset:37888
    v_mfma_f32_16x16x32_bf16 a[164:167], a[84:87], a[28:31], a[164:167]
    v_mfma_f32_16x16x32_bf16 v[152:155], a[88:91], a[0:3], v[152:155]
    buffer_load_dwordx4 v17, s[20:23], s42 offen offset:2048 lds
    v_mfma_f32_16x16x32_bf16 v[156:159], a[88:91], a[4:7], v[156:159]
    ds_read_b64_tr_b16 a[122:123], v13 offset:38400
    v_mfma_f32_16x16x32_bf16 v[160:163], a[88:91], a[8:11], v[160:163]
    v_mfma_f32_16x16x32_bf16 v[164:167], a[88:91], a[12:15], v[164:167]
    ds_read_b64_tr_b16 a[124:125], v14 offset:37888
    v_mfma_f32_16x16x32_bf16 v[168:171], a[88:91], a[16:19], v[168:171]
    buffer_load_dwordx4 v17, s[24:27], s42 offen offset:3072 lds
    v_mfma_f32_16x16x32_bf16 v[172:175], a[88:91], a[20:23], v[172:175]
    ds_read_b64_tr_b16 a[126:127], v14 offset:38400
    v_mfma_f32_16x16x32_bf16 v[176:179], a[88:91], a[24:27], v[176:179]
    v_mfma_f32_16x16x32_bf16 v[180:183], a[88:91], a[28:31], v[180:183]
    ds_read_b64_tr_b16 a[128:129], v11 offset:38912
    v_mfma_f32_16x16x32_bf16 v[184:187], a[92:95], a[0:3], v[184:187]
    s_add_u32 m0, s45, 77824
    v_mfma_f32_16x16x32_bf16 v[188:191], a[92:95], a[4:7], v[188:191]
    v_mfma_f32_16x16x32_bf16 v[192:195], a[92:95], a[8:11], v[192:195]
    ds_read_b64_tr_b16 a[130:131], v11 offset:39424
    v_mfma_f32_16x16x32_bf16 v[196:199], a[92:95], a[12:15], v[196:199]
    ds_read_b64_tr_b16 a[132:133], v12 offset:38912
    v_mfma_f32_16x16x32_bf16 v[200:203], a[92:95], a[16:19], v[200:203]
    v_mfma_f32_16x16x32_bf16 v[204:207], a[92:95], a[20:23], v[204:207]
    s_add_u32 s41, s41, 196608
    v_mfma_f32_16x16x32_bf16 v[208:211], a[92:95], a[24:27], v[208:211]
    ds_read_b64_tr_b16 a[134:135], v12 offset:39424
    v_mfma_f32_16x16x32_bf16 v[212:215], a[92:95], a[28:31], v[212:215]
    v_mfma_f32_16x16x32_bf16 a[168:171], a[96:99], a[0:3], a[168:171]
    ds_read_b64_tr_b16 a[136:137], v13 offset:38912
    v_mfma_f32_16x16x32_bf16 a[172:175], a[96:99], a[4:7], a[172:175]
    buffer_load_dwordx4 v17, s[28:31], s42 offen lds
    v_mfma_f32_16x16x32_bf16 a[176:179], a[96:99], a[8:11], a[176:179]
    v_mfma_f32_16x16x32_bf16 a[180:183], a[96:99], a[12:15], a[180:183]
    ds_read_b64_tr_b16 a[138:139], v13 offset:39424
    v_mfma_f32_16x16x32_bf16 a[184:187], a[96:99], a[16:19], a[184:187]
    ds_read_b64_tr_b16 a[140:141], v14 offset:38912
    v_mfma_f32_16x16x32_bf16 a[188:191], a[96:99], a[20:23], a[188:191]
    v_mfma_f32_16x16x32_bf16 a[192:195], a[96:99], a[24:27], a[192:195]
    s_add_u32 s42, s42, 229376
    v_mfma_f32_16x16x32_bf16 a[196:199], a[96:99], a[28:31], a[196:199]
    ds_read_b64_tr_b16 a[142:143], v14 offset:39424
    v_mfma_f32_16x16x32_bf16 a[200:203], a[100:103], a[0:3], a[200:203]
    v_mfma_f32_16x16x32_bf16 a[204:207], a[100:103], a[4:7], a[204:207]
    v_mfma_f32_16x16x32_bf16 a[208:211], a[100:103], a[8:11], a[208:211]
    v_mfma_f32_16x16x32_bf16 a[212:215], a[100:103], a[12:15], a[212:215]
    v_mfma_f32_16x16x32_bf16 a[216:219], a[100:103], a[16:19], a[216:219]
    v_mfma_f32_16x16x32_bf16 a[220:223], a[100:103], a[20:23], a[220:223]
    v_mfma_f32_16x16x32_bf16 a[224:227], a[100:103], a[24:27], a[224:227]
    v_mfma_f32_16x16x32_bf16 a[228:231], a[100:103], a[28:31], a[228:231]
    s_waitcnt lgkmcnt(0)
    v_mfma_f32_16x16x32_bf16 v[24:27], a[104:107], a[32:35], v[24:27]
    v_mfma_f32_16x16x32_bf16 v[28:31], a[104:107], a[36:39], v[28:31]
    v_mfma_f32_16x16x32_bf16 v[32:35], a[104:107], a[40:43], v[32:35]
    v_mfma_f32_16x16x32_bf16 v[36:39], a[104:107], a[44:47], v[36:39]
    v_mfma_f32_16x16x32_bf16 v[40:43], a[104:107], a[48:51], v[40:43]
    v_mfma_f32_16x16x32_bf16 v[44:47], a[104:107], a[52:55], v[44:47]
    v_mfma_f32_16x16x32_bf16 v[48:51], a[104:107], a[56:59], v[48:51]
    v_mfma_f32_16x16x32_bf16 v[52:55], a[104:107], a[60:63], v[52:55]
    v_mfma_f32_16x16x32_bf16 v[56:59], a[108:111], a[32:35], v[56:59]
    s_waitcnt vmcnt(18)
    v_mfma_f32_16x16x32_bf16 v[60:63], a[108:111], a[36:39], v[60:63]
    s_barrier
    v_mfma_f32_16x16x32_bf16 v[64:67], a[108:111], a[40:43], v[64:67]
    s_add_u32 m0, s44, 110592
    v_mfma_f32_16x16x32_bf16 v[68:71], a[108:111], a[44:47], v[68:71]
    ds_read_b64_tr_b16 a[64:65], v3 offset:0
    v_mfma_f32_16x16x32_bf16 v[72:75], a[108:111], a[48:51], v[72:75]
    ds_read_b64_tr_b16 a[66:67], v3 offset:512
    v_mfma_f32_16x16x32_bf16 v[76:79], a[108:111], a[52:55], v[76:79]
    v_mfma_f32_16x16x32_bf16 v[80:83], a[108:111], a[56:59], v[80:83]
    buffer_load_dwordx4 v15, s[8:11], s40 offen offset:0 lds
    v_mfma_f32_16x16x32_bf16 v[84:87], a[108:111], a[60:63], v[84:87]
    ds_read_b128 a[0:3], v1 offset:0
    v_mfma_f32_16x16x32_bf16 v[88:91], a[112:115], a[32:35], v[88:91]
    v_mfma_f32_16x16x32_bf16 v[92:95], a[112:115], a[36:39], v[92:95]
    ds_read_b128 a[4:7], v1 offset:1024
    v_mfma_f32_16x16x32_bf16 v[96:99], a[112:115], a[40:43], v[96:99]
    buffer_load_dwordx4 v15, s[8:11], s40 offen offset:1024 lds
    v_mfma_f32_16x16x32_bf16 v[100:103], a[112:115], a[44:47], v[100:103]
    v_mfma_f32_16x16x32_bf16 v[104:107], a[112:115], a[48:51], v[104:107]
    ds_read_b128 a[8:11], v1 offset:2048
    v_mfma_f32_16x16x32_bf16 v[108:111], a[112:115], a[52:55], v[108:111]
    ds_read_b128 a[12:15], v1 offset:3072
    v_mfma_f32_16x16x32_bf16 v[112:115], a[112:115], a[56:59], v[112:115]
    v_mfma_f32_16x16x32_bf16 v[116:119], a[112:115], a[60:63], v[116:119]
    buffer_load_dwordx4 v15, s[8:11], s40 offen offset:2048 lds
    v_mfma_f32_16x16x32_bf16 v[120:123], a[116:119], a[32:35], v[120:123]
    ds_read_b64_tr_b16 a[68:69], v4 offset:0
    v_mfma_f32_16x16x32_bf16 v[124:127], a[116:119], a[36:39], v[124:127]
    v_mfma_f32_16x16x32_bf16 v[128:131], a[116:119], a[40:43], v[128:131]
    ds_read_b64_tr_b16 a[70:71], v4 offset:512
    v_mfma_f32_16x16x32_bf16 v[132:135], a[116:119], a[44:47], v[132:135]
    buffer_load_dwordx4 v15, s[8:11], s40 offen offset:3072 lds
    v_mfma_f32_16x16x32_bf16 v[136:139], a[116:119], a[48:51], v[136:139]
    v_mfma_f32_16x16x32_bf16 v[140:143], a[116:119], a[52:55], v[140:143]
    ds_read_b128 a[16:19], v1 offset:4096
    v_mfma_f32_16x16x32_bf16 v[144:147], a[116:119], a[56:59], v[144:147]
    ds_read_b128 a[20:23], v1 offset:5120
    v_mfma_f32_16x16x32_bf16 v[148:151], a[116:119], a[60:63], v[148:151]
    s_add_u32 m0, s45, 110592
    v_mfma_f32_16x16x32_bf16 v[216:219], a[120:123], a[32:35], v[216:219]
    v_mfma_f32_16x16x32_bf16 v[220:223], a[120:123], a[36:39], v[220:223]
    ds_read_b128 a[24:27], v1 offset:6144
    v_mfma_f32_16x16x32_bf16 v[224:227], a[120:123], a[40:43], v[224:227]
    ds_read_b128 a[28:31], v1 offset:7168
    v_mfma_f32_16x16x32_bf16 v[228:231], a[120:123], a[44:47], v[228:231]
    v_mfma_f32_16x16x32_bf16 v[232:235], a[120:123], a[48:51], v[232:235]
    s_add_u32 s40, s40, 131072
    v_mfma_f32_16x16x32_bf16 v[236:239], a[120:123], a[52:55], v[236:239]
    ds_read_b64_tr_b16 a[72:73], v7 offset:1024
    v_mfma_f32_16x16x32_bf16 v[240:243], a[120:123], a[56:59], v[240:243]
    v_mfma_f32_16x16x32_bf16 v[244:247], a[120:123], a[60:63], v[244:247]
    ds_read_b64_tr_b16 a[74:75], v7 offset:1536
    v_mfma_f32_16x16x32_bf16 v[248:251], a[124:127], a[32:35], v[248:251]
    buffer_load_dwordx4 v16, s[12:15], s41 offen lds
    v_mfma_f32_16x16x32_bf16 v[252:255], a[124:127], a[36:39], v[252:255]
    v_mfma_f32_16x16x32_bf16 a[144:147], a[124:127], a[40:43], a[144:147]
    ds_read_b64_tr_b16 a[76:77], v8 offset:1024
    v_mfma_f32_16x16x32_bf16 a[148:151], a[124:127], a[44:47], a[148:151]
    buffer_load_dwordx4 v17, s[16:19], s42 offen offset:1024 lds
    v_mfma_f32_16x16x32_bf16 a[152:155], a[124:127], a[48:51], a[152:155]
    v_mfma_f32_16x16x32_bf16 a[156:159], a[124:127], a[52:55], a[156:159]
    ds_read_b64_tr_b16 a[78:79], v8 offset:1536
    v_mfma_f32_16x16x32_bf16 a[160:163], a[124:127], a[56:59], a[160:163]
    ds_read_b64_tr_b16 a[80:81], v9 offset:1024
    v_mfma_f32_16x16x32_bf16 a[164:167], a[124:127], a[60:63], a[164:167]
    v_mfma_f32_16x16x32_bf16 v[152:155], a[128:131], a[32:35], v[152:155]
    buffer_load_dwordx4 v17, s[20:23], s42 offen offset:2048 lds
    v_mfma_f32_16x16x32_bf16 v[156:159], a[128:131], a[36:39], v[156:159]
    ds_read_b64_tr_b16 a[82:83], v9 offset:1536
    v_mfma_f32_16x16x32_bf16 v[160:163], a[128:131], a[40:43], v[160:163]
    v_mfma_f32_16x16x32_bf16 v[164:167], a[128:131], a[44:47], v[164:167]
    ds_read_b64_tr_b16 a[84:85], v10 offset:1024
    v_mfma_f32_16x16x32_bf16 v[168:171], a[128:131], a[48:51], v[168:171]
    buffer_load_dwordx4 v17, s[24:27], s42 offen offset:3072 lds
    v_mfma_f32_16x16x32_bf16 v[172:175], a[128:131], a[52:55], v[172:175]
    ds_read_b64_tr_b16 a[86:87], v10 offset:1536
    v_mfma_f32_16x16x32_bf16 v[176:179], a[128:131], a[56:59], v[176:179]
    v_mfma_f32_16x16x32_bf16 v[180:183], a[128:131], a[60:63], v[180:183]
    ds_read_b64_tr_b16 a[88:89], v7 offset:2048
    v_mfma_f32_16x16x32_bf16 v[184:187], a[132:135], a[32:35], v[184:187]
    s_add_u32 m0, s45, 114688
    v_mfma_f32_16x16x32_bf16 v[188:191], a[132:135], a[36:39], v[188:191]
    v_mfma_f32_16x16x32_bf16 v[192:195], a[132:135], a[40:43], v[192:195]
    ds_read_b64_tr_b16 a[90:91], v7 offset:2560
    v_mfma_f32_16x16x32_bf16 v[196:199], a[132:135], a[44:47], v[196:199]
    ds_read_b64_tr_b16 a[92:93], v8 offset:2048
    v_mfma_f32_16x16x32_bf16 v[200:203], a[132:135], a[48:51], v[200:203]
    v_mfma_f32_16x16x32_bf16 v[204:207], a[132:135], a[52:55], v[204:207]
    s_add_u32 s41, s41, 196608
    v_mfma_f32_16x16x32_bf16 v[208:211], a[132:135], a[56:59], v[208:211]
    ds_read_b64_tr_b16 a[94:95], v8 offset:2560
    v_mfma_f32_16x16x32_bf16 v[212:215], a[132:135], a[60:63], v[212:215]
    v_mfma_f32_16x16x32_bf16 a[168:171], a[136:139], a[32:35], a[168:171]
    ds_read_b64_tr_b16 a[96:97], v9 offset:2048
    v_mfma_f32_16x16x32_bf16 a[172:175], a[136:139], a[36:39], a[172:175]
    buffer_load_dwordx4 v17, s[28:31], s42 offen lds
    v_mfma_f32_16x16x32_bf16 a[176:179], a[136:139], a[40:43], a[176:179]
    v_mfma_f32_16x16x32_bf16 a[180:183], a[136:139], a[44:47], a[180:183]
    ds_read_b64_tr_b16 a[98:99], v9 offset:2560
    v_mfma_f32_16x16x32_bf16 a[184:187], a[136:139], a[48:51], a[184:187]
    ds_read_b64_tr_b16 a[100:101], v10 offset:2048
    v_mfma_f32_16x16x32_bf16 a[188:191], a[136:139], a[52:55], a[188:191]
    v_mfma_f32_16x16x32_bf16 a[192:195], a[136:139], a[56:59], a[192:195]
    s_add_u32 s42, s42, 229376
    v_mfma_f32_16x16x32_bf16 a[196:199], a[136:139], a[60:63], a[196:199]
    ds_read_b64_tr_b16 a[102:103], v10 offset:2560
    v_mfma_f32_16x16x32_bf16 a[200:203], a[140:143], a[32:35], a[200:203]
    v_mfma_f32_16x16x32_bf16 a[204:207], a[140:143], a[36:39], a[204:207]
    v_mfma_f32_16x16x32_bf16 a[208:211], a[140:143], a[40:43], a[208:211]
    v_mfma_f32_16x16x32_bf16 a[212:215], a[140:143], a[44:47], a[212:215]
    v_mfma_f32_16x16x32_bf16 a[216:219], a[140:143], a[48:51], a[216:219]
    s_sub_u32 s46, s46, 1
    v_mfma_f32_16x16x32_bf16 a[220:223], a[140:143], a[52:55], a[220:223]
    s_cmp_lg_u32 s46, 0
    v_mfma_f32_16x16x32_bf16 a[224:227], a[140:143], a[56:59], a[224:227]
    v_mfma_f32_16x16x32_bf16 a[228:231], a[140:143], a[60:63], a[228:231]
    s_cbranch_scc1 L_gemm1_kernel_loopA
    s_waitcnt lgkmcnt(0)
    v_mfma_f32_16x16x32_bf16 v[24:27], a[64:67], a[0:3], v[24:27]
    v_mfma_f32_16x16x32_bf16 v[28:31], a[64:67], a[4:7], v[28:31]
    v_mfma_f32_16x16x32_bf16 v[32:35], a[64:67], a[8:11], v[32:35]
    v_mfma_f32_16x16x32_bf16 v[36:39], a[64:67], a[12:15], v[36:39]
    v_mfma_f32_16x16x32_bf16 v[40:43], a[64:67], a[16:19], v[40:43]
    v_mfma_f32_16x16x32_bf16 v[44:47], a[64:67], a[20:23], v[44:47]
    v_mfma_f32_16x16x32_bf16 v[48:51], a[64:67], a[24:27], v[48:51]
    s_waitcnt vmcnt(18)
    v_mfma_f32_16x16x32_bf16 v[52:55], a[64:67], a[28:31], v[52:55]
    s_barrier
    buffer_load_dword v22, v21, s[72:75], s47 offen
    v_mfma_f32_16x16x32_bf16 v[56:59], a[68:71], a[0:3], v[56:59]
    ds_read_b64_tr_b16 a[104:105], v3 offset:36864
    s_add_u32 s47, s47, 1048576
    v_mfma_f32_16x16x32_bf16 v[60:63], a[68:71], a[4:7], v[60:63]
    ds_read_b64_tr_b16 a[106:107], v3 offset:37376
    v_mfma_f32_16x16x32_bf16 v[64:67], a[68:71], a[8:11], v[64:67]
    buffer_load_dword v22, v21, s[72:75], s47 offen
    v_mfma_f32_16x16x32_bf16 v[68:71], a[68:71], a[12:15], v[68:71]
    ds_read_b128 a[32:35], v1 offset:36864
    v_mfma_f32_16x16x32_bf16 v[72:75], a[68:71], a[16:19], v[72:75]
    ds_read_b128 a[36:39], v1 offset:37888
    s_add_u32 s47, s47, 1048576
    v_mfma_f32_16x16x32_bf16 v[76:79], a[68:71], a[20:23], v[76:79]
    v_mfma_f32_16x16x32_bf16 v[80:83], a[68:71], a[24:27], v[80:83]
    ds_read_b128 a[40:43], v1 offset:38912
    buffer_load_dword v22, v21, s[72:75], s47 offen
    v_mfma_f32_16x16x32_bf16 v[84:87], a[68:71], a[28:31], v[84:87]
    s_add_u32 s47, s47, 1048576
    v_mfma_f32_16x16x32_bf16 v[88:91], a[72:75], a[0:3], v[88:91]
    ds_read_b128 a[44:47], v1 offset:39936
    v_mfma_f32_16x16x32_bf16 v[92:95], a[72:75], a[4:7], v[92:95]
    ds_read_b64_tr_b16 a[108:109], v4 offset:36864
    v_mfma_f32_16x16x32_bf16 v[96:99], a[72:75], a[8:11], v[96:99]
    buffer_load_dword v22, v21, s[72:75], s47 offen
    v_mfma_f32_16x16x32_bf16 v[100:103], a[72:75], a[12:15], v[100:103]
    ds_read_b64_tr_b16 a[110:111], v4 offset:37376
    s_add_u32 s47, s47, 1048576
    v_mfma_f32_16x16x32_bf16 v[104:107], a[72:75], a[16:19], v[104:107]
    v_mfma_f32_16x16x32_bf16 v[108:111], a[72:75], a[20:23], v[108:111]
    ds_read_b128 a[48:51], v1 offset:40960
    buffer_load_dword v22, v21, s[72:75], s47 offen
    v_mfma_f32_16x16x32_bf16 v[112:115], a[72:75], a[24:27], v[112:115]
    ds_read_b128 a[52:55], v1 offset:41984
    s_add_u32 s47, s47, 1048576
    v_mfma_f32_16x16x32_bf16 v[116:119], a[72:75], a[28:31], v[116:119]
    v_mfma_f32_16x16x32_bf16 v[120:123], a[76:79], a[0:3], v[120:123]
    ds_read_b128 a[56:59], v1 offset:43008
    v_mfma_f32_16x16x32_bf16 v[124:127], a[76:79], a[4:7], v[124:127]
    buffer_load_dword v22, v21, s[72:75], s47 offen
    v_mfma_f32_16x16x32_bf16 v[128:131], a[76:79], a[8:11], v[128:131]
    ds_read_b128 a[60:63], v1 offset:44032
    s_add_u32 s47, s47, 1048576
    v_mfma_f32_16x16x32_bf16 v[132:135], a[76:79], a[12:15], v[132:135]
    ds_read_b64_tr_b16 a[112:113], v7 offset:37888
    v_mfma_f32_16x16x32_bf16 v[136:139], a[76:79], a[16:19], v[136:139]
    buffer_load_dword v22, v21, s[72:75], s47 offen
    v_mfma_f32_16x16x32_bf16 v[140:143], a[76:79], a[20:23], v[140:143]
    ds_read_b64_tr_b16 a[114:115], v7 offset:38400
    v_mfma_f32_16x16x32_bf16 v[144:147], a[76:79], a[24:27], v[144:147]
    s_add_u32 s47, s47, 1048576
    v_mfma_f32_16x16x32_bf16 v[148:151], a[76:79], a[28:31], v[148:151]
    ds_read_b64_tr_b16 a[116:117], v8 offset:37888
    v_mfma_f32_16x16x32_bf16 v[152:155], a[88:91], a[0:3], v[152:155]
    ds_read_b64_tr_b16 a[118:119], v8 offset:38400
    v_mfma_f32_16x16x32_bf16 v[156:159], a[88:91], a[4:7], v[156:159]
    v_mfma_f32_16x16x32_bf16 v[160:163], a[88:91], a[8:11], v[160:163]
    ds_read_b64_tr_b16 a[128:129], v7 offset:38912
    v_mfma_f32_16x16x32_bf16 v[164:167], a[88:91], a[12:15], v[164:167]
    v_mfma_f32_16x16x32_bf16 v[168:171], a[88:91], a[16:19], v[168:171]
    ds_read_b64_tr_b16 a[130:131], v7 offset:39424
    v_mfma_f32_16x16x32_bf16 v[172:175], a[88:91], a[20:23], v[172:175]
    ds_read_b64_tr_b16 a[132:133], v8 offset:38912
    v_mfma_f32_16x16x32_bf16 v[176:179], a[88:91], a[24:27], v[176:179]
    v_mfma_f32_16x16x32_bf16 v[180:183], a[88:91], a[28:31], v[180:183]
    ds_read_b64_tr_b16 a[134:135], v8 offset:39424
    v_mfma_f32_16x16x32_bf16 v[184:187], a[92:95], a[0:3], v[184:187]
    v_mfma_f32_16x16x32_bf16 v[188:191], a[92:95], a[4:7], v[188:191]
    v_mfma_f32_16x16x32_bf16 v[192:195], a[92:95], a[8:11], v[192:195]
    v_lshlrev_b32 v15, 17, v0
    v_mov_b32 v17, 0
    v_lshl_add_u32 v16, v18, 6, v0
    v_mov_b32 v23, 1
    v_mfma_f32_16x16x32_bf16 v[196:199], a[92:95], a[12:15], v[196:199]
    v_lshlrev_b32 v16, 8, v16
    v_mfma_f32_16x16x32_bf16 v[200:203], a[92:95], a[16:19], v[200:203]
    buffer_store_dword v17, v15, s[80:83], s59 offen sc0 sc1
    v_mfma_f32_16x16x32_bf16 v[204:207], a[92:95], a[20:23], v[204:207]
    buffer_atomic_add v23, v16, s[76:79], 0 offen sc0 sc1
    v_mfma_f32_16x16x32_bf16 v[208:211], a[92:95], a[24:27], v[208:211]
    v_mfma_f32_16x16x32_bf16 v[212:215], a[92:95], a[28:31], v[212:215]
    s_add_u32 s32, s6, 4194304
    s_addc_u32 s33, s7, 0
    s_mov_b32 s34, 31457280
    s_mov_b32 s35, 0x20000
    v_lshlrev_b32 v15, 4, v0
    v_lshlrev_b32 v16, 9, v19
    v_lshl_add_u32 v17, v20, 4, v16
    v_bfe_u32 v21, v0, 3, 1
    v_lshl_add_u32 v16, v21, 8, v16
    v_and_b32 v21, 7, v0
    v_lshl_add_u32 v16, v21, 4, v16
    s_lshl_b32 s52, s63, 3
    s_lshl_b32 s53, s65, 2
    s_add_u32 s52, s52, s53
    s_lshl_b32 s53, s60, 2
    s_add_u32 s53, s53, s66
    s_mul_i32 s54, s60, 14
    s_add_u32 s54, s54, 32
    s_lshl_b32 s55, s52, 11
    s_cmp_eq_u32 s62, 2
    s_cbranch_scc1 L_g1epi_k
    s_lshl_b32 s57, s62, 1
    s_add_u32 s57, s57, s53
    s_lshl_b32 s57, s57, 17
    s_lshl_b32 s58, s52, 11
    s_add_u32 s57, s57, s58
    s_mov_b32 s58, 2048
    s_mov_b32 s59, 256
    s_mov_b32 s67, 0x3e8293ee
    s_branch L_g1epi_qk
L_g1epi_k:
    s_lshl_b32 s57, s53, 18
    s_lshl_b32 s58, s52, 12
    s_add_u32 s57, s57, s58
    s_add_u32 s57, s57, 4194304
    s_mov_b32 s58, 4096
    s_mov_b32 s59, 128
    s_mov_b32 s67, 1.0
    v_mov_b32 v17, v16
L_g1epi_qk:
    s_waitcnt lgkmcnt(0)
    v_mfma_f32_16x16x32_bf16 v[24:27], a[104:107], a[32:35], v[24:27]
    v_mfma_f32_16x16x32_bf16 v[28:31], a[104:107], a[36:39], v[28:31]
    v_mfma_f32_16x16x32_bf16 v[32:35], a[104:107], a[40:43], v[32:35]
    v_mfma_f32_16x16x32_bf16 v[36:39], a[104:107], a[44:47], v[36:39]
    v_mfma_f32_16x16x32_bf16 v[40:43], a[104:107], a[48:51], v[40:43]
    v_mfma_f32_16x16x32_bf16 v[44:47], a[104:107], a[52:55], v[44:47]
    v_mfma_f32_16x16x32_bf16 v[48:51], a[104:107], a[56:59], v[48:51]
    s_waitcnt vmcnt(18)
    v_mfma_f32_16x16x32_bf16 v[52:55], a[104:107], a[60:63], v[52:55]
    s_barrier
    v_mfma_f32_16x16x32_bf16 v[56:59], a[108:111], a[32:35], v[56:59]
    ds_read_b64_tr_b16 a[64:65], v5 offset:0
    v_mfma_f32_16x16x32_bf16 v[60:63], a[108:111], a[36:39], v[60:63]
    ds_read_b64_tr_b16 a[66:67], v5 offset:512
    v_mfma_f32_16x16x32_bf16 v[64:67], a[108:111], a[40:43], v[64:67]
    v_mfma_f32_16x16x32_bf16 v[68:71], a[108:111], a[44:47], v[68:71]
    ds_read_b128 a[0:3], v2 offset:0
    v_mfma_f32_16x16x32_bf16 v[72:75], a[108:111], a[48:51], v[72:75]
    ds_read_b128 a[4:7], v2 offset:1024
    v_mfma_f32_16x16x32_bf16 v[76:79], a[108:111], a[52:55], v[76:79]
    v_mfma_f32_16x16x32_bf16 v[80:83], a[108:111], a[56:59], v[80:83]
    ds_read_b128 a[8:11], v2 offset:2048
    v_mfma_f32_16x16x32_bf16 v[84:87], a[108:111], a[60:63], v[84:87]
    v_mfma_f32_16x16x32_bf16 v[88:91], a[112:115], a[32:35], v[88:91]
    ds_read_b128 a[12:15], v2 offset:3072
    v_mfma_f32_16x16x32_bf16 v[92:95], a[112:115], a[36:39], v[92:95]
    ds_read_b64_tr_b16 a[68:69], v6 offset:0
    v_mfma_f32_16x16x32_bf16 v[96:99], a[112:115], a[40:43], v[96:99]
    v_mfma_f32_16x16x32_bf16 v[100:103], a[112:115], a[44:47], v[100:103]
    ds_read_b64_tr_b16 a[70:71], v6 offset:512
    v_mfma_f32_16x16x32_bf16 v[104:107], a[112:115], a[48:51], v[104:107]
    v_mfma_f32_16x16x32_bf16 v[108:111], a[112:115], a[52:55], v[108:111]
    ds_read_b128 a[16:19], v2 offset:4096
    v_mfma_f32_16x16x32_bf16 v[112:115], a[112:115], a[56:59], v[112:115]
    ds_read_b128 a[20:23], v2 offset:5120
    v_mfma_f32_16x16x32_bf16 v[116:119], a[112:115], a[60:63], v[116:119]
    v_mfma_f32_16x16x32_bf16 v[120:123], a[116:119], a[32:35], v[120:123]
    ds_read_b128 a[24:27], v2 offset:6144
    v_mfma_f32_16x16x32_bf16 v[124:127], a[116:119], a[36:39], v[124:127]
    v_mfma_f32_16x16x32_bf16 v[128:131], a[116:119], a[40:43], v[128:131]
    ds_read_b128 a[28:31], v2 offset:7168
    v_mfma_f32_16x16x32_bf16 v[132:135], a[116:119], a[44:47], v[132:135]
    ds_read_b64_tr_b16 a[72:73], v11 offset:1024
    v_mfma_f32_16x16x32_bf16 v[136:139], a[116:119], a[48:51], v[136:139]
    v_mfma_f32_16x16x32_bf16 v[140:143], a[116:119], a[52:55], v[140:143]
    ds_read_b64_tr_b16 a[74:75], v11 offset:1536
    v_mfma_f32_16x16x32_bf16 v[144:147], a[116:119], a[56:59], v[144:147]
    v_mfma_f32_16x16x32_bf16 v[148:151], a[116:119], a[60:63], v[148:151]
    ds_read_b64_tr_b16 a[76:77], v12 offset:1024
    v_mfma_f32_16x16x32_bf16 v[152:155], a[128:131], a[32:35], v[152:155]
    ds_read_b64_tr_b16 a[78:79], v12 offset:1536
    v_mfma_f32_16x16x32_bf16 v[156:159], a[128:131], a[36:39], v[156:159]
    v_mfma_f32_16x16x32_bf16 v[160:163], a[128:131], a[40:43], v[160:163]
    ds_read_b64_tr_b16 a[88:89], v11 offset:2048
    v_mfma_f32_16x16x32_bf16 v[164:167], a[128:131], a[44:47], v[164:167]
    v_mfma_f32_16x16x32_bf16 v[168:171], a[128:131], a[48:51], v[168:171]
    ds_read_b64_tr_b16 a[90:91], v11 offset:2560
    v_mfma_f32_16x16x32_bf16 v[172:175], a[128:131], a[52:55], v[172:175]
    ds_read_b64_tr_b16 a[92:93], v12 offset:2048
    v_mfma_f32_16x16x32_bf16 v[176:179], a[128:131], a[56:59], v[176:179]
    v_mfma_f32_16x16x32_bf16 v[180:183], a[128:131], a[60:63], v[180:183]
    ds_read_b64_tr_b16 a[94:95], v12 offset:2560
    v_mfma_f32_16x16x32_bf16 v[184:187], a[132:135], a[32:35], v[184:187]
    v_mfma_f32_16x16x32_bf16 v[188:191], a[132:135], a[36:39], v[188:191]
    v_mfma_f32_16x16x32_bf16 v[192:195], a[132:135], a[40:43], v[192:195]
    v_mfma_f32_16x16x32_bf16 v[196:199], a[132:135], a[44:47], v[196:199]
    v_mfma_f32_16x16x32_bf16 v[200:203], a[132:135], a[48:51], v[200:203]
    v_mfma_f32_16x16x32_bf16 v[204:207], a[132:135], a[52:55], v[204:207]
    v_mfma_f32_16x16x32_bf16 v[208:211], a[132:135], a[56:59], v[208:211]
    v_mfma_f32_16x16x32_bf16 v[212:215], a[132:135], a[60:63], v[212:215]
    s_waitcnt lgkmcnt(0)
    v_mfma_f32_16x16x32_bf16 v[24:27], a[64:67], a[0:3], v[24:27]
    v_mfma_f32_16x16x32_bf16 v[28:31], a[64:67], a[4:7], v[28:31]
    v_mfma_f32_16x16x32_bf16 v[32:35], a[64:67], a[8:11], v[32:35]
    v_mfma_f32_16x16x32_bf16 v[36:39], a[64:67], a[12:15], v[36:39]
    v_mfma_f32_16x16x32_bf16 v[40:43], a[64:67], a[16:19], v[40:43]
    v_mfma_f32_16x16x32_bf16 v[44:47], a[64:67], a[20:23], v[44:47]
    v_mfma_f32_16x16x32_bf16 v[48:51], a[64:67], a[24:27], v[48:51]
    s_waitcnt vmcnt(9)
    v_mfma_f32_16x16x32_bf16 v[52:55], a[64:67], a[28:31], v[52:55]
    s_barrier
    v_mfma_f32_16x16x32_bf16 v[56:59], a[68:71], a[0:3], v[56:59]
    ds_read_b64_tr_b16 a[104:105], v5 offset:36864
    v_mfma_f32_16x16x32_bf16 v[60:63], a[68:71], a[4:7], v[60:63]
    ds_read_b64_tr_b16 a[106:107], v5 offset:37376
    v_mfma_f32_16x16x32_bf16 v[64:67], a[68:71], a[8:11], v[64:67]
    v_mfma_f32_16x16x32_bf16 v[68:71], a[68:71], a[12:15], v[68:71]
    ds_read_b128 a[32:35], v2 offset:36864
    v_mfma_f32_16x16x32_bf16 v[72:75], a[68:71], a[16:19], v[72:75]
    ds_read_b128 a[36:39], v2 offset:37888
    v_mfma_f32_16x16x32_bf16 v[76:79], a[68:71], a[20:23], v[76:79]
    v_mfma_f32_16x16x32_bf16 v[80:83], a[68:71], a[24:27], v[80:83]
    ds_read_b128 a[40:43], v2 offset:38912
    v_mfma_f32_16x16x32_bf16 v[84:87], a[68:71], a[28:31], v[84:87]
    v_mfma_f32_16x16x32_bf16 v[88:91], a[72:75], a[0:3], v[88:91]
    ds_read_b128 a[44:47], v2 offset:39936
    v_mfma_f32_16x16x32_bf16 v[92:95], a[72:75], a[4:7], v[92:95]
    ds_read_b64_tr_b16 a[108:109], v6 offset:36864
    v_mfma_f32_16x16x32_bf16 v[96:99], a[72:75], a[8:11], v[96:99]
    v_mfma_f32_16x16x32_bf16 v[100:103], a[72:75], a[12:15], v[100:103]
    ds_read_b64_tr_b16 a[110:111], v6 offset:37376
    v_mfma_f32_16x16x32_bf16 v[104:107], a[72:75], a[16:19], v[104:107]
    v_mfma_f32_16x16x32_bf16 v[108:111], a[72:75], a[20:23], v[108:111]
    ds_read_b128 a[48:51], v2 offset:40960
    v_mfma_f32_16x16x32_bf16 v[112:115], a[72:75], a[24:27], v[112:115]
    ds_read_b128 a[52:55], v2 offset:41984
    v_mfma_f32_16x16x32_bf16 v[116:119], a[72:75], a[28:31], v[116:119]
    v_mfma_f32_16x16x32_bf16 v[120:123], a[76:79], a[0:3], v[120:123]
    ds_read_b128 a[56:59], v2 offset:43008
    v_mfma_f32_16x16x32_bf16 v[124:127], a[76:79], a[4:7], v[124:127]
    v_mfma_f32_16x16x32_bf16 v[128:131], a[76:79], a[8:11], v[128:131]
    ds_read_b128 a[60:63], v2 offset:44032
    v_mfma_f32_16x16x32_bf16 v[132:135], a[76:79], a[12:15], v[132:135]
    ds_read_b64_tr_b16 a[112:113], v11 offset:37888
    v_mfma_f32_16x16x32_bf16 v[136:139], a[76:79], a[16:19], v[136:139]
    v_mfma_f32_16x16x32_bf16 v[140:143], a[76:79], a[20:23], v[140:143]
    ds_read_b64_tr_b16 a[114:115], v11 offset:38400
    v_mfma_f32_16x16x32_bf16 v[144:147], a[76:79], a[24:27], v[144:147]
    v_mfma_f32_16x16x32_bf16 v[148:151], a[76:79], a[28:31], v[148:151]
    ds_read_b64_tr_b16 a[116:117], v12 offset:37888
    v_mfma_f32_16x16x32_bf16 v[152:155], a[88:91], a[0:3], v[152:155]
    ds_read_b64_tr_b16 a[118:119], v12 offset:38400
    v_mfma_f32_16x16x32_bf16 v[156:159], a[88:91], a[4:7], v[156:159]
    v_mfma_f32_16x16x32_bf16 v[160:163], a[88:91], a[8:11], v[160:163]
    ds_read_b64_tr_b16 a[128:129], v11 offset:38912
    v_mfma_f32_16x16x32_bf16 v[164:167], a[88:91], a[12:15], v[164:167]
    v_mfma_f32_16x16x32_bf16 v[168:171], a[88:91], a[16:19], v[168:171]
    ds_read_b64_tr_b16 a[130:131], v11 offset:39424
    v_mfma_f32_16x16x32_bf16 v[172:175], a[88:91], a[20:23], v[172:175]
    ds_read_b64_tr_b16 a[132:133], v12 offset:38912
    v_mfma_f32_16x16x32_bf16 v[176:179], a[88:91], a[24:27], v[176:179]
    v_mfma_f32_16x16x32_bf16 v[180:183], a[88:91], a[28:31], v[180:183]
    ds_read_b64_tr_b16 a[134:135], v12 offset:39424
    v_mfma_f32_16x16x32_bf16 v[184:187], a[92:95], a[0:3], v[184:187]
    v_mfma_f32_16x16x32_bf16 v[188:191], a[92:95], a[4:7], v[188:191]
    v_mfma_f32_16x16x32_bf16 v[192:195], a[92:95], a[8:11], v[192:195]
    v_mfma_f32_16x16x32_bf16 v[196:199], a[92:95], a[12:15], v[196:199]
    v_mfma_f32_16x16x32_bf16 v[200:203], a[92:95], a[16:19], v[200:203]
    v_mfma_f32_16x16x32_bf16 v[204:207], a[92:95], a[20:23], v[204:207]
    v_mfma_f32_16x16x32_bf16 v[208:211], a[92:95], a[24:27], v[208:211]
    v_mfma_f32_16x16x32_bf16 v[212:215], a[92:95], a[28:31], v[212:215]
    s_waitcnt lgkmcnt(0)
    v_mfma_f32_16x16x32_bf16 v[24:27], a[104:107], a[32:35], v[24:27]
    ds_read_b64_tr_b16 a[80:81], v9 offset:1024
    v_mfma_f32_16x16x32_bf16 v[28:31], a[104:107], a[36:39], v[28:31]
    v_mfma_f32_16x16x32_bf16 v[32:35], a[104:107], a[40:43], v[32:35]
    ds_read_b64_tr_b16 a[82:83], v9 offset:1536
    v_mfma_f32_16x16x32_bf16 v[36:39], a[104:107], a[44:47], v[36:39]
    v_mfma_f32_16x16x32_bf16 v[40:43], a[104:107], a[48:51], v[40:43]
    v_mfma_f32_16x16x32_bf16 v[44:47], a[104:107], a[52:55], v[44:47]
    ds_read_b128 a[0:3], v1 offset:0
    v_mfma_f32_16x16x32_bf16 v[48:51], a[104:107], a[56:59], v[48:51]
    v_mfma_f32_16x16x32_bf16 v[52:55], a[104:107], a[60:63], v[52:55]
    ds_read_b128 a[4:7], v1 offset:1024
    v_mfma_f32_16x16x32_bf16 v[56:59], a[108:111], a[32:35], v[56:59]
    v_mfma_f32_16x16x32_bf16 v[60:63], a[108:111], a[36:39], v[60:63]
    v_mfma_f32_16x16x32_bf16 v[64:67], a[108:111], a[40:43], v[64:67]
    ds_read_b128 a[8:11], v1 offset:2048
    v_mfma_f32_16x16x32_bf16 v[68:71], a[108:111], a[44:47], v[68:71]
    v_mfma_f32_16x16x32_bf16 v[72:75], a[108:111], a[48:51], v[72:75]
    ds_read_b128 a[12:15], v1 offset:3072
    v_mfma_f32_16x16x32_bf16 v[76:79], a[108:111], a[52:55], v[76:79]
    v_mfma_f32_16x16x32_bf16 v[80:83], a[108:111], a[56:59], v[80:83]
    v_mfma_f32_16x16x32_bf16 v[84:87], a[108:111], a[60:63], v[84:87]
    ds_read_b64_tr_b16 a[84:85], v10 offset:1024
    v_mfma_f32_16x16x32_bf16 v[88:91], a[112:115], a[32:35], v[88:91]
    v_mfma_f32_16x16x32_bf16 v[92:95], a[112:115], a[36:39], v[92:95]
    ds_read_b64_tr_b16 a[86:87], v10 offset:1536
    v_mfma_f32_16x16x32_bf16 v[96:99], a[112:115], a[40:43], v[96:99]
    v_mfma_f32_16x16x32_bf16 v[100:103], a[112:115], a[44:47], v[100:103]
    v_mfma_f32_16x16x32_bf16 v[104:107], a[112:115], a[48:51], v[104:107]
    ds_read_b128 a[16:19], v1 offset:4096
    v_mfma_f32_16x16x32_bf16 v[108:111], a[112:115], a[52:55], v[108:111]
    v_mfma_f32_16x16x32_bf16 v[112:115], a[112:115], a[56:59], v[112:115]
    v_mfma_f32_16x16x32_bf16 v[116:119], a[112:115], a[60:63], v[116:119]
    ds_read_b128 a[20:23], v1 offset:5120
    v_mfma_f32_16x16x32_bf16 v[120:123], a[116:119], a[32:35], v[120:123]
    v_mfma_f32_16x16x32_bf16 v[124:127], a[116:119], a[36:39], v[124:127]
    ds_read_b128 a[24:27], v1 offset:6144
    v_mfma_f32_16x16x32_bf16 v[128:131], a[116:119], a[40:43], v[128:131]
    v_mfma_f32_16x16x32_bf16 v[132:135], a[116:119], a[44:47], v[132:135]
    v_mfma_f32_16x16x32_bf16 v[136:139], a[116:119], a[48:51], v[136:139]
    ds_read_b128 a[28:31], v1 offset:7168
    v_mfma_f32_16x16x32_bf16 v[140:143], a[116:119], a[52:55], v[140:143]
    v_mfma_f32_16x16x32_bf16 v[144:147], a[116:119], a[56:59], v[144:147]
    ds_read_b64_tr_b16 a[96:97], v9 offset:2048
    v_mfma_f32_16x16x32_bf16 v[148:151], a[116:119], a[60:63], v[148:151]
    v_mfma_f32_16x16x32_bf16 v[152:155], a[128:131], a[32:35], v[152:155]
    v_mfma_f32_16x16x32_bf16 v[156:159], a[128:131], a[36:39], v[156:159]
    ds_read_b64_tr_b16 a[98:99], v9 offset:2560
    v_mfma_f32_16x16x32_bf16 v[160:163], a[128:131], a[40:43], v[160:163]
    v_mfma_f32_16x16x32_bf16 v[164:167], a[128:131], a[44:47], v[164:167]
    ds_read_b64_tr_b16 a[100:101], v10 offset:2048
    v_mfma_f32_16x16x32_bf16 v[168:171], a[128:131], a[48:51], v[168:171]
    v_mfma_f32_16x16x32_bf16 v[172:175], a[128:131], a[52:55], v[172:175]
    v_mfma_f32_16x16x32_bf16 v[176:179], a[128:131], a[56:59], v[176:179]
    ds_read_b64_tr_b16 a[102:103], v10 offset:2560
    v_mfma_f32_16x16x32_bf16 v[180:183], a[128:131], a[60:63], v[180:183]
    v_mfma_f32_16x16x32_bf16 v[184:187], a[132:135], a[32:35], v[184:187]
    v_mfma_f32_16x16x32_bf16 v[188:191], a[132:135], a[36:39], v[188:191]
    v_mfma_f32_16x16x32_bf16 v[192:195], a[132:135], a[40:43], v[192:195]
    v_mfma_f32_16x16x32_bf16 v[196:199], a[132:135], a[44:47], v[196:199]
    v_mfma_f32_16x16x32_bf16 v[200:203], a[132:135], a[48:51], v[200:203]
    v_mfma_f32_16x16x32_bf16 v[204:207], a[132:135], a[52:55], v[204:207]
    v_mfma_f32_16x16x32_bf16 v[208:211], a[132:135], a[56:59], v[208:211]
    v_mfma_f32_16x16x32_bf16 v[212:215], a[132:135], a[60:63], v[212:215]
    s_waitcnt lgkmcnt(0)
    v_mfma_f32_16x16x32_bf16 v[216:219], a[80:83], a[0:3], v[216:219]
    ds_read_b64_tr_b16 a[120:121], v9 offset:37888
    v_mfma_f32_16x16x32_bf16 v[220:223], a[80:83], a[4:7], v[220:223]
    ds_read_b64_tr_b16 a[122:123], v9 offset:38400
    v_mfma_f32_16x16x32_bf16 v[224:227], a[80:83], a[8:11], v[224:227]
    v_mfma_f32_16x16x32_bf16 v[228:231], a[80:83], a[12:15], v[228:231]
    ds_read_b128 a[32:35], v1 offset:36864
    v_mfma_f32_16x16x32_bf16 v[232:235], a[80:83], a[16:19], v[232:235]
    ds_read_b128 a[36:39], v1 offset:37888
    v_mul_f32 v24, s67, v24
    v_mul_f32 v25, s67, v25
    v_mfma_f32_16x16x32_bf16 v[236:239], a[80:83], a[20:23], v[236:239]
    v_mul_f32 v26, s67, v26
    v_mul_f32 v27, s67, v27
    v_mfma_f32_16x16x32_bf16 v[240:243], a[80:83], a[24:27], v[240:243]
    ds_read_b128 a[40:43], v1 offset:38912
    v_mul_f32 v56, s67, v56
    v_mul_f32 v57, s67, v57
    v_mfma_f32_16x16x32_bf16 v[244:247], a[80:83], a[28:31], v[244:247]
    ds_read_b128 a[44:47], v1 offset:39936
    v_mul_f32 v58, s67, v58
    v_mul_f32 v59, s67, v59
    v_mfma_f32_16x16x32_bf16 v[248:251], a[84:87], a[0:3], v[248:251]
    v_cvt_pk_bf16_f32 v24, v24, v25
    v_cvt_pk_bf16_f32 v25, v26, v27
    v_mfma_f32_16x16x32_bf16 v[252:255], a[84:87], a[4:7], v[252:255]
    ds_read_b64_tr_b16 a[124:125], v10 offset:37888
    v_cvt_pk_bf16_f32 v26, v56, v57
    v_cvt_pk_bf16_f32 v27, v58, v59
    v_mfma_f32_16x16x32_bf16 a[144:147], a[84:87], a[8:11], a[144:147]
    ds_read_b64_tr_b16 a[126:127], v10 offset:38400
    buffer_store_dwordx4 v[24:27], v17, s[32:35], s57 offen offset:0 sc0 sc1
    s_add_u32 s68, s57, s59
    v_mfma_f32_16x16x32_bf16 a[148:151], a[84:87], a[12:15], a[148:151]
    v_mul_f32 v28, s67, v28
    v_mul_f32 v29, s67, v29
    v_mfma_f32_16x16x32_bf16 a[152:155], a[84:87], a[16:19], a[152:155]
    ds_read_b128 a[48:51], v1 offset:40960
    v_mul_f32 v30, s67, v30
    v_mul_f32 v31, s67, v31
    v_mfma_f32_16x16x32_bf16 a[156:159], a[84:87], a[20:23], a[156:159]
    v_mul_f32 v60, s67, v60
    v_mul_f32 v61, s67, v61
    v_mfma_f32_16x16x32_bf16 a[160:163], a[84:87], a[24:27], a[160:163]
    ds_read_b128 a[52:55], v1 offset:41984
    v_mul_f32 v62, s67, v62
    v_mul_f32 v63, s67, v63
    v_mfma_f32_16x16x32_bf16 a[164:167], a[84:87], a[28:31], a[164:167]
    ds_read_b128 a[56:59], v1 offset:43008
    v_cvt_pk_bf16_f32 v28, v28, v29
    v_cvt_pk_bf16_f32 v29, v30, v31
    v_mfma_f32_16x16x32_bf16 a[168:171], a[96:99], a[0:3], a[168:171]
    v_cvt_pk_bf16_f32 v30, v60, v61
    v_cvt_pk_bf16_f32 v31, v62, v63
    v_mfma_f32_16x16x32_bf16 a[172:175], a[96:99], a[4:7], a[172:175]
    ds_read_b128 a[60:63], v1 offset:44032
    buffer_store_dwordx4 v[28:31], v17, s[32:35], s68 offen offset:0 sc0 sc1
    s_add_u32 s57, s57, s58
    v_mfma_f32_16x16x32_bf16 a[176:179], a[96:99], a[8:11], a[176:179]
    ds_read_b64_tr_b16 a[136:137], v9 offset:38912
    v_mul_f32 v32, s67, v32
    v_mul_f32 v33, s67, v33
    v_mfma_f32_16x16x32_bf16 a[180:183], a[96:99], a[12:15], a[180:183]
    v_mul_f32 v34, s67, v34
    v_mul_f32 v35, s67, v35
    v_mfma_f32_16x16x32_bf16 a[184:187], a[96:99], a[16:19], a[184:187]
    ds_read_b64_tr_b16 a[138:139], v9 offset:39424
    v_mul_f32 v64, s67, v64
    v_mul_f32 v65, s67, v65
    v_mfma_f32_16x16x32_bf16 a[188:191], a[96:99], a[20:23], a[188:191]
    ds_read_b64_tr_b16 a[140:141], v10 offset:38912
    v_mul_f32 v66, s67, v66
    v_mul_f32 v67, s67, v67
    v_mfma_f32_16x16x32_bf16 a[192:195], a[96:99], a[24:27], a[192:195]
    v_cvt_pk_bf16_f32 v32, v32, v33
    v_cvt_pk_bf16_f32 v33, v34, v35
    v_mfma_f32_16x16x32_bf16 a[196:199], a[96:99], a[28:31], a[196:199]
    ds_read_b64_tr_b16 a[142:143], v10 offset:39424
    v_cvt_pk_bf16_f32 v34, v64, v65
    v_cvt_pk_bf16_f32 v35, v66, v67
    v_mfma_f32_16x16x32_bf16 a[200:203], a[100:103], a[0:3], a[200:203]
    buffer_store_dwordx4 v[32:35], v17, s[32:35], s57 offen offset:0 sc0 sc1
    s_add_u32 s68, s57, s59
    v_mfma_f32_16x16x32_bf16 a[204:207], a[100:103], a[4:7], a[204:207]
    v_mul_f32 v36, s67, v36
    v_mul_f32 v37, s67, v37
    v_mfma_f32_16x16x32_bf16 a[208:211], a[100:103], a[8:11], a[208:211]
    v_mul_f32 v38, s67, v38
    v_mul_f32 v39, s67, v39
    v_mfma_f32_16x16x32_bf16 a[212:215], a[100:103], a[12:15], a[212:215]
    v_mul_f32 v68, s67, v68
    v_mul_f32 v69, s67, v69
    v_mfma_f32_16x16x32_bf16 a[216:219], a[100:103], a[16:19], a[216:219]
    v_mul_f32 v70, s67, v70
    v_mul_f32 v71, s67, v71
    v_mfma_f32_16x16x32_bf16 a[220:223], a[100:103], a[20:23], a[220:223]
    v_cvt_pk_bf16_f32 v36, v36, v37
    v_cvt_pk_bf16_f32 v37, v38, v39
    v_mfma_f32_16x16x32_bf16 a[224:227], a[100:103], a[24:27], a[224:227]
    v_cvt_pk_bf16_f32 v38, v68, v69
    v_cvt_pk_bf16_f32 v39, v70, v71
    v_mfma_f32_16x16x32_bf16 a[228:231], a[100:103], a[28:31], a[228:231]
    buffer_store_dwordx4 v[36:39], v17, s[32:35], s68 offen offset:0 sc0 sc1
    s_add_u32 s57, s57, s58
    s_waitcnt lgkmcnt(0)
    v_mfma_f32_16x16x32_bf16 v[216:219], a[120:123], a[32:35], v[216:219]
    ds_read_b64_tr_b16 a[80:81], v13 offset:1024
    v_mul_f32 v40, s67, v40
    v_mul_f32 v41, s67, v41
    v_mfma_f32_16x16x32_bf16 v[220:223], a[120:123], a[36:39], v[220:223]
    ds_read_b64_tr_b16 a[82:83], v13 offset:1536
    v_mul_f32 v42, s67, v42
    v_mul_f32 v43, s67, v43
    v_mfma_f32_16x16x32_bf16 v[224:227], a[120:123], a[40:43], v[224:227]
    v_mul_f32 v72, s67, v72
    v_mul_f32 v73, s67, v73
    v_mfma_f32_16x16x32_bf16 v[228:231], a[120:123], a[44:47], v[228:231]
    ds_read_b128 a[0:3], v2 offset:0
    v_mul_f32 v74, s67, v74
    v_mfma_f32_16x16x32_bf16 v[232:235], a[120:123], a[48:51], v[232:235]
    ds_read_b128 a[4:7], v2 offset:1024
    v_mul_f32 v75, s67, v75
    v_cvt_pk_bf16_f32 v40, v40, v41
    v_mfma_f32_16x16x32_bf16 v[236:239], a[120:123], a[52:55], v[236:239]
    v_cvt_pk_bf16_f32 v41, v42, v43
    v_cvt_pk_bf16_f32 v42, v72, v73
    v_mfma_f32_16x16x32_bf16 v[240:243], a[120:123], a[56:59], v[240:243]
    ds_read_b128 a[8:11], v2 offset:2048
    v_cvt_pk_bf16_f32 v43, v74, v75
    buffer_store_dwordx4 v[40:43], v17, s[32:35], s57 offen offset:0 sc0 sc1
    v_mfma_f32_16x16x32_bf16 v[244:247], a[120:123], a[60:63], v[244:247]
    ds_read_b128 a[12:15], v2 offset:3072
    s_add_u32 s68, s57, s59
    v_mfma_f32_16x16x32_bf16 v[248:251], a[124:127], a[32:35], v[248:251]
    v_mul_f32 v44, s67, v44
    v_mul_f32 v45, s67, v45
    v_mfma_f32_16x16x32_bf16 v[252:255], a[124:127], a[36:39], v[252:255]
    ds_read_b64_tr_b16 a[84:85], v14 offset:1024
    v_mul_f32 v46, s67, v46
    v_mul_f32 v47, s67, v47
    v_mfma_f32_16x16x32_bf16 a[144:147], a[124:127], a[40:43], a[144:147]
    ds_read_b64_tr_b16 a[86:87], v14 offset:1536
    v_mul_f32 v76, s67, v76
    v_mul_f32 v77, s67, v77
    v_mfma_f32_16x16x32_bf16 a[148:151], a[124:127], a[44:47], a[148:151]
    v_mul_f32 v78, s67, v78
    v_mfma_f32_16x16x32_bf16 a[152:155], a[124:127], a[48:51], a[152:155]
    ds_read_b128 a[16:19], v2 offset:4096
    v_mul_f32 v79, s67, v79
    v_cvt_pk_bf16_f32 v44, v44, v45
    v_mfma_f32_16x16x32_bf16 a[156:159], a[124:127], a[52:55], a[156:159]
    v_cvt_pk_bf16_f32 v45, v46, v47
    v_cvt_pk_bf16_f32 v46, v76, v77
    v_mfma_f32_16x16x32_bf16 a[160:163], a[124:127], a[56:59], a[160:163]
    ds_read_b128 a[20:23], v2 offset:5120
    v_cvt_pk_bf16_f32 v47, v78, v79
    buffer_store_dwordx4 v[44:47], v17, s[32:35], s68 offen offset:0 sc0 sc1
    v_mfma_f32_16x16x32_bf16 a[164:167], a[124:127], a[60:63], a[164:167]
    ds_read_b128 a[24:27], v2 offset:6144
    s_add_u32 s57, s57, s58
    v_mfma_f32_16x16x32_bf16 a[168:171], a[136:139], a[32:35], a[168:171]
    v_mul_f32 v48, s67, v48
    v_mul_f32 v49, s67, v49
    v_mfma_f32_16x16x32_bf16 a[172:175], a[136:139], a[36:39], a[172:175]
    ds_read_b128 a[28:31], v2 offset:7168
    v_mul_f32 v50, s67, v50
    v_mul_f32 v51, s67, v51
    v_mfma_f32_16x16x32_bf16 a[176:179], a[136:139], a[40:43], a[176:179]
    ds_read_b64_tr_b16 a[96:97], v13 offset:2048
    v_mul_f32 v80, s67, v80
    v_mul_f32 v81, s67, v81
    v_mfma_f32_16x16x32_bf16 a[180:183], a[136:139], a[44:47], a[180:183]
    v_mul_f32 v82, s67, v82
    v_mfma_f32_16x16x32_bf16 a[184:187], a[136:139], a[48:51], a[184:187]
    ds_read_b64_tr_b16 a[98:99], v13 offset:2560
    v_mul_f32 v83, s67, v83
    v_cvt_pk_bf16_f32 v48, v48, v49
    v_mfma_f32_16x16x32_bf16 a[188:191], a[136:139], a[52:55], a[188:191]
    ds_read_b64_tr_b16 a[100:101], v14 offset:2048
    v_cvt_pk_bf16_f32 v49, v50, v51
    v_cvt_pk_bf16_f32 v50, v80, v81
    v_mfma_f32_16x16x32_bf16 a[192:195], a[136:139], a[56:59], a[192:195]
    v_cvt_pk_bf16_f32 v51, v82, v83
    buffer_store_dwordx4 v[48:51], v17, s[32:35], s57 offen offset:0 sc0 sc1
    v_mfma_f32_16x16x32_bf16 a[196:199], a[136:139], a[60:63], a[196:199]
    ds_read_b64_tr_b16 a[102:103], v14 offset:2560
    s_add_u32 s68, s57, s59
    v_mfma_f32_16x16x32_bf16 a[200:203], a[140:143], a[32:35], a[200:203]
    v_mul_f32 v52, s67, v52
    v_mul_f32 v53, s67, v53
    v_mfma_f32_16x16x32_bf16 a[204:207], a[140:143], a[36:39], a[204:207]
    v_mul_f32 v54, s67, v54
    v_mul_f32 v55, s67, v55
    v_mfma_f32_16x16x32_bf16 a[208:211], a[140:143], a[40:43], a[208:211]
    v_mul_f32 v84, s67, v84
    v_mul_f32 v85, s67, v85
    v_mfma_f32_16x16x32_bf16 a[212:215], a[140:143], a[44:47], a[212:215]
    v_mul_f32 v86, s67, v86
    v_mfma_f32_16x16x32_bf16 a[216:219], a[140:143], a[48:51], a[216:219]
    v_mul_f32 v87, s67, v87
    v_cvt_pk_bf16_f32 v52, v52, v53
    v_mfma_f32_16x16x32_bf16 a[220:223], a[140:143], a[52:55], a[220:223]
    v_cvt_pk_bf16_f32 v53, v54, v55
    v_cvt_pk_bf16_f32 v54, v84, v85
    v_mfma_f32_16x16x32_bf16 a[224:227], a[140:143], a[56:59], a[224:227]
    v_cvt_pk_bf16_f32 v55, v86, v87
    buffer_store_dwordx4 v[52:55], v17, s[32:35], s68 offen offset:0 sc0 sc1
    v_mfma_f32_16x16x32_bf16 a[228:231], a[140:143], a[60:63], a[228:231]
    s_add_u32 s57, s57, s58
    s_waitcnt lgkmcnt(0)
    v_mfma_f32_16x16x32_bf16 v[216:219], a[80:83], a[0:3], v[216:219]
    ds_read_b64_tr_b16 a[120:121], v13 offset:37888
    s_lshl_b32 s57, s62, 2
    s_lshl_b32 s58, s66, 1
    v_mfma_f32_16x16x32_bf16 v[220:223], a[80:83], a[4:7], v[220:223]
    ds_read_b64_tr_b16 a[122:123], v13 offset:38400
    s_add_u32 s57, s57, s58
    s_add_u32 s57, s57, s54
    v_mfma_f32_16x16x32_bf16 v[224:227], a[80:83], a[8:11], v[224:227]
    s_lshl_b32 s56, s57, 17
    s_add_u32 s56, s56, s55
    v_mfma_f32_16x16x32_bf16 v[228:231], a[80:83], a[12:15], v[228:231]
    ds_read_b128 a[32:35], v2 offset:36864
    s_add_u32 s56, s56, 12582912
    v_mfma_f32_16x16x32_bf16 v[232:235], a[80:83], a[16:19], v[232:235]
    ds_read_b128 a[36:39], v2 offset:37888
    v_mul_f32 v88, v152, v88
    v_mul_f32 v89, v153, v89
    v_mfma_f32_16x16x32_bf16 v[236:239], a[80:83], a[20:23], v[236:239]
    v_mul_f32 v90, v154, v90
    v_mul_f32 v91, v155, v91
    v_mfma_f32_16x16x32_bf16 v[240:243], a[80:83], a[24:27], v[240:243]
    ds_read_b128 a[40:43], v2 offset:38912
    v_mul_f32 v120, v184, v120
    v_mul_f32 v121, v185, v121
    v_mfma_f32_16x16x32_bf16 v[244:247], a[80:83], a[28:31], v[244:247]
    ds_read_b128 a[44:47], v2 offset:39936
    v_mul_f32 v122, v186, v122
    v_mfma_f32_16x16x32_bf16 v[248:251], a[84:87], a[0:3], v[248:251]
    v_mul_f32 v123, v187, v123
    v_cvt_pk_bf16_f32 v88, v88, v89
    v_mfma_f32_16x16x32_bf16 v[252:255], a[84:87], a[4:7], v[252:255]
    ds_read_b64_tr_b16 a[124:125], v14 offset:37888
    v_cvt_pk_bf16_f32 v89, v90, v91
    v_cvt_pk_bf16_f32 v90, v120, v121
    v_mfma_f32_16x16x32_bf16 a[144:147], a[84:87], a[8:11], a[144:147]
    ds_read_b64_tr_b16 a[126:127], v14 offset:38400
    v_cvt_pk_bf16_f32 v91, v122, v123
    buffer_store_dwordx4 v[88:91], v15, s[32:35], s56 offen offset:0 sc0 sc1
    v_mfma_f32_16x16x32_bf16 a[148:151], a[84:87], a[12:15], a[148:151]
    v_mul_f32 v92, v156, v92
    v_mfma_f32_16x16x32_bf16 a[152:155], a[84:87], a[16:19], a[152:155]
    ds_read_b128 a[48:51], v2 offset:40960
    v_mul_f32 v93, v157, v93
    v_mul_f32 v94, v158, v94
    v_mfma_f32_16x16x32_bf16 a[156:159], a[84:87], a[20:23], a[156:159]
    v_mul_f32 v95, v159, v95
    v_mul_f32 v124, v188, v124
    v_mfma_f32_16x16x32_bf16 a[160:163], a[84:87], a[24:27], a[160:163]
    ds_read_b128 a[52:55], v2 offset:41984
    v_mul_f32 v125, v189, v125
    v_mul_f32 v126, v190, v126
    v_mfma_f32_16x16x32_bf16 a[164:167], a[84:87], a[28:31], a[164:167]
    ds_read_b128 a[56:59], v2 offset:43008
    v_mul_f32 v127, v191, v127
    v_mfma_f32_16x16x32_bf16 a[168:171], a[96:99], a[0:3], a[168:171]
    v_cvt_pk_bf16_f32 v92, v92, v93
    v_cvt_pk_bf16_f32 v93, v94, v95
    v_mfma_f32_16x16x32_bf16 a[172:175], a[96:99], a[4:7], a[172:175]
    ds_read_b128 a[60:63], v2 offset:44032
    v_cvt_pk_bf16_f32 v94, v124, v125
    v_cvt_pk_bf16_f32 v95, v126, v127
    v_mfma_f32_16x16x32_bf16 a[176:179], a[96:99], a[8:11], a[176:179]
    ds_read_b64_tr_b16 a[136:137], v13 offset:38912
    buffer_store_dwordx4 v[92:95], v15, s[32:35], s56 offen offset:1024 sc0 sc1
    v_mul_f32 v96, v160, v96
    v_mfma_f32_16x16x32_bf16 a[180:183], a[96:99], a[12:15], a[180:183]
    v_mul_f32 v97, v161, v97
    v_mfma_f32_16x16x32_bf16 a[184:187], a[96:99], a[16:19], a[184:187]
    ds_read_b64_tr_b16 a[138:139], v13 offset:39424
    v_mul_f32 v98, v162, v98
    v_mul_f32 v99, v163, v99
    v_mfma_f32_16x16x32_bf16 a[188:191], a[96:99], a[20:23], a[188:191]
    ds_read_b64_tr_b16 a[140:141], v14 offset:38912
    v_mul_f32 v128, v192, v128
    v_mul_f32 v129, v193, v129
    v_mfma_f32_16x16x32_bf16 a[192:195], a[96:99], a[24:27], a[192:195]
    v_mul_f32 v130, v194, v130
    v_mul_f32 v131, v195, v131
    v_mfma_f32_16x16x32_bf16 a[196:199], a[96:99], a[28:31], a[196:199]
    ds_read_b64_tr_b16 a[142:143], v14 offset:39424
    v_cvt_pk_bf16_f32 v96, v96, v97
    v_mfma_f32_16x16x32_bf16 a[200:203], a[100:103], a[0:3], a[200:203]
    v_cvt_pk_bf16_f32 v97, v98, v99
    v_cvt_pk_bf16_f32 v98, v128, v129
    v_mfma_f32_16x16x32_bf16 a[204:207], a[100:103], a[4:7], a[204:207]
    v_cvt_pk_bf16_f32 v99, v130, v131
    buffer_store_dwordx4 v[96:99], v15, s[32:35], s56 offen offset:2048 sc0 sc1
    v_mfma_f32_16x16x32_bf16 a[208:211], a[100:103], a[8:11], a[208:211]
    v_mul_f32 v100, v164, v100
    v_mul_f32 v101, v165, v101
    v_mfma_f32_16x16x32_bf16 a[212:215], a[100:103], a[12:15], a[212:215]
    v_mul_f32 v102, v166, v102
    v_mfma_f32_16x16x32_bf16 a[216:219], a[100:103], a[16:19], a[216:219]
    v_mul_f32 v103, v167, v103
    v_mul_f32 v132, v196, v132
    v_mfma_f32_16x16x32_bf16 a[220:223], a[100:103], a[20:23], a[220:223]
    v_mul_f32 v133, v197, v133
    v_mul_f32 v134, v198, v134
    v_mfma_f32_16x16x32_bf16 a[224:227], a[100:103], a[24:27], a[224:227]
    v_mul_f32 v135, v199, v135
    v_cvt_pk_bf16_f32 v100, v100, v101
    v_mfma_f32_16x16x32_bf16 a[228:231], a[100:103], a[28:31], a[228:231]
    v_cvt_pk_bf16_f32 v101, v102, v103
    s_waitcnt lgkmcnt(0)
    v_mfma_f32_16x16x32_bf16 v[216:219], a[120:123], a[32:35], v[216:219]
    v_cvt_pk_bf16_f32 v102, v132, v133
    v_cvt_pk_bf16_f32 v103, v134, v135
    v_mfma_f32_16x16x32_bf16 v[220:223], a[120:123], a[36:39], v[220:223]
    buffer_store_dwordx4 v[100:103], v15, s[32:35], s56 offen offset:3072 sc0 sc1
    s_add_u32 s56, s56, 4096
    v_mfma_f32_16x16x32_bf16 v[224:227], a[120:123], a[40:43], v[224:227]
    v_mul_f32 v104, v168, v104
    v_mul_f32 v105, v169, v105
    v_mfma_f32_16x16x32_bf16 v[228:231], a[120:123], a[44:47], v[228:231]
    v_mul_f32 v106, v170, v106
    v_mfma_f32_16x16x32_bf16 v[232:235], a[120:123], a[48:51], v[232:235]
    v_mul_f32 v107, v171, v107
    v_mul_f32 v136, v200, v136
    v_mfma_f32_16x16x32_bf16 v[236:239], a[120:123], a[52:55], v[236:239]
    v_mul_f32 v137, v201, v137
    v_mul_f32 v138, v202, v138
    v_mfma_f32_16x16x32_bf16 v[240:243], a[120:123], a[56:59], v[240:243]
    v_mul_f32 v139, v203, v139
    v_cvt_pk_bf16_f32 v104, v104, v105
    v_mfma_f32_16x16x32_bf16 v[244:247], a[120:123], a[60:63], v[244:247]
    v_cvt_pk_bf16_f32 v105, v106, v107
    v_mfma_f32_16x16x32_bf16 v[248:251], a[124:127], a[32:35], v[248:251]
    v_cvt_pk_bf16_f32 v106, v136, v137
    v_cvt_pk_bf16_f32 v107, v138, v139
    v_mfma_f32_16x16x32_bf16 v[252:255], a[124:127], a[36:39], v[252:255]
    buffer_store_dwordx4 v[104:107], v15, s[32:35], s56 offen offset:0 sc0 sc1
    v_mul_f32 v108, v172, v108
    v_mfma_f32_16x16x32_bf16 a[144:147], a[124:127], a[40:43], a[144:147]
    v_mul_f32 v109, v173, v109
    v_mul_f32 v110, v174, v110
    v_mfma_f32_16x16x32_bf16 a[148:151], a[124:127], a[44:47], a[148:151]
    v_mul_f32 v111, v175, v111
    v_mfma_f32_16x16x32_bf16 a[152:155], a[124:127], a[48:51], a[152:155]
    v_mul_f32 v140, v204, v140
    v_mul_f32 v141, v205, v141
    v_mfma_f32_16x16x32_bf16 a[156:159], a[124:127], a[52:55], a[156:159]
    v_mul_f32 v142, v206, v142
    v_mul_f32 v143, v207, v143
    v_mfma_f32_16x16x32_bf16 a[160:163], a[124:127], a[56:59], a[160:163]
    v_cvt_pk_bf16_f32 v108, v108, v109
    v_cvt_pk_bf16_f32 v109, v110, v111
    v_mfma_f32_16x16x32_bf16 a[164:167], a[124:127], a[60:63], a[164:167]
    v_cvt_pk_bf16_f32 v110, v140, v141
    v_mfma_f32_16x16x32_bf16 a[168:171], a[136:139], a[32:35], a[168:171]
    v_cvt_pk_bf16_f32 v111, v142, v143
    buffer_store_dwordx4 v[108:111], v15, s[32:35], s56 offen offset:1024 sc0 sc1
    v_mfma_f32_16x16x32_bf16 a[172:175], a[136:139], a[36:39], a[172:175]
    v_mul_f32 v112, v176, v112
    v_mul_f32 v113, v177, v113
    v_mfma_f32_16x16x32_bf16 a[176:179], a[136:139], a[40:43], a[176:179]
    v_mul_f32 v114, v178, v114
    v_mul_f32 v115, v179, v115
    v_mfma_f32_16x16x32_bf16 a[180:183], a[136:139], a[44:47], a[180:183]
    v_mul_f32 v144, v208, v144
    v_mfma_f32_16x16x32_bf16 a[184:187], a[136:139], a[48:51], a[184:187]
    v_mul_f32 v145, v209, v145
    v_mul_f32 v146, v210, v146
    v_mfma_f32_16x16x32_bf16 a[188:191], a[136:139], a[52:55], a[188:191]
    v_mul_f32 v147, v211, v147
    v_cvt_pk_bf16_f32 v112, v112, v113
    v_mfma_f32_16x16x32_bf16 a[192:195], a[136:139], a[56:59], a[192:195]
    v_cvt_pk_bf16_f32 v113, v114, v115
    v_cvt_pk_bf16_f32 v114, v144, v145
    v_mfma_f32_16x16x32_bf16 a[196:199], a[136:139], a[60:63], a[196:199]
    v_cvt_pk_bf16_f32 v115, v146, v147
    v_mfma_f32_16x16x32_bf16 a[200:203], a[140:143], a[32:35], a[200:203]
    buffer_store_dwordx4 v[112:115], v15, s[32:35], s56 offen offset:2048 sc0 sc1
    v_mul_f32 v116, v180, v116
    v_mfma_f32_16x16x32_bf16 a[204:207], a[140:143], a[36:39], a[204:207]
    v_mul_f32 v117, v181, v117
    v_mul_f32 v118, v182, v118
    v_mfma_f32_16x16x32_bf16 a[208:211], a[140:143], a[40:43], a[208:211]
    v_mul_f32 v119, v183, v119
    v_mul_f32 v148, v212, v148
    v_mfma_f32_16x16x32_bf16 a[212:215], a[140:143], a[44:47], a[212:215]
    v_mul_f32 v149, v213, v149
    v_mfma_f32_16x16x32_bf16 a[216:219], a[140:143], a[48:51], a[216:219]
    v_mul_f32 v150, v214, v150
    v_mul_f32 v151, v215, v151
    v_mfma_f32_16x16x32_bf16 a[220:223], a[140:143], a[52:55], a[220:223]
    v_cvt_pk_bf16_f32 v116, v116, v117
    v_cvt_pk_bf16_f32 v117, v118, v119
    v_mfma_f32_16x16x32_bf16 a[224:227], a[140:143], a[56:59], a[224:227]
    v_cvt_pk_bf16_f32 v118, v148, v149
    v_cvt_pk_bf16_f32 v119, v150, v151
    v_mfma_f32_16x16x32_bf16 a[228:231], a[140:143], a[60:63], a[228:231]
    buffer_store_dwordx4 v[116:119], v15, s[32:35], s56 offen offset:3072 sc0 sc1
    s_nop 7
    s_add_u32 s57, s57, 1
    s_lshl_b32 s56, s57, 17
    s_add_u32 s56, s56, s55
    s_add_u32 s56, s56, 12582912
    v_accvgpr_read_b32 v24, a168
    v_accvgpr_read_b32 v25, a169
    v_accvgpr_read_b32 v26, a170
    v_accvgpr_read_b32 v27, a171
    v_accvgpr_read_b32 v28, a200
    v_accvgpr_read_b32 v29, a201
    v_accvgpr_read_b32 v30, a202
    v_accvgpr_read_b32 v31, a203
    v_mul_f32 v216, v24, v216
    v_mul_f32 v217, v25, v217
    v_mul_f32 v218, v26, v218
    v_mul_f32 v219, v27, v219
    v_mul_f32 v248, v28, v248
    v_mul_f32 v249, v29, v249
    v_mul_f32 v250, v30, v250
    v_mul_f32 v251, v31, v251
    v_cvt_pk_bf16_f32 v216, v216, v217
    v_cvt_pk_bf16_f32 v217, v218, v219
    v_cvt_pk_bf16_f32 v218, v248, v249
    v_cvt_pk_bf16_f32 v219, v250, v251
    buffer_store_dwordx4 v[216:219], v15, s[32:35], s56 offen offset:0 sc0 sc1
    v_accvgpr_read_b32 v32, a172
    v_accvgpr_read_b32 v33, a173
    v_accvgpr_read_b32 v34, a174
    v_accvgpr_read_b32 v35, a175
    v_accvgpr_read_b32 v36, a204
    v_accvgpr_read_b32 v37, a205
    v_accvgpr_read_b32 v38, a206
    v_accvgpr_read_b32 v39, a207
    v_mul_f32 v220, v32, v220
    v_mul_f32 v221, v33, v221
    v_mul_f32 v222, v34, v222
    v_mul_f32 v223, v35, v223
    v_mul_f32 v252, v36, v252
    v_mul_f32 v253, v37, v253
    v_mul_f32 v254, v38, v254
    v_mul_f32 v255, v39, v255
    v_cvt_pk_bf16_f32 v220, v220, v221
    v_cvt_pk_bf16_f32 v221, v222, v223
    v_cvt_pk_bf16_f32 v222, v252, v253
    v_cvt_pk_bf16_f32 v223, v254, v255
    buffer_store_dwordx4 v[220:223], v15, s[32:35], s56 offen offset:1024 sc0 sc1
    v_accvgpr_read_b32 v40, a144
    v_accvgpr_read_b32 v41, a145
    v_accvgpr_read_b32 v42, a146
    v_accvgpr_read_b32 v43, a147
    v_accvgpr_read_b32 v44, a176
    v_accvgpr_read_b32 v45, a177
    v_accvgpr_read_b32 v46, a178
    v_accvgpr_read_b32 v47, a179
    v_accvgpr_read_b32 v48, a208
    v_accvgpr_read_b32 v49, a209
    v_accvgpr_read_b32 v50, a210
    v_accvgpr_read_b32 v51, a211
    v_mul_f32 v224, v44, v224
    v_mul_f32 v225, v45, v225
    v_mul_f32 v226, v46, v226
    v_mul_f32 v227, v47, v227
    v_mul_f32 v40, v48, v40
    v_mul_f32 v41, v49, v41
    v_mul_f32 v42, v50, v42
    v_mul_f32 v43, v51, v43
    v_cvt_pk_bf16_f32 v224, v224, v225
    v_cvt_pk_bf16_f32 v225, v226, v227
    v_cvt_pk_bf16_f32 v226, v40, v41
    v_cvt_pk_bf16_f32 v227, v42, v43
    buffer_store_dwordx4 v[224:227], v15, s[32:35], s56 offen offset:2048 sc0 sc1
    v_accvgpr_read_b32 v52, a148
    v_accvgpr_read_b32 v53, a149
    v_accvgpr_read_b32 v54, a150
    v_accvgpr_read_b32 v55, a151
    v_accvgpr_read_b32 v24, a180
    v_accvgpr_read_b32 v25, a181
    v_accvgpr_read_b32 v26, a182
    v_accvgpr_read_b32 v27, a183
    v_accvgpr_read_b32 v28, a212
    v_accvgpr_read_b32 v29, a213
    v_accvgpr_read_b32 v30, a214
    v_accvgpr_read_b32 v31, a215
    v_mul_f32 v228, v24, v228
    v_mul_f32 v229, v25, v229
    v_mul_f32 v230, v26, v230
    v_mul_f32 v231, v27, v231
    v_mul_f32 v52, v28, v52
    v_mul_f32 v53, v29, v53
    v_mul_f32 v54, v30, v54
    v_mul_f32 v55, v31, v55
    v_cvt_pk_bf16_f32 v228, v228, v229
    v_cvt_pk_bf16_f32 v229, v230, v231
    v_cvt_pk_bf16_f32 v230, v52, v53
    v_cvt_pk_bf16_f32 v231, v54, v55
    buffer_store_dwordx4 v[228:231], v15, s[32:35], s56 offen offset:3072 sc0 sc1
    s_add_u32 s56, s56, 4096
    v_accvgpr_read_b32 v32, a152
    v_accvgpr_read_b32 v33, a153
    v_accvgpr_read_b32 v34, a154
    v_accvgpr_read_b32 v35, a155
    v_accvgpr_read_b32 v36, a184
    v_accvgpr_read_b32 v37, a185
    v_accvgpr_read_b32 v38, a186
    v_accvgpr_read_b32 v39, a187
    v_accvgpr_read_b32 v40, a216
    v_accvgpr_read_b32 v41, a217
    v_accvgpr_read_b32 v42, a218
    v_accvgpr_read_b32 v43, a219
    v_mul_f32 v232, v36, v232
    v_mul_f32 v233, v37, v233
    v_mul_f32 v234, v38, v234
    v_mul_f32 v235, v39, v235
    v_mul_f32 v32, v40, v32
    v_mul_f32 v33, v41, v33
    v_mul_f32 v34, v42, v34
    v_mul_f32 v35, v43, v35
    v_cvt_pk_bf16_f32 v232, v232, v233
    v_cvt_pk_bf16_f32 v233, v234, v235
    v_cvt_pk_bf16_f32 v234, v32, v33
    v_cvt_pk_bf16_f32 v235, v34, v35
    buffer_store_dwordx4 v[232:235], v15, s[32:35], s56 offen offset:0 sc0 sc1
    v_accvgpr_read_b32 v44, a156
    v_accvgpr_read_b32 v45, a157
    v_accvgpr_read_b32 v46, a158
    v_accvgpr_read_b32 v47, a159
    v_accvgpr_read_b32 v48, a188
    v_accvgpr_read_b32 v49, a189
    v_accvgpr_read_b32 v50, a190
    v_accvgpr_read_b32 v51, a191
    v_accvgpr_read_b32 v52, a220
    v_accvgpr_read_b32 v53, a221
    v_accvgpr_read_b32 v54, a222
    v_accvgpr_read_b32 v55, a223
    v_mul_f32 v236, v48, v236
    v_mul_f32 v237, v49, v237
    v_mul_f32 v238, v50, v238
    v_mul_f32 v239, v51, v239
    v_mul_f32 v44, v52, v44
    v_mul_f32 v45, v53, v45
    v_mul_f32 v46, v54, v46
    v_mul_f32 v47, v55, v47
    v_cvt_pk_bf16_f32 v236, v236, v237
    v_cvt_pk_bf16_f32 v237, v238, v239
    v_cvt_pk_bf16_f32 v238, v44, v45
    v_cvt_pk_bf16_f32 v239, v46, v47
    buffer_store_dwordx4 v[236:239], v15, s[32:35], s56 offen offset:1024 sc0 sc1
    v_accvgpr_read_b32 v24, a160
    v_accvgpr_read_b32 v25, a161
    v_accvgpr_read_b32 v26, a162
    v_accvgpr_read_b32 v27, a163
    v_accvgpr_read_b32 v28, a192
    v_accvgpr_read_b32 v29, a193
    v_accvgpr_read_b32 v30, a194
    v_accvgpr_read_b32 v31, a195
    v_accvgpr_read_b32 v32, a224
    v_accvgpr_read_b32 v33, a225
    v_accvgpr_read_b32 v34, a226
    v_accvgpr_read_b32 v35, a227
    v_mul_f32 v240, v28, v240
    v_mul_f32 v241, v29, v241
    v_mul_f32 v242, v30, v242
    v_mul_f32 v243, v31, v243
    v_mul_f32 v24, v32, v24
    v_mul_f32 v25, v33, v25
    v_mul_f32 v26, v34, v26
    v_mul_f32 v27, v35, v27
    v_cvt_pk_bf16_f32 v240, v240, v241
    v_cvt_pk_bf16_f32 v241, v242, v243
    v_cvt_pk_bf16_f32 v242, v24, v25
    v_cvt_pk_bf16_f32 v243, v26, v27
    buffer_store_dwordx4 v[240:243], v15, s[32:35], s56 offen offset:2048 sc0 sc1
    v_accvgpr_read_b32 v36, a164
    v_accvgpr_read_b32 v37, a165
    v_accvgpr_read_b32 v38, a166
    v_accvgpr_read_b32 v39, a167
    v_accvgpr_read_b32 v40, a196
    v_accvgpr_read_b32 v41, a197
    v_accvgpr_read_b32 v42, a198
    v_accvgpr_read_b32 v43, a199
    v_accvgpr_read_b32 v44, a228
    v_accvgpr_read_b32 v45, a229
    v_accvgpr_read_b32 v46, a230
    v_accvgpr_read_b32 v47, a231
    v_mul_f32 v244, v40, v244
    v_mul_f32 v245, v41, v245
    v_mul_f32 v246, v42, v246
    v_mul_f32 v247, v43, v247
    v_mul_f32 v36, v44, v36
    v_mul_f32 v37, v45, v37
    v_mul_f32 v38, v46, v38
    v_mul_f32 v39, v47, v39
    v_cvt_pk_bf16_f32 v244, v244, v245
    v_cvt_pk_bf16_f32 v245, v246, v247
    v_cvt_pk_bf16_f32 v246, v36, v37
    v_cvt_pk_bf16_f32 v247, v38, v39
    buffer_store_dwordx4 v[244:247], v15, s[32:35], s56 offen offset:3072 sc0 sc1
    s_waitcnt vmcnt(0)
    v_readfirstlane_b32 s58, v23
    s_cmp_lg_u32 s58, 255
    s_cbranch_scc1 L_gemm1_kernel_neA
    v_mov_b32 v22, 32768
    v_mov_b32 v23, s69
    s_mov_b64 exec, 1
    buffer_store_dword v23, v22, s[36:39], 0 offen sc0 sc1
    s_mov_b64 exec, -1
L_gemm1_kernel_neA:
    s_endpgm
L_gemm1_kernel_B:
    s_add_u32 m0, s45, 0
    s_nop 0
    buffer_load_dwordx4 v16, s[12:15], s41 offen lds
    buffer_load_dwordx4 v16, s[16:19], s41 offen offset:1024 lds
    buffer_load_dwordx4 v16, s[20:23], s41 offen offset:2048 lds
    buffer_load_dwordx4 v17, s[24:27], s42 offen offset:3072 lds
    s_add_u32 m0, s45, 4096
    s_nop 0
    s_add_u32 s41, s41, 196608
    buffer_load_dwordx4 v17, s[28:31], s42 offen lds
    s_add_u32 s42, s42, 229376
    s_mov_b32 s57, 0x3f803f80
    v_mov_b32 v90, s57
    v_mov_b32 v72, 0
    v_mov_b32 v73, 0
    v_mov_b32 v74, 0
    v_mov_b32 v75, 0
    v_mov_b32 v76, 0
    v_mov_b32 v77, 0
    v_mov_b32 v78, 0
    v_mov_b32 v79, 0
    s_waitcnt vmcnt(8)
    v_dot2_f32_bf16 v72, v24, v90, v72
    v_dot2_f32_bf16 v76, v24, v24, v76
    v_dot2_f32_bf16 v73, v25, v90, v73
    v_dot2_f32_bf16 v77, v25, v25, v77
    v_dot2_f32_bf16 v74, v26, v90, v74
    v_dot2_f32_bf16 v78, v26, v26, v78
    v_dot2_f32_bf16 v75, v27, v90, v75
    v_dot2_f32_bf16 v79, v27, v27, v79
    s_waitcnt vmcnt(7)
    v_dot2_f32_bf16 v72, v28, v90, v72
    v_dot2_f32_bf16 v76, v28, v28, v76
    v_dot2_f32_bf16 v73, v29, v90, v73
    v_dot2_f32_bf16 v77, v29, v29, v77
    v_dot2_f32_bf16 v74, v30, v90, v74
    v_dot2_f32_bf16 v78, v30, v30, v78
    v_dot2_f32_bf16 v75, v31, v90, v75
    v_dot2_f32_bf16 v79, v31, v31, v79
    s_waitcnt vmcnt(6)
    v_dot2_f32_bf16 v72, v32, v90, v72
    v_dot2_f32_bf16 v76, v32, v32, v76
    v_dot2_f32_bf16 v73, v33, v90, v73
    v_dot2_f32_bf16 v77, v33, v33, v77
    v_dot2_f32_bf16 v74, v34, v90, v74
    v_dot2_f32_bf16 v78, v34, v34, v78
    v_dot2_f32_bf16 v75, v35, v90, v75
    v_dot2_f32_bf16 v79, v35, v35, v79
    s_waitcnt vmcnt(5)
    v_dot2_f32_bf16 v72, v36, v90, v72
    v_dot2_f32_bf16 v76, v36, v36, v76
    v_dot2_f32_bf16 v73, v37, v90, v73
    v_dot2_f32_bf16 v77, v37, v37, v77
    v_dot2_f32_bf16 v74, v38, v90, v74
    v_dot2_f32_bf16 v78, v38, v38, v78
    v_dot2_f32_bf16 v75, v39, v90, v75
    v_dot2_f32_bf16 v79, v39, v39, v79
    v_lshlrev_b32 v40, 16, v24
    v_and_b32 v41, 0xffff0000, v24
    v_lshlrev_b32 v42, 16, v25
    v_pk_add_f32 v[72:73], v[72:73], v[74:75]
    v_pk_add_f32 v[76:77], v[76:77], v[78:79]
    v_and_b32 v43, 0xffff0000, v25
    v_add_f32 v72, v72, v73
    v_add_f32 v73, v76, v77
    v_mov_b32 v74, v72
    v_mov_b32 v75, v73
    v_lshlrev_b32 v44, 16, v26
    v_and_b32 v45, 0xffff0000, v26
    v_permlane32_swap_b32 v72, v74
    v_permlane32_swap_b32 v73, v75
    v_lshlrev_b32 v46, 16, v27
    v_and_b32 v47, 0xffff0000, v27
    v_pk_add_f32 v[72:73], v[72:73], v[74:75]
    v_mov_b32 v74, v72
    v_mov_b32 v75, v73
    v_lshlrev_b32 v48, 16, v28
    v_and_b32 v49, 0xffff0000, v28
    v_permlane16_swap_b32 v72, v74
    v_permlane16_swap_b32 v73, v75
    v_lshlrev_b32 v50, 16, v29
    v_and_b32 v51, 0xffff0000, v29
    v_pk_add_f32 v[72:73], v[72:73], v[74:75]
    v_lshlrev_b32 v52, 16, v30
    v_and_b32 v53, 0xffff0000, v30
    v_add_f32_dpp v72, v72, v72 row_ror:8 row_mask:0xf bank_mask:0xf
    v_add_f32_dpp v73, v73, v73 row_ror:8 row_mask:0xf bank_mask:0xf
    ds_write_b32 v92, v72
    ds_write_b32 v92, v73 offset:256
    v_lshlrev_b32 v54, 16, v31
    v_and_b32 v55, 0xffff0000, v31
    v_lshlrev_b32 v56, 16, v32
    v_and_b32 v57, 0xffff0000, v32
    v_lshlrev_b32 v58, 16, v33
    v_and_b32 v59, 0xffff0000, v33
    v_lshlrev_b32 v60, 16, v34
    v_and_b32 v61, 0xffff0000, v34
    v_lshlrev_b32 v62, 16, v35
    v_and_b32 v63, 0xffff0000, v35
    s_waitcnt lgkmcnt(0)
    s_barrier
    ds_read_b128 v[72:75], v93
    ds_read_b128 v[76:79], v93 offset:256
    v_lshlrev_b32 v64, 16, v36
    v_and_b32 v65, 0xffff0000, v36
    v_lshlrev_b32 v66, 16, v37
    v_and_b32 v67, 0xffff0000, v37
    v_lshlrev_b32 v68, 16, v38
    v_and_b32 v69, 0xffff0000, v38
    v_lshlrev_b32 v70, 16, v39
    v_and_b32 v71, 0xffff0000, v39
    s_waitcnt lgkmcnt(0)
    v_pk_add_f32 v[72:73], v[72:73], v[74:75]
    v_pk_add_f32 v[76:77], v[76:77], v[78:79]
    v_add_f32 v88, v72, v73
    v_add_f32 v89, v76, v77
    v_mul_f32 v88, 0x3a800000, v88
    v_mul_f32 v89, 0x3a800000, v89
    v_fma_f32 v89, -v88, v88, v89
    v_max_f32 v89, 0, v89
    v_cvt_pk_bf16_f32 v89, v89, v88
    v_and_b32 v88, 0xffff0000, v89
    v_lshlrev_b32 v89, 16, v89
    v_add_f32 v89, 0x3727c5ac, v89
    v_cvt_pk_bf16_f32 v89, v89, v89
    v_lshlrev_b32 v89, 16, v89
    v_sqrt_f32 v89, v89
    v_xor_b32 v88, 0x80000000, v88
    v_cvt_pk_bf16_f32 v89, v89, v89
    v_lshlrev_b32 v89, 16, v89
    v_rcp_f32 v89, v89
    s_nop 0
    v_pk_add_f32 v[40:41], v[40:41], v[88:89] op_sel_hi:[1,0]
    v_pk_add_f32 v[42:43], v[42:43], v[88:89] op_sel_hi:[1,0]
    v_pk_add_f32 v[44:45], v[44:45], v[88:89] op_sel_hi:[1,0]
    v_pk_add_f32 v[46:47], v[46:47], v[88:89] op_sel_hi:[1,0]
    v_cvt_pk_bf16_f32 v24, v40, v41
    v_cvt_pk_bf16_f32 v25, v42, v43
    v_cvt_pk_bf16_f32 v26, v44, v45
    v_cvt_pk_bf16_f32 v27, v46, v47
    v_lshlrev_b32 v40, 16, v24
    v_and_b32 v41, 0xffff0000, v24
    v_lshlrev_b32 v42, 16, v25
    v_and_b32 v43, 0xffff0000, v25
    v_lshlrev_b32 v44, 16, v26
    v_and_b32 v45, 0xffff0000, v26
    v_lshlrev_b32 v46, 16, v27
    v_and_b32 v47, 0xffff0000, v27
    v_pk_mul_f32 v[40:41], v[40:41], v[88:89] op_sel:[0,1] op_sel_hi:[1,1]
    v_pk_mul_f32 v[42:43], v[42:43], v[88:89] op_sel:[0,1] op_sel_hi:[1,1]
    v_pk_mul_f32 v[44:45], v[44:45], v[88:89] op_sel:[0,1] op_sel_hi:[1,1]
    v_pk_mul_f32 v[46:47], v[46:47], v[88:89] op_sel:[0,1] op_sel_hi:[1,1]
    v_cvt_pk_bf16_f32 v24, v40, v41
    v_cvt_pk_bf16_f32 v25, v42, v43
    v_cvt_pk_bf16_f32 v26, v44, v45
    v_cvt_pk_bf16_f32 v27, v46, v47
    buffer_store_dwordx4 v[24:27], v91, s[8:11], s43 offen sc0 sc1
    s_add_u32 s43, s43, 1048576
    v_pk_add_f32 v[48:49], v[48:49], v[88:89] op_sel_hi:[1,0]
    v_pk_add_f32 v[50:51], v[50:51], v[88:89] op_sel_hi:[1,0]
    v_pk_add_f32 v[52:53], v[52:53], v[88:89] op_sel_hi:[1,0]
    v_pk_add_f32 v[54:55], v[54:55], v[88:89] op_sel_hi:[1,0]
    v_cvt_pk_bf16_f32 v28, v48, v49
    v_cvt_pk_bf16_f32 v29, v50, v51
    v_cvt_pk_bf16_f32 v30, v52, v53
    v_cvt_pk_bf16_f32 v31, v54, v55
    v_lshlrev_b32 v48, 16, v28
    v_and_b32 v49, 0xffff0000, v28
    v_lshlrev_b32 v50, 16, v29
    v_and_b32 v51, 0xffff0000, v29
    v_lshlrev_b32 v52, 16, v30
    v_and_b32 v53, 0xffff0000, v30
    v_lshlrev_b32 v54, 16, v31
    v_and_b32 v55, 0xffff0000, v31
    v_pk_mul_f32 v[48:49], v[48:49], v[88:89] op_sel:[0,1] op_sel_hi:[1,1]
    v_pk_mul_f32 v[50:51], v[50:51], v[88:89] op_sel:[0,1] op_sel_hi:[1,1]
    v_pk_mul_f32 v[52:53], v[52:53], v[88:89] op_sel:[0,1] op_sel_hi:[1,1]
    v_pk_mul_f32 v[54:55], v[54:55], v[88:89] op_sel:[0,1] op_sel_hi:[1,1]
    v_cvt_pk_bf16_f32 v28, v48, v49
    v_cvt_pk_bf16_f32 v29, v50, v51
    v_cvt_pk_bf16_f32 v30, v52, v53
    v_cvt_pk_bf16_f32 v31, v54, v55
    buffer_store_dwordx4 v[28:31], v91, s[8:11], s43 offen sc0 sc1
    s_add_u32 s43, s43, 1048576
    v_pk_add_f32 v[56:57], v[56:57], v[88:89] op_sel_hi:[1,0]
    v_pk_add_f32 v[58:59], v[58:59], v[88:89] op_sel_hi:[1,0]
    v_pk_add_f32 v[60:61], v[60:61], v[88:89] op_sel_hi:[1,0]
    v_pk_add_f32 v[62:63], v[62:63], v[88:89] op_sel_hi:[1,0]
    v_cvt_pk_bf16_f32 v32, v56, v57
    v_cvt_pk_bf16_f32 v33, v58, v59
    v_cvt_pk_bf16_f32 v34, v60, v61
    v_cvt_pk_bf16_f32 v35, v62, v63
    v_lshlrev_b32 v56, 16, v32
    v_and_b32 v57, 0xffff0000, v32
    v_lshlrev_b32 v58, 16, v33
    v_and_b32 v59, 0xffff0000, v33
    v_lshlrev_b32 v60, 16, v34
    v_and_b32 v61, 0xffff0000, v34
    v_lshlrev_b32 v62, 16, v35
    v_and_b32 v63, 0xffff0000, v35
    v_pk_mul_f32 v[56:57], v[56:57], v[88:89] op_sel:[0,1] op_sel_hi:[1,1]
    v_pk_mul_f32 v[58:59], v[58:59], v[88:89] op_sel:[0,1] op_sel_hi:[1,1]
    v_pk_mul_f32 v[60:61], v[60:61], v[88:89] op_sel:[0,1] op_sel_hi:[1,1]
    v_pk_mul_f32 v[62:63], v[62:63], v[88:89] op_sel:[0,1] op_sel_hi:[1,1]
    v_cvt_pk_bf16_f32 v32, v56, v57
    v_cvt_pk_bf16_f32 v33, v58, v59
    v_cvt_pk_bf16_f32 v34, v60, v61
    v_cvt_pk_bf16_f32 v35, v62, v63
    buffer_store_dwordx4 v[32:35], v91, s[8:11], s43 offen sc0 sc1
    s_add_u32 s43, s43, 1048576
    v_pk_add_f32 v[64:65], v[64:65], v[88:89] op_sel_hi:[1,0]
    v_pk_add_f32 v[66:67], v[66:67], v[88:89] op_sel_hi:[1,0]
    v_pk_add_f32 v[68:69], v[68:69], v[88:89] op_sel_hi:[1,0]
    v_pk_add_f32 v[70:71], v[70:71], v[88:89] op_sel_hi:[1,0]
    v_cvt_pk_bf16_f32 v36, v64, v65
    v_cvt_pk_bf16_f32 v37, v66, v67
    v_cvt_pk_bf16_f32 v38, v68, v69
    v_cvt_pk_bf16_f32 v39, v70, v71
    v_lshlrev_b32 v64, 16, v36
    v_and_b32 v65, 0xffff0000, v36
    v_lshlrev_b32 v66, 16, v37
    v_and_b32 v67, 0xffff0000, v37
    v_lshlrev_b32 v68, 16, v38
    v_and_b32 v69, 0xffff0000, v38
    v_lshlrev_b32 v70, 16, v39
    v_and_b32 v71, 0xffff0000, v39
    v_pk_mul_f32 v[64:65], v[64:65], v[88:89] op_sel:[0,1] op_sel_hi:[1,1]
    v_pk_mul_f32 v[66:67], v[66:67], v[88:89] op_sel:[0,1] op_sel_hi:[1,1]
    v_pk_mul_f32 v[68:69], v[68:69], v[88:89] op_sel:[0,1] op_sel_hi:[1,1]
    v_pk_mul_f32 v[70:71], v[70:71], v[88:89] op_sel:[0,1] op_sel_hi:[1,1]
    v_cvt_pk_bf16_f32 v36, v64, v65
    v_cvt_pk_bf16_f32 v37, v66, v67
    v_cvt_pk_bf16_f32 v38, v68, v69
    v_cvt_pk_bf16_f32 v39, v70, v71
    buffer_store_dwordx4 v[36:39], v91, s[8:11], s43 offen sc0 sc1
    s_add_u32 s69, s69, 1
    s_lshl_b32 s57, s2, 7
    v_mov_b32 v22, 0
    v_mov_b32 v23, s69
    s_waitcnt vmcnt(0)
    s_barrier
    s_cmp_lg_u32 s64, 0
    s_cbranch_scc1 L_gemm1_kernel_nfB
    s_mov_b64 exec, 1
    buffer_store_dword v23, v22, s[36:39], s57 offen sc0 sc1
    s_mov_b64 exec, -1
L_gemm1_kernel_nfB:
    s_add_u32 m0, s45, 36864
    s_nop 0
    buffer_load_dwordx4 v16, s[12:15], s41 offen lds
    buffer_load_dwordx4 v16, s[16:19], s41 offen offset:1024 lds
    buffer_load_dwordx4 v16, s[20:23], s41 offen offset:2048 lds
    buffer_load_dwordx4 v17, s[24:27], s42 offen offset:3072 lds
    s_add_u32 m0, s45, 40960
    s_nop 0
    s_add_u32 s41, s41, 196608
    buffer_load_dwordx4 v17, s[28:31], s42 offen lds
    s_add_u32 s42, s42, 229376
    s_add_u32 m0, s45, 73728
    s_nop 0
    buffer_load_dwordx4 v16, s[12:15], s41 offen lds
    buffer_load_dwordx4 v16, s[16:19], s41 offen offset:1024 lds
    buffer_load_dwordx4 v16, s[20:23], s41 offen offset:2048 lds
    buffer_load_dwordx4 v17, s[24:27], s42 offen offset:3072 lds
    s_add_u32 m0, s45, 77824
    s_nop 0
    s_add_u32 s41, s41, 196608
    buffer_load_dwordx4 v17, s[28:31], s42 offen lds
    s_add_u32 s42, s42, 229376
    v_and_b32 v23, 31, v0
    v_lshlrev_b32 v23, 7, v23
    s_lshl_b32 s57, s63, 12
    buffer_load_dword v22, v23, s[36:39], s57 offen sc0 sc1
    v_mov_b32 v24, 0
    v_mov_b32 v25, 0
    v_mov_b32 v26, 0
    v_mov_b32 v27, 0
    v_mov_b32 v28, 0
    v_mov_b32 v29, 0
    v_mov_b32 v30, 0
    v_mov_b32 v31, 0
    v_mov_b32 v32, 0
    v_mov_b32 v33, 0
    v_mov_b32 v34, 0
    v_mov_b32 v35, 0
    v_mov_b32 v36, 0
    v_mov_b32 v37, 0
    v_mov_b32 v38, 0
    v_mov_b32 v39, 0
    v_mov_b32 v40, 0
    v_mov_b32 v41, 0
    v_mov_b32 v42, 0
    v_mov_b32 v43, 0
    v_mov_b32 v44, 0
    v_mov_b32 v45, 0
    v_mov_b32 v46, 0
    v_mov_b32 v47, 0
    v_mov_b32 v48, 0
    v_mov_b32 v49, 0
    v_mov_b32 v50, 0
    v_mov_b32 v51, 0
    v_mov_b32 v52, 0
    v_mov_b32 v53, 0
    v_mov_b32 v54, 0
    v_mov_b32 v55, 0
    v_mov_b32 v56, 0
    v_mov_b32 v57, 0
    v_mov_b32 v58, 0
    v_mov_b32 v59, 0
    v_mov_b32 v60, 0
    v_mov_b32 v61, 0
    v_mov_b32 v62, 0
    v_mov_b32 v63, 0
    v_mov_b32 v64, 0
    v_mov_b32 v65, 0
    v_mov_b32 v66, 0
    v_mov_b32 v67, 0
    v_mov_b32 v68, 0
    v_mov_b32 v69, 0
    v_mov_b32 v70, 0
    v_mov_b32 v71, 0
    v_mov_b32 v72, 0
    v_mov_b32 v73, 0
    v_mov_b32 v74, 0
    v_mov_b32 v75, 0
    v_mov_b32 v76, 0
    v_mov_b32 v77, 0
    v_mov_b32 v78, 0
    v_mov_b32 v79, 0
    v_mov_b32 v80, 0
    v_mov_b32 v81, 0
    v_mov_b32 v82, 0
    v_mov_b32 v83, 0
    v_mov_b32 v84, 0
    v_mov_b32 v85, 0
    v_mov_b32 v86, 0
    v_mov_b32 v87, 0
    v_mov_b32 v88, 0
    v_mov_b32 v89, 0
    v_mov_b32 v90, 0
    v_mov_b32 v91, 0
    v_mov_b32 v92, 0
    v_mov_b32 v93, 0
    v_mov_b32 v94, 0
    v_mov_b32 v95, 0
    v_mov_b32 v96, 0
    v_mov_b32 v97, 0
    v_mov_b32 v98, 0
    v_mov_b32 v99, 0
    v_mov_b32 v100, 0
    v_mov_b32 v101, 0
    v_mov_b32 v102, 0
    v_mov_b32 v103, 0
    v_mov_b32 v104, 0
    v_mov_b32 v105, 0
    v_mov_b32 v106, 0
    v_mov_b32 v107, 0
    v_mov_b32 v108, 0
    v_mov_b32 v109, 0
    v_mov_b32 v110, 0
    v_mov_b32 v111, 0
    v_mov_b32 v112, 0
    v_mov_b32 v113, 0
    v_mov_b32 v114, 0
    v_mov_b32 v115, 0
    v_mov_b32 v116, 0
    v_mov_b32 v117, 0
    v_mov_b32 v118, 0
    v_mov_b32 v119, 0
    v_mov_b32 v120, 0
    v_mov_b32 v121, 0
    v_mov_b32 v122, 0
    v_mov_b32 v123, 0
    v_mov_b32 v124, 0
    v_mov_b32 v125, 0
    v_mov_b32 v126, 0
    v_mov_b32 v127, 0
    v_mov_b32 v128, 0
    v_mov_b32 v129, 0
    v_mov_b32 v130, 0
    v_mov_b32 v131, 0
    v_mov_b32 v132, 0
    v_mov_b32 v133, 0
    v_mov_b32 v134, 0
    v_mov_b32 v135, 0
    v_mov_b32 v136, 0
    v_mov_b32 v137, 0
    v_mov_b32 v138, 0
    v_mov_b32 v139, 0
    v_mov_b32 v140, 0
    v_mov_b32 v141, 0
    v_mov_b32 v142, 0
    v_mov_b32 v143, 0
    v_mov_b32 v144, 0
    v_mov_b32 v145, 0
    v_mov_b32 v146, 0
    v_mov_b32 v147, 0
    v_mov_b32 v148, 0
    v_mov_b32 v149, 0
    v_mov_b32 v150, 0
    v_mov_b32 v151, 0
    v_mov_b32 v152, 0
    v_mov_b32 v153, 0
    v_mov_b32 v154, 0
    v_mov_b32 v155, 0
    v_mov_b32 v156, 0
    v_mov_b32 v157, 0
    v_mov_b32 v158, 0
    v_mov_b32 v159, 0
    v_mov_b32 v160, 0
    v_mov_b32 v161, 0
    v_mov_b32 v162, 0
    v_mov_b32 v163, 0
    v_mov_b32 v164, 0
    v_mov_b32 v165, 0
    v_mov_b32 v166, 0
    v_mov_b32 v167, 0
    v_mov_b32 v168, 0
    v_mov_b32 v169, 0
    v_mov_b32 v170, 0
    v_mov_b32 v171, 0
    v_mov_b32 v172, 0
    v_mov_b32 v173, 0
    v_mov_b32 v174, 0
    v_mov_b32 v175, 0
    v_mov_b32 v176, 0
    v_mov_b32 v177, 0
    v_mov_b32 v178, 0
    v_mov_b32 v179, 0
    v_mov_b32 v180, 0
    v_mov_b32 v181, 0
    v_mov_b32 v182, 0
    v_mov_b32 v183, 0
    v_mov_b32 v184, 0
    v_mov_b32 v185, 0
    v_mov_b32 v186, 0
    v_mov_b32 v187, 0
    v_mov_b32 v188, 0
    v_mov_b32 v189, 0
    v_mov_b32 v190, 0
    v_mov_b32 v191, 0
    v_mov_b32 v192, 0
    v_mov_b32 v193, 0
    v_mov_b32 v194, 0
    v_mov_b32 v195, 0
    v_mov_b32 v196, 0
    v_mov_b32 v197, 0
    v_mov_b32 v198, 0
    v_mov_b32 v199, 0
    v_mov_b32 v200, 0
    v_mov_b32 v201, 0
    v_mov_b32 v202, 0
    v_mov_b32 v203, 0
    v_mov_b32 v204, 0
    v_mov_b32 v205, 0
    v_mov_b32 v206, 0
    v_mov_b32 v207, 0
    v_mov_b32 v208, 0
    v_mov_b32 v209, 0
    v_mov_b32 v210, 0
    v_mov_b32 v211, 0
    v_mov_b32 v212, 0
    v_mov_b32 v213, 0
    v_mov_b32 v214, 0
    v_mov_b32 v215, 0
    v_mov_b32 v216, 0
    v_mov_b32 v217, 0
    v_mov_b32 v218, 0
    v_mov_b32 v219, 0
    v_mov_b32 v220, 0
    v_mov_b32 v221, 0
    v_mov_b32 v222, 0
    v_mov_b32 v223, 0
    v_mov_b32 v224, 0
    v_mov_b32 v225, 0
    v_mov_b32 v226, 0
    v_mov_b32 v227, 0
    v_mov_b32 v228, 0
    v_mov_b32 v229, 0
    v_mov_b32 v230, 0
    v_mov_b32 v231, 0
    v_mov_b32 v232, 0
    v_mov_b32 v233, 0
    v_mov_b32 v234, 0
    v_mov_b32 v235, 0
    v_mov_b32 v236, 0
    v_mov_b32 v237, 0
    v_mov_b32 v238, 0
    v_mov_b32 v239, 0
    v_mov_b32 v240, 0
    v_mov_b32 v241, 0
    v_mov_b32 v242, 0
    v_mov_b32 v243, 0
    v_mov_b32 v244, 0
    v_mov_b32 v245, 0
    v_mov_b32 v246, 0
    v_mov_b32 v247, 0
    v_mov_b32 v248, 0
    v_mov_b32 v249, 0
    v_mov_b32 v250, 0
    v_mov_b32 v251, 0
    v_mov_b32 v252, 0
    v_mov_b32 v253, 0
    v_mov_b32 v254, 0
    v_mov_b32 v255, 0
    v_accvgpr_write_b32 a144, 0
    v_accvgpr_write_b32 a145, 0
    v_accvgpr_write_b32 a146, 0
    v_accvgpr_write_b32 a147, 0
    v_accvgpr_write_b32 a148, 0
    v_accvgpr_write_b32 a149, 0
    v_accvgpr_write_b32 a150, 0
    v_accvgpr_write_b32 a151, 0
    v_accvgpr_write_b32 a152, 0
    v_accvgpr_write_b32 a153, 0
    v_accvgpr_write_b32 a154, 0
    v_accvgpr_write_b32 a155, 0
    v_accvgpr_write_b32 a156, 0
    v_accvgpr_write_b32 a157, 0
    v_accvgpr_write_b32 a158, 0
    v_accvgpr_write_b32 a159, 0
    v_accvgpr_write_b32 a160, 0
    v_accvgpr_write_b32 a161, 0
    v_accvgpr_write_b32 a162, 0
    v_accvgpr_write_b32 a163, 0
    v_accvgpr_write_b32 a164, 0
    v_accvgpr_write_b32 a165, 0
    v_accvgpr_write_b32 a166, 0
    v_accvgpr_write_b32 a167, 0
    v_accvgpr_write_b32 a168, 0
    v_accvgpr_write_b32 a169, 0
    v_accvgpr_write_b32 a170, 0
    v_accvgpr_write_b32 a171, 0
    v_accvgpr_write_b32 a172, 0
    v_accvgpr_write_b32 a173, 0
    v_accvgpr_write_b32 a174, 0
    v_accvgpr_write_b32 a175, 0
    v_accvgpr_write_b32 a176, 0
    v_accvgpr_write_b32 a177, 0
    v_accvgpr_write_b32 a178, 0
    v_accvgpr_write_b32 a179, 0
    v_accvgpr_write_b32 a180, 0
    v_accvgpr_write_b32 a181, 0
    v_accvgpr_write_b32 a182, 0
    v_accvgpr_write_b32 a183, 0
    v_accvgpr_write_b32 a184, 0
    v_accvgpr_write_b32 a185, 0
    v_accvgpr_write_b32 a186, 0
    v_accvgpr_write_b32 a187, 0
    v_accvgpr_write_b32 a188, 0
    v_accvgpr_write_b32 a189, 0
    v_accvgpr_write_b32 a190, 0
    v_accvgpr_write_b32 a191, 0
    v_accvgpr_write_b32 a192, 0
    v_accvgpr_write_b32 a193, 0
    v_accvgpr_write_b32 a194, 0
    v_accvgpr_write_b32 a195, 0
    v_accvgpr_write_b32 a196, 0
    v_accvgpr_write_b32 a197, 0
    v_accvgpr_write_b32 a198, 0
    v_accvgpr_write_b32 a199, 0
    v_accvgpr_write_b32 a200, 0
    v_accvgpr_write_b32 a201, 0
    v_accvgpr_write_b32 a202, 0
    v_accvgpr_write_b32 a203, 0
    v_accvgpr_write_b32 a204, 0
    v_accvgpr_write_b32 a205, 0
    v_accvgpr_write_b32 a206, 0
    v_accvgpr_write_b32 a207, 0
    v_accvgpr_write_b32 a208, 0
    v_accvgpr_write_b32 a209, 0
    v_accvgpr_write_b32 a210, 0
    v_accvgpr_write_b32 a211, 0
    v_accvgpr_write_b32 a212, 0
    v_accvgpr_write_b32 a213, 0
    v_accvgpr_write_b32 a214, 0
    v_accvgpr_write_b32 a215, 0
    v_accvgpr_write_b32 a216, 0
    v_accvgpr_write_b32 a217, 0
    v_accvgpr_write_b32 a218, 0
    v_accvgpr_write_b32 a219, 0
    v_accvgpr_write_b32 a220, 0
    v_accvgpr_write_b32 a221, 0
    v_accvgpr_write_b32 a222, 0
    v_accvgpr_write_b32 a223, 0
    v_accvgpr_write_b32 a224, 0
    v_accvgpr_write_b32 a225, 0
    v_accvgpr_write_b32 a226, 0
    v_accvgpr_write_b32 a227, 0
    v_accvgpr_write_b32 a228, 0
    v_accvgpr_write_b32 a229, 0
    v_accvgpr_write_b32 a230, 0
    v_accvgpr_write_b32 a231, 0
    s_mov_b32 s58, 0x40000
L_gemm1_kernel_spinB:
    s_waitcnt vmcnt(0)
    v_cmp_ne_u32 vcc, s69, v22
    s_sub_u32 s58, s58, 1
    s_cbranch_vccz L_gemm1_kernel_goB
    s_cbranch_scc1 L_gemm1_kernel_goB
    buffer_load_dword v22, v23, s[36:39], s57 offen sc0 sc1
    s_branch L_gemm1_kernel_spinB
L_gemm1_kernel_goB:
    s_add_u32 m0, s44, 0
    s_nop 0
    buffer_load_dwordx4 v15, s[8:11], s40 offen offset:0 lds
    buffer_load_dwordx4 v15, s[8:11], s40 offen offset:1024 lds
    buffer_load_dwordx4 v15, s[8:11], s40 offen offset:2048 lds
    buffer_load_dwordx4 v15, s[8:11], s40 offen offset:3072 lds
    s_add_u32 s40, s40, 131072
    s_add_u32 m0, s44, 36864
    s_nop 0
    buffer_load_dwordx4 v15, s[8:11], s40 offen offset:0 lds
    buffer_load_dwordx4 v15, s[8:11], s40 offen offset:1024 lds
    buffer_load_dwordx4 v15, s[8:11], s40 offen offset:2048 lds
    buffer_load_dwordx4 v15, s[8:11], s40 offen offset:3072 lds
    s_add_u32 s40, s40, 131072
    s_add_u32 m0, s44, 73728
    s_nop 0
    buffer_load_dwordx4 v15, s[8:11], s40 offen offset:0 lds
    buffer_load_dwordx4 v15, s[8:11], s40 offen offset:1024 lds
    buffer_load_dwordx4 v15, s[8:11], s40 offen offset:2048 lds
    buffer_load_dwordx4 v15, s[8:11], s40 offen offset:3072 lds
    s_add_u32 s40, s40, 131072
    s_add_u32 m0, s44, 110592
    s_nop 0
    buffer_load_dwordx4 v15, s[8:11], s40 offen offset:0 lds
    buffer_load_dwordx4 v15, s[8:11], s40 offen offset:1024 lds
    buffer_load_dwordx4 v15, s[8:11], s40 offen offset:2048 lds
    buffer_load_dwordx4 v15, s[8:11], s40 offen offset:3072 lds
    s_add_u32 s40, s40, 131072
    s_add_u32 m0, s45, 110592
    s_nop 0
    buffer_load_dwordx4 v16, s[12:15], s41 offen lds
    buffer_load_dwordx4 v16, s[16:19], s41 offen offset:1024 lds
    buffer_load_dwordx4 v16, s[20:23], s41 offen offset:2048 lds
    buffer_load_dwordx4 v17, s[24:27], s42 offen offset:3072 lds
    s_add_u32 m0, s45, 114688
    s_nop 0
    s_add_u32 s41, s41, 196608
    buffer_load_dwordx4 v17, s[28:31], s42 offen lds
    s_add_u32 s42, s42, 229376
    s_mov_b32 s46, 7
    s_waitcnt vmcnt(17)
    s_barrier
    ds_read_b64_tr_b16 a[64:65], v3 offset:0
    ds_read_b64_tr_b16 a[66:67], v3 offset:512
    ds_read_b128 a[0:3], v1 offset:0
    ds_read_b128 a[4:7], v1 offset:1024
    ds_read_b128 a[8:11], v1 offset:2048
    ds_read_b128 a[12:15], v1 offset:3072
    ds_read_b64_tr_b16 a[68:69], v4 offset:0
    ds_read_b64_tr_b16 a[70:71], v4 offset:512
    ds_read_b128 a[16:19], v1 offset:4096
    ds_read_b128 a[20:23], v1 offset:5120
    ds_read_b128 a[24:27], v1 offset:6144
    ds_read_b128 a[28:31], v1 offset:7168
    ds_read_b64_tr_b16 a[72:73], v3 offset:1024
    ds_read_b64_tr_b16 a[74:75], v3 offset:1536
    ds_read_b64_tr_b16 a[76:77], v4 offset:1024
    ds_read_b64_tr_b16 a[78:79], v4 offset:1536
    ds_read_b64_tr_b16 a[80:81], v3 offset:2048
    ds_read_b64_tr_b16 a[82:83], v3 offset:2560
    ds_read_b64_tr_b16 a[84:85], v4 offset:2048
    ds_read_b64_tr_b16 a[86:87], v4 offset:2560
    ds_read_b64_tr_b16 a[88:89], v3 offset:3072
    ds_read_b64_tr_b16 a[90:91], v3 offset:3584
    ds_read_b64_tr_b16 a[92:93], v4 offset:3072
    ds_read_b64_tr_b16 a[94:95], v4 offset:3584
    ds_read_b64_tr_b16 a[96:97], v3 offset:4096
    ds_read_b64_tr_b16 a[98:99], v3 offset:4608
    ds_read_b64_tr_b16 a[100:101], v4 offset:4096
    ds_read_b64_tr_b16 a[102:103], v4 offset:4608
    s_waitcnt lgkmcnt(0)
    v_mfma_f32_16x16x32_bf16 v[24:27], a[0:3], a[64:67], v[24:27]
    v_mfma_f32_16x16x32_bf16 v[28:31], a[4:7], a[64:67], v[28:31]
    v_mfma_f32_16x16x32_bf16 v[32:35], a[8:11], a[64:67], v[32:35]
    v_mfma_f32_16x16x32_bf16 v[36:39], a[12:15], a[64:67], v[36:39]
    v_mfma_f32_16x16x32_bf16 v[40:43], a[16:19], a[64:67], v[40:43]
    v_mfma_f32_16x16x32_bf16 v[44:47], a[20:23], a[64:67], v[44:47]
    v_mfma_f32_16x16x32_bf16 v[48:51], a[24:27], a[64:67], v[48:51]
    v_mfma_f32_16x16x32_bf16 v[52:55], a[28:31], a[64:67], v[52:55]
    v_mfma_f32_16x16x32_bf16 v[56:59], a[0:3], a[68:71], v[56:59]
    s_waitcnt vmcnt(13)
    v_mfma_f32_16x16x32_bf16 v[60:63], a[4:7], a[68:71], v[60:63]
    s_barrier
    v_mfma_f32_16x16x32_bf16 v[64:67], a[8:11], a[68:71], v[64:67]
    s_add_u32 m0, s44, 0
    v_mfma_f32_16x16x32_bf16 v[68:71], a[12:15], a[68:71], v[68:71]
    ds_read_b64_tr_b16 a[104:105], v3 offset:36864
    v_mfma_f32_16x16x32_bf16 v[72:75], a[16:19], a[68:71], v[72:75]
    ds_read_b64_tr_b16 a[106:107], v3 offset:37376
    v_mfma_f32_16x16x32_bf16 v[76:79], a[20:23], a[68:71], v[76:79]
    v_mfma_f32_16x16x32_bf16 v[80:83], a[24:27], a[68:71], v[80:83]
    buffer_load_dwordx4 v15, s[8:11], s40 offen offset:0 lds
    v_mfma_f32_16x16x32_bf16 v[84:87], a[28:31], a[68:71], v[84:87]
    ds_read_b128 a[32:35], v1 offset:36864
    v_mfma_f32_16x16x32_bf16 v[88:91], a[0:3], a[72:75], v[88:91]
    v_mfma_f32_16x16x32_bf16 v[92:95], a[4:7], a[72:75], v[92:95]
    ds_read_b128 a[36:39], v1 offset:37888
    v_mfma_f32_16x16x32_bf16 v[96:99], a[8:11], a[72:75], v[96:99]
    buffer_load_dwordx4 v15, s[8:11], s40 offen offset:1024 lds
    v_mfma_f32_16x16x32_bf16 v[100:103], a[12:15], a[72:75], v[100:103]
    v_mfma_f32_16x16x32_bf16 v[104:107], a[16:19], a[72:75], v[104:107]
    ds_read_b128 a[40:43], v1 offset:38912
    v_mfma_f32_16x16x32_bf16 v[108:111], a[20:23], a[72:75], v[108:111]
    ds_read_b128 a[44:47], v1 offset:39936
    v_mfma_f32_16x16x32_bf16 v[112:115], a[24:27], a[72:75], v[112:115]
    v_mfma_f32_16x16x32_bf16 v[116:119], a[28:31], a[72:75], v[116:119]
    buffer_load_dwordx4 v15, s[8:11], s40 offen offset:2048 lds
    v_mfma_f32_16x16x32_bf16 v[120:123], a[0:3], a[76:79], v[120:123]
    ds_read_b64_tr_b16 a[108:109], v4 offset:36864
    v_mfma_f32_16x16x32_bf16 v[124:127], a[4:7], a[76:79], v[124:127]
    v_mfma_f32_16x16x32_bf16 v[128:131], a[8:11], a[76:79], v[128:131]
    ds_read_b64_tr_b16 a[110:111], v4 offset:37376
    v_mfma_f32_16x16x32_bf16 v[132:135], a[12:15], a[76:79], v[132:135]
    buffer_load_dwordx4 v15, s[8:11], s40 offen offset:3072 lds
    v_mfma_f32_16x16x32_bf16 v[136:139], a[16:19], a[76:79], v[136:139]
    v_mfma_f32_16x16x32_bf16 v[140:143], a[20:23], a[76:79], v[140:143]
    ds_read_b128 a[48:51], v1 offset:40960
    v_mfma_f32_16x16x32_bf16 v[144:147], a[24:27], a[76:79], v[144:147]
    ds_read_b128 a[52:55], v1 offset:41984
    v_mfma_f32_16x16x32_bf16 v[148:151], a[28:31], a[76:79], v[148:151]
    s_add_u32 m0, s45, 0
    v_mfma_f32_16x16x32_bf16 v[152:155], a[80:83], a[0:3], v[152:155]
    v_mfma_f32_16x16x32_bf16 v[156:159], a[80:83], a[4:7], v[156:159]
    ds_read_b128 a[56:59], v1 offset:43008
    v_mfma_f32_16x16x32_bf16 v[160:163], a[80:83], a[8:11], v[160:163]
    ds_read_b128 a[60:63], v1 offset:44032
    v_mfma_f32_16x16x32_bf16 v[164:167], a[80:83], a[12:15], v[164:167]
    v_mfma_f32_16x16x32_bf16 v[168:171], a[80:83], a[16:19], v[168:171]
    s_add_u32 s40, s40, 131072
    v_mfma_f32_16x16x32_bf16 v[172:175], a[80:83], a[20:23], v[172:175]
    ds_read_b64_tr_b16 a[112:113], v3 offset:37888
    v_mfma_f32_16x16x32_bf16 v[176:179], a[80:83], a[24:27], v[176:179]
    v_mfma_f32_16x16x32_bf16 v[180:183], a[80:83], a[28:31], v[180:183]
    ds_read_b64_tr_b16 a[114:115], v3 offset:38400
    v_mfma_f32_16x16x32_bf16 v[184:187], a[84:87], a[0:3], v[184:187]
    buffer_load_dwordx4 v16, s[12:15], s41 offen lds
    v_mfma_f32_16x16x32_bf16 v[188:191], a[84:87], a[4:7], v[188:191]
    v_mfma_f32_16x16x32_bf16 v[192:195], a[84:87], a[8:11], v[192:195]
    ds_read_b64_tr_b16 a[116:117], v4 offset:37888
    v_mfma_f32_16x16x32_bf16 v[196:199], a[84:87], a[12:15], v[196:199]
    buffer_load_dwordx4 v16, s[16:19], s41 offen offset:1024 lds
    v_mfma_f32_16x16x32_bf16 v[200:203], a[84:87], a[16:19], v[200:203]
    v_mfma_f32_16x16x32_bf16 v[204:207], a[84:87], a[20:23], v[204:207]
    ds_read_b64_tr_b16 a[118:119], v4 offset:38400
    v_mfma_f32_16x16x32_bf16 v[208:211], a[84:87], a[24:27], v[208:211]
    ds_read_b64_tr_b16 a[120:121], v3 offset:38912
    v_mfma_f32_16x16x32_bf16 v[212:215], a[84:87], a[28:31], v[212:215]
    v_mfma_f32_16x16x32_bf16 v[216:219], a[88:91], a[0:3], v[216:219]
    buffer_load_dwordx4 v16, s[20:23], s41 offen offset:2048 lds
    v_mfma_f32_16x16x32_bf16 v[220:223], a[88:91], a[4:7], v[220:223]
    ds_read_b64_tr_b16 a[122:123], v3 offset:39424
    v_mfma_f32_16x16x32_bf16 v[224:227], a[88:91], a[8:11], v[224:227]
    v_mfma_f32_16x16x32_bf16 v[228:231], a[88:91], a[12:15], v[228:231]
    ds_read_b64_tr_b16 a[124:125], v4 offset:38912
    v_mfma_f32_16x16x32_bf16 v[232:235], a[88:91], a[16:19], v[232:235]
    buffer_load_dwordx4 v17, s[24:27], s42 offen offset:3072 lds
    v_mfma_f32_16x16x32_bf16 v[236:239], a[88:91], a[20:23], v[236:239]
    ds_read_b64_tr_b16 a[126:127], v4 offset:39424
    v_mfma_f32_16x16x32_bf16 v[240:243], a[88:91], a[24:27], v[240:243]
    v_mfma_f32_16x16x32_bf16 v[244:247], a[88:91], a[28:31], v[244:247]
    ds_read_b64_tr_b16 a[128:129], v3 offset:39936
    v_mfma_f32_16x16x32_bf16 v[248:251], a[92:95], a[0:3], v[248:251]
    s_add_u32 m0, s45, 4096
    v_mfma_f32_16x16x32_bf16 v[252:255], a[92:95], a[4:7], v[252:255]
    v_mfma_f32_16x16x32_bf16 a[144:147], a[92:95], a[8:11], a[144:147]
    ds_read_b64_tr_b16 a[130:131], v3 offset:40448
    v_mfma_f32_16x16x32_bf16 a[148:151], a[92:95], a[12:15], a[148:151]
    ds_read_b64_tr_b16 a[132:133], v4 offset:39936
    v_mfma_f32_16x16x32_bf16 a[152:155], a[92:95], a[16:19], a[152:155]
    v_mfma_f32_16x16x32_bf16 a[156:159], a[92:95], a[20:23], a[156:159]
    s_add_u32 s41, s41, 196608
    v_mfma_f32_16x16x32_bf16 a[160:163], a[92:95], a[24:27], a[160:163]
    ds_read_b64_tr_b16 a[134:135], v4 offset:40448
    v_mfma_f32_16x16x32_bf16 a[164:167], a[92:95], a[28:31], a[164:167]
    v_mfma_f32_16x16x32_bf16 a[168:171], a[96:99], a[0:3], a[168:171]
    ds_read_b64_tr_b16 a[136:137], v3 offset:40960
    v_mfma_f32_16x16x32_bf16 a[172:175], a[96:99], a[4:7], a[172:175]
    buffer_load_dwordx4 v17, s[28:31], s42 offen lds
    v_mfma_f32_16x16x32_bf16 a[176:179], a[96:99], a[8:11], a[176:179]
    v_mfma_f32_16x16x32_bf16 a[180:183], a[96:99], a[12:15], a[180:183]
    ds_read_b64_tr_b16 a[138:139], v3 offset:41472
    v_mfma_f32_16x16x32_bf16 a[184:187], a[96:99], a[16:19], a[184:187]
    ds_read_b64_tr_b16 a[140:141], v4 offset:40960
    v_mfma_f32_16x16x32_bf16 a[188:191], a[96:99], a[20:23], a[188:191]
    v_mfma_f32_16x16x32_bf16 a[192:195], a[96:99], a[24:27], a[192:195]
    s_add_u32 s42, s42, 229376
    v_mfma_f32_16x16x32_bf16 a[196:199], a[96:99], a[28:31], a[196:199]
    ds_read_b64_tr_b16 a[142:143], v4 offset:41472
    v_mfma_f32_16x16x32_bf16 a[200:203], a[100:103], a[0:3], a[200:203]
    v_mfma_f32_16x16x32_bf16 a[204:207], a[100:103], a[4:7], a[204:207]
    v_mfma_f32_16x16x32_bf16 a[208:211], a[100:103], a[8:11], a[208:211]
    v_mfma_f32_16x16x32_bf16 a[212:215], a[100:103], a[12:15], a[212:215]
    v_mfma_f32_16x16x32_bf16 a[216:219], a[100:103], a[16:19], a[216:219]
    v_mfma_f32_16x16x32_bf16 a[220:223], a[100:103], a[20:23], a[220:223]
    v_mfma_f32_16x16x32_bf16 a[224:227], a[100:103], a[24:27], a[224:227]
    v_mfma_f32_16x16x32_bf16 a[228:231], a[100:103], a[28:31], a[228:231]
    s_waitcnt lgkmcnt(0)
    v_mfma_f32_16x16x32_bf16 v[24:27], a[32:35], a[104:107], v[24:27]
    v_mfma_f32_16x16x32_bf16 v[28:31], a[36:39], a[104:107], v[28:31]
    v_mfma_f32_16x16x32_bf16 v[32:35], a[40:43], a[104:107], v[32:35]
    v_mfma_f32_16x16x32_bf16 v[36:39], a[44:47], a[104:107], v[36:39]
    v_mfma_f32_16x16x32_bf16 v[40:43], a[48:51], a[104:107], v[40:43]
    v_mfma_f32_16x16x32_bf16 v[44:47], a[52:55], a[104:107], v[44:47]
    v_mfma_f32_16x16x32_bf16 v[48:51], a[56:59], a[104:107], v[48:51]
    v_mfma_f32_16x16x32_bf16 v[52:55], a[60:63], a[104:107], v[52:55]
    v_mfma_f32_16x16x32_bf16 v[56:59], a[32:35], a[108:111], v[56:59]
    s_waitcnt vmcnt(18)
    v_mfma_f32_16x16x32_bf16 v[60:63], a[36:39], a[108:111], v[60:63]
    s_barrier
    v_mfma_f32_16x16x32_bf16 v[64:67], a[40:43], a[108:111], v[64:67]
    s_add_u32 m0, s44, 36864
    v_mfma_f32_16x16x32_bf16 v[68:71], a[44:47], a[108:111], v[68:71]
    ds_read_b64_tr_b16 a[64:65], v5 offset:0
    v_mfma_f32_16x16x32_bf16 v[72:75], a[48:51], a[108:111], v[72:75]
    ds_read_b64_tr_b16 a[66:67], v5 offset:512
    v_mfma_f32_16x16x32_bf16 v[76:79], a[52:55], a[108:111], v[76:79]
    v_mfma_f32_16x16x32_bf16 v[80:83], a[56:59], a[108:111], v[80:83]
    buffer_load_dwordx4 v15, s[8:11], s40 offen offset:0 lds
    v_mfma_f32_16x16x32_bf16 v[84:87], a[60:63], a[108:111], v[84:87]
    ds_read_b128 a[0:3], v2 offset:0
    v_mfma_f32_16x16x32_bf16 v[88:91], a[32:35], a[112:115], v[88:91]
    v_mfma_f32_16x16x32_bf16 v[92:95], a[36:39], a[112:115], v[92:95]
    ds_read_b128 a[4:7], v2 offset:1024
    v_mfma_f32_16x16x32_bf16 v[96:99], a[40:43], a[112:115], v[96:99]
    buffer_load_dwordx4 v15, s[8:11], s40 offen offset:1024 lds
    v_mfma_f32_16x16x32_bf16 v[100:103], a[44:47], a[112:115], v[100:103]
    v_mfma_f32_16x16x32_bf16 v[104:107], a[48:51], a[112:115], v[104:107]
    ds_read_b128 a[8:11], v2 offset:2048
    v_mfma_f32_16x16x32_bf16 v[108:111], a[52:55], a[112:115], v[108:111]
    ds_read_b128 a[12:15], v2 offset:3072
    v_mfma_f32_16x16x32_bf16 v[112:115], a[56:59], a[112:115], v[112:115]
    v_mfma_f32_16x16x32_bf16 v[116:119], a[60:63], a[112:115], v[116:119]
    buffer_load_dwordx4 v15, s[8:11], s40 offen offset:2048 lds
    v_mfma_f32_16x16x32_bf16 v[120:123], a[32:35], a[116:119], v[120:123]
    ds_read_b64_tr_b16 a[68:69], v6 offset:0
    v_mfma_f32_16x16x32_bf16 v[124:127], a[36:39], a[116:119], v[124:127]
    v_mfma_f32_16x16x32_bf16 v[128:131], a[40:43], a[116:119], v[128:131]
    ds_read_b64_tr_b16 a[70:71], v6 offset:512
    v_mfma_f32_16x16x32_bf16 v[132:135], a[44:47], a[116:119], v[132:135]
    buffer_load_dwordx4 v15, s[8:11], s40 offen offset:3072 lds
    v_mfma_f32_16x16x32_bf16 v[136:139], a[48:51], a[116:119], v[136:139]
    v_mfma_f32_16x16x32_bf16 v[140:143], a[52:55], a[116:119], v[140:143]
    ds_read_b128 a[16:19], v2 offset:4096
    v_mfma_f32_16x16x32_bf16 v[144:147], a[56:59], a[116:119], v[144:147]
    ds_read_b128 a[20:23], v2 offset:5120
    v_mfma_f32_16x16x32_bf16 v[148:151], a[60:63], a[116:119], v[148:151]
    s_add_u32 m0, s45, 36864
    v_mfma_f32_16x16x32_bf16 v[152:155], a[120:123], a[32:35], v[152:155]
    v_mfma_f32_16x16x32_bf16 v[156:159], a[120:123], a[36:39], v[156:159]
    ds_read_b128 a[24:27], v2 offset:6144
    v_mfma_f32_16x16x32_bf16 v[160:163], a[120:123], a[40:43], v[160:163]
    ds_read_b128 a[28:31], v2 offset:7168
    v_mfma_f32_16x16x32_bf16 v[164:167], a[120:123], a[44:47], v[164:167]
    v_mfma_f32_16x16x32_bf16 v[168:171], a[120:123], a[48:51], v[168:171]
    s_add_u32 s40, s40, 131072
    v_mfma_f32_16x16x32_bf16 v[172:175], a[120:123], a[52:55], v[172:175]
    ds_read_b64_tr_b16 a[72:73], v5 offset:1024
    v_mfma_f32_16x16x32_bf16 v[176:179], a[120:123], a[56:59], v[176:179]
    v_mfma_f32_16x16x32_bf16 v[180:183], a[120:123], a[60:63], v[180:183]
    ds_read_b64_tr_b16 a[74:75], v5 offset:1536
    v_mfma_f32_16x16x32_bf16 v[184:187], a[124:127], a[32:35], v[184:187]
    buffer_load_dwordx4 v16, s[12:15], s41 offen lds
    v_mfma_f32_16x16x32_bf16 v[188:191], a[124:127], a[36:39], v[188:191]
    v_mfma_f32_16x16x32_bf16 v[192:195], a[124:127], a[40:43], v[192:195]
    ds_read_b64_tr_b16 a[76:77], v6 offset:1024
    v_mfma_f32_16x16x32_bf16 v[196:199], a[124:127], a[44:47], v[196:199]
    buffer_load_dwordx4 v16, s[16:19], s41 offen offset:1024 lds
    v_mfma_f32_16x16x32_bf16 v[200:203], a[124:127], a[48:51], v[200:203]
    v_mfma_f32_16x16x32_bf16 v[204:207], a[124:127], a[52:55], v[204:207]
    ds_read_b64_tr_b16 a[78:79], v6 offset:1536
    v_mfma_f32_16x16x32_bf16 v[208:211], a[124:127], a[56:59], v[208:211]
    ds_read_b64_tr_b16 a[80:81], v5 offset:2048
    v_mfma_f32_16x16x32_bf16 v[212:215], a[124:127], a[60:63], v[212:215]
    v_mfma_f32_16x16x32_bf16 v[216:219], a[128:131], a[32:35], v[216:219]
    buffer_load_dwordx4 v16, s[20:23], s41 offen offset:2048 lds
    v_mfma_f32_16x16x32_bf16 v[220:223], a[128:131], a[36:39], v[220:223]
    ds_read_b64_tr_b16 a[82:83], v5 offset:2560
    v_mfma_f32_16x16x32_bf16 v[224:227], a[128:131], a[40:43], v[224:227]
    v_mfma_f32_16x16x32_bf16 v[228:231], a[128:131], a[44:47], v[228:231]
    ds_read_b64_tr_b16 a[84:85], v6 offset:2048
    v_mfma_f32_16x16x32_bf16 v[232:235], a[128:131], a[48:51], v[232:235]
    buffer_load_dwordx4 v17, s[24:27], s42 offen offset:3072 lds
    v_mfma_f32_16x16x32_bf16 v[236:239], a[128:131], a[52:55], v[236:239]
    ds_read_b64_tr_b16 a[86:87], v6 offset:2560
    v_mfma_f32_16x16x32_bf16 v[240:243], a[128:131], a[56:59], v[240:243]
    v_mfma_f32_16x16x32_bf16 v[244:247], a[128:131], a[60:63], v[244:247]
    ds_read_b64_tr_b16 a[88:89], v5 offset:3072
    v_mfma_f32_16x16x32_bf16 v[248:251], a[132:135], a[32:35], v[248:251]
    s_add_u32 m0, s45, 40960
    v_mfma_f32_16x16x32_bf16 v[252:255], a[132:135], a[36:39], v[252:255]
    v_mfma_f32_16x16x32_bf16 a[144:147], a[132:135], a[40:43], a[144:147]
    ds_read_b64_tr_b16 a[90:91], v5 offset:3584
    v_mfma_f32_16x16x32_bf16 a[148:151], a[132:135], a[44:47], a[148:151]
    ds_read_b64_tr_b16 a[92:93], v6 offset:3072
    v_mfma_f32_16x16x32_bf16 a[152:155], a[132:135], a[48:51], a[152:155]
    v_mfma_f32_16x16x32_bf16 a[156:159], a[132:135], a[52:55], a[156:159]
    s_add_u32 s41, s41, 196608
    v_mfma_f32_16x16x32_bf16 a[160:163], a[132:135], a[56:59], a[160:163]
    ds_read_b64_tr_b16 a[94:95], v6 offset:3584
    v_mfma_f32_16x16x32_bf16 a[164:167], a[132:135], a[60:63], a[164:167]
    v_mfma_f32_16x16x32_bf16 a[168:171], a[136:139], a[32:35], a[168:171]
    ds_read_b64_tr_b16 a[96:97], v5 offset:4096
    v_mfma_f32_16x16x32_bf16 a[172:175], a[136:139], a[36:39], a[172:175]
    buffer_load_dwordx4 v17, s[28:31], s42 offen lds
    v_mfma_f32_16x16x32_bf16 a[176:179], a[136:139], a[40:43], a[176:179]
    v_mfma_f32_16x16x32_bf16 a[180:183], a[136:139], a[44:47], a[180:183]
    ds_read_b64_tr_b16 a[98:99], v5 offset:4608
    v_mfma_f32_16x16x32_bf16 a[184:187], a[136:139], a[48:51], a[184:187]
    ds_read_b64_tr_b16 a[100:101], v6 offset:4096
    v_mfma_f32_16x16x32_bf16 a[188:191], a[136:139], a[52:55], a[188:191]
    v_mfma_f32_16x16x32_bf16 a[192:195], a[136:139], a[56:59], a[192:195]
    s_add_u32 s42, s42, 229376
    v_mfma_f32_16x16x32_bf16 a[196:199], a[136:139], a[60:63], a[196:199]
    ds_read_b64_tr_b16 a[102:103], v6 offset:4608
    v_mfma_f32_16x16x32_bf16 a[200:203], a[140:143], a[32:35], a[200:203]
    v_mfma_f32_16x16x32_bf16 a[204:207], a[140:143], a[36:39], a[204:207]
    v_mfma_f32_16x16x32_bf16 a[208:211], a[140:143], a[40:43], a[208:211]
    v_mfma_f32_16x16x32_bf16 a[212:215], a[140:143], a[44:47], a[212:215]
    v_mfma_f32_16x16x32_bf16 a[216:219], a[140:143], a[48:51], a[216:219]
    v_mfma_f32_16x16x32_bf16 a[220:223], a[140:143], a[52:55], a[220:223]
    v_mfma_f32_16x16x32_bf16 a[224:227], a[140:143], a[56:59], a[224:227]
    v_mfma_f32_16x16x32_bf16 a[228:231], a[140:143], a[60:63], a[228:231]
    s_branch L_gemm1_kernel_midB
L_gemm1_kernel_loopB:
    s_waitcnt lgkmcnt(0)
    v_mfma_f32_16x16x32_bf16 v[24:27], a[0:3], a[64:67], v[24:27]
    v_mfma_f32_16x16x32_bf16 v[28:31], a[4:7], a[64:67], v[28:31]
    v_mfma_f32_16x16x32_bf16 v[32:35], a[8:11], a[64:67], v[32:35]
    v_mfma_f32_16x16x32_bf16 v[36:39], a[12:15], a[64:67], v[36:39]
    v_mfma_f32_16x16x32_bf16 v[40:43], a[16:19], a[64:67], v[40:43]
    v_mfma_f32_16x16x32_bf16 v[44:47], a[20:23], a[64:67], v[44:47]
    v_mfma_f32_16x16x32_bf16 v[48:51], a[24:27], a[64:67], v[48:51]
    v_mfma_f32_16x16x32_bf16 v[52:55], a[28:31], a[64:67], v[52:55]
    v_mfma_f32_16x16x32_bf16 v[56:59], a[0:3], a[68:71], v[56:59]
    s_waitcnt vmcnt(18)
    v_mfma_f32_16x16x32_bf16 v[60:63], a[4:7], a[68:71], v[60:63]
    s_barrier
    v_mfma_f32_16x16x32_bf16 v[64:67], a[8:11], a[68:71], v[64:67]
    s_add_u32 m0, s44, 0
    v_mfma_f32_16x16x32_bf16 v[68:71], a[12:15], a[68:71], v[68:71]
    ds_read_b64_tr_b16 a[104:105], v3 offset:36864
    v_mfma_f32_16x16x32_bf16 v[72:75], a[16:19], a[68:71], v[72:75]
    ds_read_b64_tr_b16 a[106:107], v3 offset:37376
    v_mfma_f32_16x16x32_bf16 v[76:79], a[20:23], a[68:71], v[76:79]
    v_mfma_f32_16x16x32_bf16 v[80:83], a[24:27], a[68:71], v[80:83]
    buffer_load_dwordx4 v15, s[8:11], s40 offen offset:0 lds
    v_mfma_f32_16x16x32_bf16 v[84:87], a[28:31], a[68:71], v[84:87]
    ds_read_b128 a[32:35], v1 offset:36864
    v_mfma_f32_16x16x32_bf16 v[88:91], a[0:3], a[72:75], v[88:91]
    v_mfma_f32_16x16x32_bf16 v[92:95], a[4:7], a[72:75], v[92:95]
    ds_read_b128 a[36:39], v1 offset:37888
    v_mfma_f32_16x16x32_bf16 v[96:99], a[8:11], a[72:75], v[96:99]
    buffer_load_dwordx4 v15, s[8:11], s40 offen offset:1024 lds
    v_mfma_f32_16x16x32_bf16 v[100:103], a[12:15], a[72:75], v[100:103]
    v_mfma_f32_16x16x32_bf16 v[104:107], a[16:19], a[72:75], v[104:107]
    ds_read_b128 a[40:43], v1 offset:38912
    v_mfma_f32_16x16x32_bf16 v[108:111], a[20:23], a[72:75], v[108:111]
    ds_read_b128 a[44:47], v1 offset:39936
    v_mfma_f32_16x16x32_bf16 v[112:115], a[24:27], a[72:75], v[112:115]
    v_mfma_f32_16x16x32_bf16 v[116:119], a[28:31], a[72:75], v[116:119]
    buffer_load_dwordx4 v15, s[8:11], s40 offen offset:2048 lds
    v_mfma_f32_16x16x32_bf16 v[120:123], a[0:3], a[76:79], v[120:123]
    ds_read_b64_tr_b16 a[108:109], v4 offset:36864
    v_mfma_f32_16x16x32_bf16 v[124:127], a[4:7], a[76:79], v[124:127]
    v_mfma_f32_16x16x32_bf16 v[128:131], a[8:11], a[76:79], v[128:131]
    ds_read_b64_tr_b16 a[110:111], v4 offset:37376
    v_mfma_f32_16x16x32_bf16 v[132:135], a[12:15], a[76:79], v[132:135]
    buffer_load_dwordx4 v15, s[8:11], s40 offen offset:3072 lds
    v_mfma_f32_16x16x32_bf16 v[136:139], a[16:19], a[76:79], v[136:139]
    v_mfma_f32_16x16x32_bf16 v[140:143], a[20:23], a[76:79], v[140:143]
    ds_read_b128 a[48:51], v1 offset:40960
    v_mfma_f32_16x16x32_bf16 v[144:147], a[24:27], a[76:79], v[144:147]
    ds_read_b128 a[52:55], v1 offset:41984
    v_mfma_f32_16x16x32_bf16 v[148:151], a[28:31], a[76:79], v[148:151]
    s_add_u32 m0, s45, 0
    v_mfma_f32_16x16x32_bf16 v[152:155], a[80:83], a[0:3], v[152:155]
    v_mfma_f32_16x16x32_bf16 v[156:159], a[80:83], a[4:7], v[156:159]
    ds_read_b128 a[56:59], v1 offset:43008
    v_mfma_f32_16x16x32_bf16 v[160:163], a[80:83], a[8:11], v[160:163]
    ds_read_b128 a[60:63], v1 offset:44032
    v_mfma_f32_16x16x32_bf16 v[164:167], a[80:83], a[12:15], v[164:167]
    v_mfma_f32_16x16x32_bf16 v[168:171], a[80:83], a[16:19], v[168:171]
    s_add_u32 s40, s40, 131072
    v_mfma_f32_16x16x32_bf16 v[172:175], a[80:83], a[20:23], v[172:175]
    ds_read_b64_tr_b16 a[112:113], v3 offset:37888
    v_mfma_f32_16x16x32_bf16 v[176:179], a[80:83], a[24:27], v[176:179]
    v_mfma_f32_16x16x32_bf16 v[180:183], a[80:83], a[28:31], v[180:183]
    ds_read_b64_tr_b16 a[114:115], v3 offset:38400
    v_mfma_f32_16x16x32_bf16 v[184:187], a[84:87], a[0:3], v[184:187]
    buffer_load_dwordx4 v16, s[12:15], s41 offen lds
    v_mfma_f32_16x16x32_bf16 v[188:191], a[84:87], a[4:7], v[188:191]
    v_mfma_f32_16x16x32_bf16 v[192:195], a[84:87], a[8:11], v[192:195]
    ds_read_b64_tr_b16 a[116:117], v4 offset:37888
    v_mfma_f32_16x16x32_bf16 v[196:199], a[84:87], a[12:15], v[196:199]
    buffer_load_dwordx4 v16, s[16:19], s41 offen offset:1024 lds
    v_mfma_f32_16x16x32_bf16 v[200:203], a[84:87], a[16:19], v[200:203]
    v_mfma_f32_16x16x32_bf16 v[204:207], a[84:87], a[20:23], v[204:207]
    ds_read_b64_tr_b16 a[118:119], v4 offset:38400
    v_mfma_f32_16x16x32_bf16 v[208:211], a[84:87], a[24:27], v[208:211]
    ds_read_b64_tr_b16 a[120:121], v3 offset:38912
    v_mfma_f32_16x16x32_bf16 v[212:215], a[84:87], a[28:31], v[212:215]
    v_mfma_f32_16x16x32_bf16 v[216:219], a[88:91], a[0:3], v[216:219]
    buffer_load_dwordx4 v16, s[20:23], s41 offen offset:2048 lds
    v_mfma_f32_16x16x32_bf16 v[220:223], a[88:91], a[4:7], v[220:223]
    ds_read_b64_tr_b16 a[122:123], v3 offset:39424
    v_mfma_f32_16x16x32_bf16 v[224:227], a[88:91], a[8:11], v[224:227]
    v_mfma_f32_16x16x32_bf16 v[228:231], a[88:91], a[12:15], v[228:231]
    ds_read_b64_tr_b16 a[124:125], v4 offset:38912
    v_mfma_f32_16x16x32_bf16 v[232:235], a[88:91], a[16:19], v[232:235]
    buffer_load_dwordx4 v17, s[24:27], s42 offen offset:3072 lds
    v_mfma_f32_16x16x32_bf16 v[236:239], a[88:91], a[20:23], v[236:239]
    ds_read_b64_tr_b16 a[126:127], v4 offset:39424
    v_mfma_f32_16x16x32_bf16 v[240:243], a[88:91], a[24:27], v[240:243]
    v_mfma_f32_16x16x32_bf16 v[244:247], a[88:91], a[28:31], v[244:247]
    ds_read_b64_tr_b16 a[128:129], v3 offset:39936
    v_mfma_f32_16x16x32_bf16 v[248:251], a[92:95], a[0:3], v[248:251]
    s_add_u32 m0, s45, 4096
    v_mfma_f32_16x16x32_bf16 v[252:255], a[92:95], a[4:7], v[252:255]
    v_mfma_f32_16x16x32_bf16 a[144:147], a[92:95], a[8:11], a[144:147]
    ds_read_b64_tr_b16 a[130:131], v3 offset:40448
    v_mfma_f32_16x16x32_bf16 a[148:151], a[92:95], a[12:15], a[148:151]
    ds_read_b64_tr_b16 a[132:133], v4 offset:39936
    v_mfma_f32_16x16x32_bf16 a[152:155], a[92:95], a[16:19], a[152:155]
    v_mfma_f32_16x16x32_bf16 a[156:159], a[92:95], a[20:23], a[156:159]
    s_add_u32 s41, s41, 196608
    v_mfma_f32_16x16x32_bf16 a[160:163], a[92:95], a[24:27], a[160:163]
    ds_read_b64_tr_b16 a[134:135], v4 offset:40448
    v_mfma_f32_16x16x32_bf16 a[164:167], a[92:95], a[28:31], a[164:167]
    v_mfma_f32_16x16x32_bf16 a[168:171], a[96:99], a[0:3], a[168:171]
    ds_read_b64_tr_b16 a[136:137], v3 offset:40960
    v_mfma_f32_16x16x32_bf16 a[172:175], a[96:99], a[4:7], a[172:175]
    buffer_load_dwordx4 v17, s[28:31], s42 offen lds
    v_mfma_f32_16x16x32_bf16 a[176:179], a[96:99], a[8:11], a[176:179]
    v_mfma_f32_16x16x32_bf16 a[180:183], a[96:99], a[12:15], a[180:183]
    ds_read_b64_tr_b16 a[138:139], v3 offset:41472
    v_mfma_f32_16x16x32_bf16 a[184:187], a[96:99], a[16:19], a[184:187]
    ds_read_b64_tr_b16 a[140:141], v4 offset:40960
    v_mfma_f32_16x16x32_bf16 a[188:191], a[96:99], a[20:23], a[188:191]
    v_mfma_f32_16x16x32_bf16 a[192:195], a[96:99], a[24:27], a[192:195]
    s_add_u32 s42, s42, 229376
    v_mfma_f32_16x16x32_bf16 a[196:199], a[96:99], a[28:31], a[196:199]
    ds_read_b64_tr_b16 a[142:143], v4 offset:41472
    v_mfma_f32_16x16x32_bf16 a[200:203], a[100:103], a[0:3], a[200:203]
    v_mfma_f32_16x16x32_bf16 a[204:207], a[100:103], a[4:7], a[204:207]
    v_mfma_f32_16x16x32_bf16 a[208:211], a[100:103], a[8:11], a[208:211]
    v_mfma_f32_16x16x32_bf16 a[212:215], a[100:103], a[12:15], a[212:215]
    v_mfma_f32_16x16x32_bf16 a[216:219], a[100:103], a[16:19], a[216:219]
    v_mfma_f32_16x16x32_bf16 a[220:223], a[100:103], a[20:23], a[220:223]
    v_mfma_f32_16x16x32_bf16 a[224:227], a[100:103], a[24:27], a[224:227]
    v_mfma_f32_16x16x32_bf16 a[228:231], a[100:103], a[28:31], a[228:231]
    s_waitcnt lgkmcnt(0)
    v_mfma_f32_16x16x32_bf16 v[24:27], a[32:35], a[104:107], v[24:27]
    v_mfma_f32_16x16x32_bf16 v[28:31], a[36:39], a[104:107], v[28:31]
    v_mfma_f32_16x16x32_bf16 v[32:35], a[40:43], a[104:107], v[32:35]
    v_mfma_f32_16x16x32_bf16 v[36:39], a[44:47], a[104:107], v[36:39]
    v_mfma_f32_16x16x32_bf16 v[40:43], a[48:51], a[104:107], v[40:43]
    v_mfma_f32_16x16x32_bf16 v[44:47], a[52:55], a[104:107], v[44:47]
    v_mfma_f32_16x16x32_bf16 v[48:51], a[56:59], a[104:107], v[48:51]
    v_mfma_f32_16x16x32_bf16 v[52:55], a[60:63], a[104:107], v[52:55]
    v_mfma_f32_16x16x32_bf16 v[56:59], a[32:35], a[108:111], v[56:59]
    s_waitcnt vmcnt(18)
    v_mfma_f32_16x16x32_bf16 v[60:63], a[36:39], a[108:111], v[60:63]
    s_barrier
    v_mfma_f32_16x16x32_bf16 v[64:67], a[40:43], a[108:111], v[64:67]
    s_add_u32 m0, s44, 36864
    v_mfma_f32_16x16x32_bf16 v[68:71], a[44:47], a[108:111], v[68:71]
    ds_read_b64_tr_b16 a[64:65], v5 offset:0
    v_mfma_f32_16x16x32_bf16 v[72:75], a[48:51], a[108:111], v[72:75]
    ds_read_b64_tr_b16 a[66:67], v5 offset:512
    v_mfma_f32_16x16x32_bf16 v[76:79], a[52:55], a[108:111], v[76:79]
    v_mfma_f32_16x16x32_bf16 v[80:83], a[56:59], a[108:111], v[80:83]
    buffer_load_dwordx4 v15, s[8:11], s40 offen offset:0 lds
    v_mfma_f32_16x16x32_bf16 v[84:87], a[60:63], a[108:111], v[84:87]
    ds_read_b128 a[0:3], v2 offset:0
    v_mfma_f32_16x16x32_bf16 v[88:91], a[32:35], a[112:115], v[88:91]
    v_mfma_f32_16x16x32_bf16 v[92:95], a[36:39], a[112:115], v[92:95]
    ds_read_b128 a[4:7], v2 offset:1024
    v_mfma_f32_16x16x32_bf16 v[96:99], a[40:43], a[112:115], v[96:99]
    buffer_load_dwordx4 v15, s[8:11], s40 offen offset:1024 lds
    v_mfma_f32_16x16x32_bf16 v[100:103], a[44:47], a[112:115], v[100:103]
    v_mfma_f32_16x16x32_bf16 v[104:107], a[48:51], a[112:115], v[104:107]
    ds_read_b128 a[8:11], v2 offset:2048
    v_mfma_f32_16x16x32_bf16 v[108:111], a[52:55], a[112:115], v[108:111]
    ds_read_b128 a[12:15], v2 offset:3072
    v_mfma_f32_16x16x32_bf16 v[112:115], a[56:59], a[112:115], v[112:115]
    v_mfma_f32_16x16x32_bf16 v[116:119], a[60:63], a[112:115], v[116:119]
    buffer_load_dwordx4 v15, s[8:11], s40 offen offset:2048 lds
    v_mfma_f32_16x16x32_bf16 v[120:123], a[32:35], a[116:119], v[120:123]
    ds_read_b64_tr_b16 a[68:69], v6 offset:0
    v_mfma_f32_16x16x32_bf16 v[124:127], a[36:39], a[116:119], v[124:127]
    v_mfma_f32_16x16x32_bf16 v[128:131], a[40:43], a[116:119], v[128:131]
    ds_read_b64_tr_b16 a[70:71], v6 offset:512
    v_mfma_f32_16x16x32_bf16 v[132:135], a[44:47], a[116:119], v[132:135]
    buffer_load_dwordx4 v15, s[8:11], s40 offen offset:3072 lds
    v_mfma_f32_16x16x32_bf16 v[136:139], a[48:51], a[116:119], v[136:139]
    v_mfma_f32_16x16x32_bf16 v[140:143], a[52:55], a[116:119], v[140:143]
    ds_read_b128 a[16:19], v2 offset:4096
    v_mfma_f32_16x16x32_bf16 v[144:147], a[56:59], a[116:119], v[144:147]
    ds_read_b128 a[20:23], v2 offset:5120
    v_mfma_f32_16x16x32_bf16 v[148:151], a[60:63], a[116:119], v[148:151]
    s_add_u32 m0, s45, 36864
    v_mfma_f32_16x16x32_bf16 v[152:155], a[120:123], a[32:35], v[152:155]
    v_mfma_f32_16x16x32_bf16 v[156:159], a[120:123], a[36:39], v[156:159]
    ds_read_b128 a[24:27], v2 offset:6144
    v_mfma_f32_16x16x32_bf16 v[160:163], a[120:123], a[40:43], v[160:163]
    ds_read_b128 a[28:31], v2 offset:7168
    v_mfma_f32_16x16x32_bf16 v[164:167], a[120:123], a[44:47], v[164:167]
    v_mfma_f32_16x16x32_bf16 v[168:171], a[120:123], a[48:51], v[168:171]
    s_add_u32 s40, s40, 131072
    v_mfma_f32_16x16x32_bf16 v[172:175], a[120:123], a[52:55], v[172:175]
    ds_read_b64_tr_b16 a[72:73], v5 offset:1024
    v_mfma_f32_16x16x32_bf16 v[176:179], a[120:123], a[56:59], v[176:179]
    v_mfma_f32_16x16x32_bf16 v[180:183], a[120:123], a[60:63], v[180:183]
    ds_read_b64_tr_b16 a[74:75], v5 offset:1536
    v_mfma_f32_16x16x32_bf16 v[184:187], a[124:127], a[32:35], v[184:187]
    buffer_load_dwordx4 v16, s[12:15], s41 offen lds
    v_mfma_f32_16x16x32_bf16 v[188:191], a[124:127], a[36:39], v[188:191]
    v_mfma_f32_16x16x32_bf16 v[192:195], a[124:127], a[40:43], v[192:195]
    ds_read_b64_tr_b16 a[76:77], v6 offset:1024
    v_mfma_f32_16x16x32_bf16 v[196:199], a[124:127], a[44:47], v[196:199]
    buffer_load_dwordx4 v16, s[16:19], s41 offen offset:1024 lds
    v_mfma_f32_16x16x32_bf16 v[200:203], a[124:127], a[48:51], v[200:203]
    v_mfma_f32_16x16x32_bf16 v[204:207], a[124:127], a[52:55], v[204:207]
    ds_read_b64_tr_b16 a[78:79], v6 offset:1536
    v_mfma_f32_16x16x32_bf16 v[208:211], a[124:127], a[56:59], v[208:211]
    ds_read_b64_tr_b16 a[80:81], v5 offset:2048
    v_mfma_f32_16x16x32_bf16 v[212:215], a[124:127], a[60:63], v[212:215]
    v_mfma_f32_16x16x32_bf16 v[216:219], a[128:131], a[32:35], v[216:219]
    buffer_load_dwordx4 v16, s[20:23], s41 offen offset:2048 lds
    v_mfma_f32_16x16x32_bf16 v[220:223], a[128:131], a[36:39], v[220:223]
    ds_read_b64_tr_b16 a[82:83], v5 offset:2560
    v_mfma_f32_16x16x32_bf16 v[224:227], a[128:131], a[40:43], v[224:227]
    v_mfma_f32_16x16x32_bf16 v[228:231], a[128:131], a[44:47], v[228:231]
    ds_read_b64_tr_b16 a[84:85], v6 offset:2048
    v_mfma_f32_16x16x32_bf16 v[232:235], a[128:131], a[48:51], v[232:235]
    buffer_load_dwordx4 v17, s[24:27], s42 offen offset:3072 lds
    v_mfma_f32_16x16x32_bf16 v[236:239], a[128:131], a[52:55], v[236:239]
    ds_read_b64_tr_b16 a[86:87], v6 offset:2560
    v_mfma_f32_16x16x32_bf16 v[240:243], a[128:131], a[56:59], v[240:243]
    v_mfma_f32_16x16x32_bf16 v[244:247], a[128:131], a[60:63], v[244:247]
    ds_read_b64_tr_b16 a[88:89], v5 offset:3072
    v_mfma_f32_16x16x32_bf16 v[248:251], a[132:135], a[32:35], v[248:251]
    s_add_u32 m0, s45, 40960
    v_mfma_f32_16x16x32_bf16 v[252:255], a[132:135], a[36:39], v[252:255]
    v_mfma_f32_16x16x32_bf16 a[144:147], a[132:135], a[40:43], a[144:147]
    ds_read_b64_tr_b16 a[90:91], v5 offset:3584
    v_mfma_f32_16x16x32_bf16 a[148:151], a[132:135], a[44:47], a[148:151]
    ds_read_b64_tr_b16 a[92:93], v6 offset:3072
    v_mfma_f32_16x16x32_bf16 a[152:155], a[132:135], a[48:51], a[152:155]
    v_mfma_f32_16x16x32_bf16 a[156:159], a[132:135], a[52:55], a[156:159]
    s_add_u32 s41, s41, 196608
    v_mfma_f32_16x16x32_bf16 a[160:163], a[132:135], a[56:59], a[160:163]
    ds_read_b64_tr_b16 a[94:95], v6 offset:3584
    v_mfma_f32_16x16x32_bf16 a[164:167], a[132:135], a[60:63], a[164:167]
    v_mfma_f32_16x16x32_bf16 a[168:171], a[136:139], a[32:35], a[168:171]
    ds_read_b64_tr_b16 a[96:97], v5 offset:4096
    v_mfma_f32_16x16x32_bf16 a[172:175], a[136:139], a[36:39], a[172:175]
    buffer_load_dwordx4 v17, s[28:31], s42 offen lds
    v_mfma_f32_16x16x32_bf16 a[176:179], a[136:139], a[40:43], a[176:179]
    v_mfma_f32_16x16x32_bf16 a[180:183], a[136:139], a[44:47], a[180:183]
    ds_read_b64_tr_b16 a[98:99], v5 offset:4608
    v_mfma_f32_16x16x32_bf16 a[184:187], a[136:139], a[48:51], a[184:187]
    ds_read_b64_tr_b16 a[100:101], v6 offset:4096
    v_mfma_f32_16x16x32_bf16 a[188:191], a[136:139], a[52:55], a[188:191]
    v_mfma_f32_16x16x32_bf16 a[192:195], a[136:139], a[56:59], a[192:195]
    s_add_u32 s42, s42, 229376
    v_mfma_f32_16x16x32_bf16 a[196:199], a[136:139], a[60:63], a[196:199]
    ds_read_b64_tr_b16 a[102:103], v6 offset:4608
    v_mfma_f32_16x16x32_bf16 a[200:203], a[140:143], a[32:35], a[200:203]
    v_mfma_f32_16x16x32_bf16 a[204:207], a[140:143], a[36:39], a[204:207]
    v_mfma_f32_16x16x32_bf16 a[208:211], a[140:143], a[40:43], a[208:211]
    v_mfma_f32_16x16x32_bf16 a[212:215], a[140:143], a[44:47], a[212:215]
    v_mfma_f32_16x16x32_bf16 a[216:219], a[140:143], a[48:51], a[216:219]
    v_mfma_f32_16x16x32_bf16 a[220:223], a[140:143], a[52:55], a[220:223]
    v_mfma_f32_16x16x32_bf16 a[224:227], a[140:143], a[56:59], a[224:227]
    v_mfma_f32_16x16x32_bf16 a[228:231], a[140:143], a[60:63], a[228:231]
L_gemm1_kernel_midB:
    s_waitcnt lgkmcnt(0)
    v_mfma_f32_16x16x32_bf16 v[24:27], a[0:3], a[64:67], v[24:27]
    v_mfma_f32_16x16x32_bf16 v[28:31], a[4:7], a[64:67], v[28:31]
    v_mfma_f32_16x16x32_bf16 v[32:35], a[8:11], a[64:67], v[32:35]
    v_mfma_f32_16x16x32_bf16 v[36:39], a[12:15], a[64:67], v[36:39]
    v_mfma_f32_16x16x32_bf16 v[40:43], a[16:19], a[64:67], v[40:43]
    v_mfma_f32_16x16x32_bf16 v[44:47], a[20:23], a[64:67], v[44:47]
    v_mfma_f32_16x16x32_bf16 v[48:51], a[24:27], a[64:67], v[48:51]
    v_mfma_f32_16x16x32_bf16 v[52:55], a[28:31], a[64:67], v[52:55]
    v_mfma_f32_16x16x32_bf16 v[56:59], a[0:3], a[68:71], v[56:59]
    s_waitcnt vmcnt(18)
    v_mfma_f32_16x16x32_bf16 v[60:63], a[4:7], a[68:71], v[60:63]
    s_barrier
    v_mfma_f32_16x16x32_bf16 v[64:67], a[8:11], a[68:71], v[64:67]
    s_add_u32 m0, s44, 73728
    v_mfma_f32_16x16x32_bf16 v[68:71], a[12:15], a[68:71], v[68:71]
    ds_read_b64_tr_b16 a[104:105], v5 offset:36864
    v_mfma_f32_16x16x32_bf16 v[72:75], a[16:19], a[68:71], v[72:75]
    ds_read_b64_tr_b16 a[106:107], v5 offset:37376
    v_mfma_f32_16x16x32_bf16 v[76:79], a[20:23], a[68:71], v[76:79]
    v_mfma_f32_16x16x32_bf16 v[80:83], a[24:27], a[68:71], v[80:83]
    buffer_load_dwordx4 v15, s[8:11], s40 offen offset:0 lds
    v_mfma_f32_16x16x32_bf16 v[84:87], a[28:31], a[68:71], v[84:87]
    ds_read_b128 a[32:35], v2 offset:36864
    v_mfma_f32_16x16x32_bf16 v[88:91], a[0:3], a[72:75], v[88:91]
    v_mfma_f32_16x16x32_bf16 v[92:95], a[4:7], a[72:75], v[92:95]
    ds_read_b128 a[36:39], v2 offset:37888
    v_mfma_f32_16x16x32_bf16 v[96:99], a[8:11], a[72:75], v[96:99]
    buffer_load_dwordx4 v15, s[8:11], s40 offen offset:1024 lds
    v_mfma_f32_16x16x32_bf16 v[100:103], a[12:15], a[72:75], v[100:103]
    v_mfma_f32_16x16x32_bf16 v[104:107], a[16:19], a[72:75], v[104:107]
    ds_read_b128 a[40:43], v2 offset:38912
    v_mfma_f32_16x16x32_bf16 v[108:111], a[20:23], a[72:75], v[108:111]
    ds_read_b128 a[44:47], v2 offset:39936
    v_mfma_f32_16x16x32_bf16 v[112:115], a[24:27], a[72:75], v[112:115]
    v_mfma_f32_16x16x32_bf16 v[116:119], a[28:31], a[72:75], v[116:119]
    buffer_load_dwordx4 v15, s[8:11], s40 offen offset:2048 lds
    v_mfma_f32_16x16x32_bf16 v[120:123], a[0:3], a[76:79], v[120:123]
    ds_read_b64_tr_b16 a[108:109], v6 offset:36864
    v_mfma_f32_16x16x32_bf16 v[124:127], a[4:7], a[76:79], v[124:127]
    v_mfma_f32_16x16x32_bf16 v[128:131], a[8:11], a[76:79], v[128:131]
    ds_read_b64_tr_b16 a[110:111], v6 offset:37376
    v_mfma_f32_16x16x32_bf16 v[132:135], a[12:15], a[76:79], v[132:135]
    buffer_load_dwordx4 v15, s[8:11], s40 offen offset:3072 lds
    v_mfma_f32_16x16x32_bf16 v[136:139], a[16:19], a[76:79], v[136:139]
    v_mfma_f32_16x16x32_bf16 v[140:143], a[20:23], a[76:79], v[140:143]
    ds_read_b128 a[48:51], v2 offset:40960
    v_mfma_f32_16x16x32_bf16 v[144:147], a[24:27], a[76:79], v[144:147]
    ds_read_b128 a[52:55], v2 offset:41984
    v_mfma_f32_16x16x32_bf16 v[148:151], a[28:31], a[76:79], v[148:151]
    s_add_u32 m0, s45, 73728
    v_mfma_f32_16x16x32_bf16 v[152:155], a[80:83], a[0:3], v[152:155]
    v_mfma_f32_16x16x32_bf16 v[156:159], a[80:83], a[4:7], v[156:159]
    ds_read_b128 a[56:59], v2 offset:43008
    v_mfma_f32_16x16x32_bf16 v[160:163], a[80:83], a[8:11], v[160:163]
    ds_read_b128 a[60:63], v2 offset:44032
    v_mfma_f32_16x16x32_bf16 v[164:167], a[80:83], a[12:15], v[164:167]
    v_mfma_f32_16x16x32_bf16 v[168:171], a[80:83], a[16:19], v[168:171]
    s_add_u32 s40, s40, 131072
    v_mfma_f32_16x16x32_bf16 v[172:175], a[80:83], a[20:23], v[172:175]
    ds_read_b64_tr_b16 a[112:113], v5 offset:37888
    v_mfma_f32_16x16x32_bf16 v[176:179], a[80:83], a[24:27], v[176:179]
    v_mfma_f32_16x16x32_bf16 v[180:183], a[80:83], a[28:31], v[180:183]
    ds_read_b64_tr_b16 a[114:115], v5 offset:38400
    v_mfma_f32_16x16x32_bf16 v[184:187], a[84:87], a[0:3], v[184:187]
    buffer_load_dwordx4 v16, s[12:15], s41 offen lds
    v_mfma_f32_16x16x32_bf16 v[188:191], a[84:87], a[4:7], v[188:191]
    v_mfma_f32_16x16x32_bf16 v[192:195], a[84:87], a[8:11], v[192:195]
    ds_read_b64_tr_b16 a[116:117], v6 offset:37888
    v_mfma_f32_16x16x32_bf16 v[196:199], a[84:87], a[12:15], v[196:199]
    buffer_load_dwordx4 v16, s[16:19], s41 offen offset:1024 lds
    v_mfma_f32_16x16x32_bf16 v[200:203], a[84:87], a[16:19], v[200:203]
    v_mfma_f32_16x16x32_bf16 v[204:207], a[84:87], a[20:23], v[204:207]
    ds_read_b64_tr_b16 a[118:119], v6 offset:38400
    v_mfma_f32_16x16x32_bf16 v[208:211], a[84:87], a[24:27], v[208:211]
    ds_read_b64_tr_b16 a[120:121], v5 offset:38912
    v_mfma_f32_16x16x32_bf16 v[212:215], a[84:87], a[28:31], v[212:215]
    v_mfma_f32_16x16x32_bf16 v[216:219], a[88:91], a[0:3], v[216:219]
    buffer_load_dwordx4 v16, s[20:23], s41 offen offset:2048 lds
    v_mfma_f32_16x16x32_bf16 v[220:223], a[88:91], a[4:7], v[220:223]
    ds_read_b64_tr_b16 a[122:123], v5 offset:39424
    v_mfma_f32_16x16x32_bf16 v[224:227], a[88:91], a[8:11], v[224:227]
    v_mfma_f32_16x16x32_bf16 v[228:231], a[88:91], a[12:15], v[228:231]
    ds_read_b64_tr_b16 a[124:125], v6 offset:38912
    v_mfma_f32_16x16x32_bf16 v[232:235], a[88:91], a[16:19], v[232:235]
    buffer_load_dwordx4 v17, s[24:27], s42 offen offset:3072 lds
    v_mfma_f32_16x16x32_bf16 v[236:239], a[88:91], a[20:23], v[236:239]
    ds_read_b64_tr_b16 a[126:127], v6 offset:39424
    v_mfma_f32_16x16x32_bf16 v[240:243], a[88:91], a[24:27], v[240:243]
    v_mfma_f32_16x16x32_bf16 v[244:247], a[88:91], a[28:31], v[244:247]
    ds_read_b64_tr_b16 a[128:129], v5 offset:39936
    v_mfma_f32_16x16x32_bf16 v[248:251], a[92:95], a[0:3], v[248:251]
    s_add_u32 m0, s45, 77824
    v_mfma_f32_16x16x32_bf16 v[252:255], a[92:95], a[4:7], v[252:255]
    v_mfma_f32_16x16x32_bf16 a[144:147], a[92:95], a[8:11], a[144:147]
    ds_read_b64_tr_b16 a[130:131], v5 offset:40448
    v_mfma_f32_16x16x32_bf16 a[148:151], a[92:95], a[12:15], a[148:151]
    ds_read_b64_tr_b16 a[132:133], v6 offset:39936
    v_mfma_f32_16x16x32_bf16 a[152:155], a[92:95], a[16:19], a[152:155]
    v_mfma_f32_16x16x32_bf16 a[156:159], a[92:95], a[20:23], a[156:159]
    s_add_u32 s41, s41, 196608
    v_mfma_f32_16x16x32_bf16 a[160:163], a[92:95], a[24:27], a[160:163]
    ds_read_b64_tr_b16 a[134:135], v6 offset:40448
    v_mfma_f32_16x16x32_bf16 a[164:167], a[92:95], a[28:31], a[164:167]
    v_mfma_f32_16x16x32_bf16 a[168:171], a[96:99], a[0:3], a[168:171]
    ds_read_b64_tr_b16 a[136:137], v5 offset:40960
    v_mfma_f32_16x16x32_bf16 a[172:175], a[96:99], a[4:7], a[172:175]
    buffer_load_dwordx4 v17, s[28:31], s42 offen lds
    v_mfma_f32_16x16x32_bf16 a[176:179], a[96:99], a[8:11], a[176:179]
    v_mfma_f32_16x16x32_bf16 a[180:183], a[96:99], a[12:15], a[180:183]
    ds_read_b64_tr_b16 a[138:139], v5 offset:41472
    v_mfma_f32_16x16x32_bf16 a[184:187], a[96:99], a[16:19], a[184:187]
    ds_read_b64_tr_b16 a[140:141], v6 offset:40960
    v_mfma_f32_16x16x32_bf16 a[188:191], a[96:99], a[20:23], a[188:191]
    v_mfma_f32_16x16x32_bf16 a[192:195], a[96:99], a[24:27], a[192:195]
    s_add_u32 s42, s42, 229376
    v_mfma_f32_16x16x32_bf16 a[196:199], a[96:99], a[28:31], a[196:199]
    ds_read_b64_tr_b16 a[142:143], v6 offset:41472
    v_mfma_f32_16x16x32_bf16 a[200:203], a[100:103], a[0:3], a[200:203]
    v_mfma_f32_16x16x32_bf16 a[204:207], a[100:103], a[4:7], a[204:207]
    v_mfma_f32_16x16x32_bf16 a[208:211], a[100:103], a[8:11], a[208:211]
    v_mfma_f32_16x16x32_bf16 a[212:215], a[100:103], a[12:15], a[212:215]
    v_mfma_f32_16x16x32_bf16 a[216:219], a[100:103], a[16:19], a[216:219]
    v_mfma_f32_16x16x32_bf16 a[220:223], a[100:103], a[20:23], a[220:223]
    v_mfma_f32_16x16x32_bf16 a[224:227], a[100:103], a[24:27], a[224:227]
    v_mfma_f32_16x16x32_bf16 a[228:231], a[100:103], a[28:31], a[228:231]
    s_waitcnt lgkmcnt(0)
    v_mfma_f32_16x16x32_bf16 v[24:27], a[32:35], a[104:107], v[24:27]
    v_mfma_f32_16x16x32_bf16 v[28:31], a[36:39], a[104:107], v[28:31]
    v_mfma_f32_16x16x32_bf16 v[32:35], a[40:43], a[104:107], v[32:35]
    v_mfma_f32_16x16x32_bf16 v[36:39], a[44:47], a[104:107], v[36:39]
    v_mfma_f32_16x16x32_bf16 v[40:43], a[48:51], a[104:107], v[40:43]
    v_mfma_f32_16x16x32_bf16 v[44:47], a[52:55], a[104:107], v[44:47]
    v_mfma_f32_16x16x32_bf16 v[48:51], a[56:59], a[104:107], v[48:51]
    v_mfma_f32_16x16x32_bf16 v[52:55], a[60:63], a[104:107], v[52:55]
    v_mfma_f32_16x16x32_bf16 v[56:59], a[32:35], a[108:111], v[56:59]
    s_waitcnt vmcnt(18)
    v_mfma_f32_16x16x32_bf16 v[60:63], a[36:39], a[108:111], v[60:63]
    s_barrier
    v_mfma_f32_16x16x32_bf16 v[64:67], a[40:43], a[108:111], v[64:67]
    s_add_u32 m0, s44, 110592
    v_mfma_f32_16x16x32_bf16 v[68:71], a[44:47], a[108:111], v[68:71]
    ds_read_b64_tr_b16 a[64:65], v3 offset:0
    v_mfma_f32_16x16x32_bf16 v[72:75], a[48:51], a[108:111], v[72:75]
    ds_read_b64_tr_b16 a[66:67], v3 offset:512
    v_mfma_f32_16x16x32_bf16 v[76:79], a[52:55], a[108:111], v[76:79]
    v_mfma_f32_16x16x32_bf16 v[80:83], a[56:59], a[108:111], v[80:83]
    buffer_load_dwordx4 v15, s[8:11], s40 offen offset:0 lds
    v_mfma_f32_16x16x32_bf16 v[84:87], a[60:63], a[108:111], v[84:87]
    ds_read_b128 a[0:3], v1 offset:0
    v_mfma_f32_16x16x32_bf16 v[88:91], a[32:35], a[112:115], v[88:91]
    v_mfma_f32_16x16x32_bf16 v[92:95], a[36:39], a[112:115], v[92:95]
    ds_read_b128 a[4:7], v1 offset:1024
    v_mfma_f32_16x16x32_bf16 v[96:99], a[40:43], a[112:115], v[96:99]
    buffer_load_dwordx4 v15, s[8:11], s40 offen offset:1024 lds
    v_mfma_f32_16x16x32_bf16 v[100:103], a[44:47], a[112:115], v[100:103]
    v_mfma_f32_16x16x32_bf16 v[104:107], a[48:51], a[112:115], v[104:107]
    ds_read_b128 a[8:11], v1 offset:2048
    v_mfma_f32_16x16x32_bf16 v[108:111], a[52:55], a[112:115], v[108:111]
    ds_read_b128 a[12:15], v1 offset:3072
    v_mfma_f32_16x16x32_bf16 v[112:115], a[56:59], a[112:115], v[112:115]
    v_mfma_f32_16x16x32_bf16 v[116:119], a[60:63], a[112:115], v[116:119]
    buffer_load_dwordx4 v15, s[8:11], s40 offen offset:2048 lds
    v_mfma_f32_16x16x32_bf16 v[120:123], a[32:35], a[116:119], v[120:123]
    ds_read_b64_tr_b16 a[68:69], v4 offset:0
    v_mfma_f32_16x16x32_bf16 v[124:127], a[36:39], a[116:119], v[124:127]
    v_mfma_f32_16x16x32_bf16 v[128:131], a[40:43], a[116:119], v[128:131]
    ds_read_b64_tr_b16 a[70:71], v4 offset:512
    v_mfma_f32_16x16x32_bf16 v[132:135], a[44:47], a[116:119], v[132:135]
    buffer_load_dwordx4 v15, s[8:11], s40 offen offset:3072 lds
    v_mfma_f32_16x16x32_bf16 v[136:139], a[48:51], a[116:119], v[136:139]
    v_mfma_f32_16x16x32_bf16 v[140:143], a[52:55], a[116:119], v[140:143]
    ds_read_b128 a[16:19], v1 offset:4096
    v_mfma_f32_16x16x32_bf16 v[144:147], a[56:59], a[116:119], v[144:147]
    ds_read_b128 a[20:23], v1 offset:5120
    v_mfma_f32_16x16x32_bf16 v[148:151], a[60:63], a[116:119], v[148:151]
    s_add_u32 m0, s45, 110592
    v_mfma_f32_16x16x32_bf16 v[152:155], a[120:123], a[32:35], v[152:155]
    v_mfma_f32_16x16x32_bf16 v[156:159], a[120:123], a[36:39], v[156:159]
    ds_read_b128 a[24:27], v1 offset:6144
    v_mfma_f32_16x16x32_bf16 v[160:163], a[120:123], a[40:43], v[160:163]
    ds_read_b128 a[28:31], v1 offset:7168
    v_mfma_f32_16x16x32_bf16 v[164:167], a[120:123], a[44:47], v[164:167]
    v_mfma_f32_16x16x32_bf16 v[168:171], a[120:123], a[48:51], v[168:171]
    s_add_u32 s40, s40, 131072
    v_mfma_f32_16x16x32_bf16 v[172:175], a[120:123], a[52:55], v[172:175]
    ds_read_b64_tr_b16 a[72:73], v3 offset:1024
    v_mfma_f32_16x16x32_bf16 v[176:179], a[120:123], a[56:59], v[176:179]
    v_mfma_f32_16x16x32_bf16 v[180:183], a[120:123], a[60:63], v[180:183]
    ds_read_b64_tr_b16 a[74:75], v3 offset:1536
    v_mfma_f32_16x16x32_bf16 v[184:187], a[124:127], a[32:35], v[184:187]
    buffer_load_dwordx4 v16, s[12:15], s41 offen lds
    v_mfma_f32_16x16x32_bf16 v[188:191], a[124:127], a[36:39], v[188:191]
    v_mfma_f32_16x16x32_bf16 v[192:195], a[124:127], a[40:43], v[192:195]
    ds_read_b64_tr_b16 a[76:77], v4 offset:1024
    v_mfma_f32_16x16x32_bf16 v[196:199], a[124:127], a[44:47], v[196:199]
    buffer_load_dwordx4 v16, s[16:19], s41 offen offset:1024 lds
    v_mfma_f32_16x16x32_bf16 v[200:203], a[124:127], a[48:51], v[200:203]
    v_mfma_f32_16x16x32_bf16 v[204:207], a[124:127], a[52:55], v[204:207]
    ds_read_b64_tr_b16 a[78:79], v4 offset:1536
    v_mfma_f32_16x16x32_bf16 v[208:211], a[124:127], a[56:59], v[208:211]
    ds_read_b64_tr_b16 a[80:81], v3 offset:2048
    v_mfma_f32_16x16x32_bf16 v[212:215], a[124:127], a[60:63], v[212:215]
    v_mfma_f32_16x16x32_bf16 v[216:219], a[128:131], a[32:35], v[216:219]
    buffer_load_dwordx4 v16, s[20:23], s41 offen offset:2048 lds
    v_mfma_f32_16x16x32_bf16 v[220:223], a[128:131], a[36:39], v[220:223]
    ds_read_b64_tr_b16 a[82:83], v3 offset:2560
    v_mfma_f32_16x16x32_bf16 v[224:227], a[128:131], a[40:43], v[224:227]
    v_mfma_f32_16x16x32_bf16 v[228:231], a[128:131], a[44:47], v[228:231]
    ds_read_b64_tr_b16 a[84:85], v4 offset:2048
    v_mfma_f32_16x16x32_bf16 v[232:235], a[128:131], a[48:51], v[232:235]
    buffer_load_dwordx4 v17, s[24:27], s42 offen offset:3072 lds
    v_mfma_f32_16x16x32_bf16 v[236:239], a[128:131], a[52:55], v[236:239]
    ds_read_b64_tr_b16 a[86:87], v4 offset:2560
    v_mfma_f32_16x16x32_bf16 v[240:243], a[128:131], a[56:59], v[240:243]
    v_mfma_f32_16x16x32_bf16 v[244:247], a[128:131], a[60:63], v[244:247]
    ds_read_b64_tr_b16 a[88:89], v3 offset:3072
    v_mfma_f32_16x16x32_bf16 v[248:251], a[132:135], a[32:35], v[248:251]
    s_add_u32 m0, s45, 114688
    v_mfma_f32_16x16x32_bf16 v[252:255], a[132:135], a[36:39], v[252:255]
    v_mfma_f32_16x16x32_bf16 a[144:147], a[132:135], a[40:43], a[144:147]
    ds_read_b64_tr_b16 a[90:91], v3 offset:3584
    v_mfma_f32_16x16x32_bf16 a[148:151], a[132:135], a[44:47], a[148:151]
    ds_read_b64_tr_b16 a[92:93], v4 offset:3072
    v_mfma_f32_16x16x32_bf16 a[152:155], a[132:135], a[48:51], a[152:155]
    v_mfma_f32_16x16x32_bf16 a[156:159], a[132:135], a[52:55], a[156:159]
    s_add_u32 s41, s41, 196608
    v_mfma_f32_16x16x32_bf16 a[160:163], a[132:135], a[56:59], a[160:163]
    ds_read_b64_tr_b16 a[94:95], v4 offset:3584
    v_mfma_f32_16x16x32_bf16 a[164:167], a[132:135], a[60:63], a[164:167]
    v_mfma_f32_16x16x32_bf16 a[168:171], a[136:139], a[32:35], a[168:171]
    ds_read_b64_tr_b16 a[96:97], v3 offset:4096
    v_mfma_f32_16x16x32_bf16 a[172:175], a[136:139], a[36:39], a[172:175]
    buffer_load_dwordx4 v17, s[28:31], s42 offen lds
    v_mfma_f32_16x16x32_bf16 a[176:179], a[136:139], a[40:43], a[176:179]
    v_mfma_f32_16x16x32_bf16 a[180:183], a[136:139], a[44:47], a[180:183]
    ds_read_b64_tr_b16 a[98:99], v3 offset:4608
    v_mfma_f32_16x16x32_bf16 a[184:187], a[136:139], a[48:51], a[184:187]
    ds_read_b64_tr_b16 a[100:101], v4 offset:4096
    v_mfma_f32_16x16x32_bf16 a[188:191], a[136:139], a[52:55], a[188:191]
    v_mfma_f32_16x16x32_bf16 a[192:195], a[136:139], a[56:59], a[192:195]
    s_add_u32 s42, s42, 229376
    v_mfma_f32_16x16x32_bf16 a[196:199], a[136:139], a[60:63], a[196:199]
    ds_read_b64_tr_b16 a[102:103], v4 offset:4608
    v_mfma_f32_16x16x32_bf16 a[200:203], a[140:143], a[32:35], a[200:203]
    v_mfma_f32_16x16x32_bf16 a[204:207], a[140:143], a[36:39], a[204:207]
    v_mfma_f32_16x16x32_bf16 a[208:211], a[140:143], a[40:43], a[208:211]
    v_mfma_f32_16x16x32_bf16 a[212:215], a[140:143], a[44:47], a[212:215]
    v_mfma_f32_16x16x32_bf16 a[216:219], a[140:143], a[48:51], a[216:219]
    s_sub_u32 s46, s46, 1
    v_mfma_f32_16x16x32_bf16 a[220:223], a[140:143], a[52:55], a[220:223]
    s_cmp_lg_u32 s46, 0
    v_mfma_f32_16x16x32_bf16 a[224:227], a[140:143], a[56:59], a[224:227]
    v_mfma_f32_16x16x32_bf16 a[228:231], a[140:143], a[60:63], a[228:231]
    s_cbranch_scc1 L_gemm1_kernel_loopB
    s_waitcnt lgkmcnt(0)
    v_mfma_f32_16x16x32_bf16 v[24:27], a[0:3], a[64:67], v[24:27]
    v_mfma_f32_16x16x32_bf16 v[28:31], a[4:7], a[64:67], v[28:31]
    v_mfma_f32_16x16x32_bf16 v[32:35], a[8:11], a[64:67], v[32:35]
    v_mfma_f32_16x16x32_bf16 v[36:39], a[12:15], a[64:67], v[36:39]
    v_mfma_f32_16x16x32_bf16 v[40:43], a[16:19], a[64:67], v[40:43]
    v_mfma_f32_16x16x32_bf16 v[44:47], a[20:23], a[64:67], v[44:47]
    v_mfma_f32_16x16x32_bf16 v[48:51], a[24:27], a[64:67], v[48:51]
    s_waitcnt vmcnt(18)
    v_mfma_f32_16x16x32_bf16 v[52:55], a[28:31], a[64:67], v[52:55]
    s_barrier
    buffer_load_dword v22, v21, s[72:75], s47 offen
    v_mfma_f32_16x16x32_bf16 v[56:59], a[0:3], a[68:71], v[56:59]
    ds_read_b64_tr_b16 a[104:105], v3 offset:36864
    s_add_u32 s47, s47, 1048576
    v_mfma_f32_16x16x32_bf16 v[60:63], a[4:7], a[68:71], v[60:63]
    ds_read_b64_tr_b16 a[106:107], v3 offset:37376
    v_mfma_f32_16x16x32_bf16 v[64:67], a[8:11], a[68:71], v[64:67]
    buffer_load_dword v22, v21, s[72:75], s47 offen
    v_mfma_f32_16x16x32_bf16 v[68:71], a[12:15], a[68:71], v[68:71]
    ds_read_b128 a[32:35], v1 offset:36864
    v_mfma_f32_16x16x32_bf16 v[72:75], a[16:19], a[68:71], v[72:75]
    ds_read_b128 a[36:39], v1 offset:37888
    s_add_u32 s47, s47, 1048576
    v_mfma_f32_16x16x32_bf16 v[76:79], a[20:23], a[68:71], v[76:79]
    v_mfma_f32_16x16x32_bf16 v[80:83], a[24:27], a[68:71], v[80:83]
    ds_read_b128 a[40:43], v1 offset:38912
    buffer_load_dword v22, v21, s[72:75], s47 offen
    v_mfma_f32_16x16x32_bf16 v[84:87], a[28:31], a[68:71], v[84:87]
    s_add_u32 s47, s47, 1048576
    v_mfma_f32_16x16x32_bf16 v[88:91], a[0:3], a[72:75], v[88:91]
    ds_read_b128 a[44:47], v1 offset:39936
    v_mfma_f32_16x16x32_bf16 v[92:95], a[4:7], a[72:75], v[92:95]
    ds_read_b64_tr_b16 a[108:109], v4 offset:36864
    v_mfma_f32_16x16x32_bf16 v[96:99], a[8:11], a[72:75], v[96:99]
    buffer_load_dword v22, v21, s[72:75], s47 offen
    v_mfma_f32_16x16x32_bf16 v[100:103], a[12:15], a[72:75], v[100:103]
    ds_read_b64_tr_b16 a[110:111], v4 offset:37376
    s_add_u32 s47, s47, 1048576
    v_mfma_f32_16x16x32_bf16 v[104:107], a[16:19], a[72:75], v[104:107]
    v_mfma_f32_16x16x32_bf16 v[108:111], a[20:23], a[72:75], v[108:111]
    ds_read_b128 a[48:51], v1 offset:40960
    buffer_load_dword v22, v21, s[72:75], s47 offen
    v_mfma_f32_16x16x32_bf16 v[112:115], a[24:27], a[72:75], v[112:115]
    ds_read_b128 a[52:55], v1 offset:41984
    s_add_u32 s47, s47, 1048576
    v_mfma_f32_16x16x32_bf16 v[116:119], a[28:31], a[72:75], v[116:119]
    v_mfma_f32_16x16x32_bf16 v[120:123], a[0:3], a[76:79], v[120:123]
    ds_read_b128 a[56:59], v1 offset:43008
    v_mfma_f32_16x16x32_bf16 v[124:127], a[4:7], a[76:79], v[124:127]
    buffer_load_dword v22, v21, s[72:75], s47 offen
    v_mfma_f32_16x16x32_bf16 v[128:131], a[8:11], a[76:79], v[128:131]
    ds_read_b128 a[60:63], v1 offset:44032
    s_add_u32 s47, s47, 1048576
    v_mfma_f32_16x16x32_bf16 v[132:135], a[12:15], a[76:79], v[132:135]
    ds_read_b64_tr_b16 a[112:113], v3 offset:37888
    v_mfma_f32_16x16x32_bf16 v[136:139], a[16:19], a[76:79], v[136:139]
    buffer_load_dword v22, v21, s[72:75], s47 offen
    v_mfma_f32_16x16x32_bf16 v[140:143], a[20:23], a[76:79], v[140:143]
    ds_read_b64_tr_b16 a[114:115], v3 offset:38400
    v_mfma_f32_16x16x32_bf16 v[144:147], a[24:27], a[76:79], v[144:147]
    s_add_u32 s47, s47, 1048576
    v_mfma_f32_16x16x32_bf16 v[148:151], a[28:31], a[76:79], v[148:151]
    ds_read_b64_tr_b16 a[116:117], v4 offset:37888
    v_mfma_f32_16x16x32_bf16 v[152:155], a[80:83], a[0:3], v[152:155]
    ds_read_b64_tr_b16 a[118:119], v4 offset:38400
    v_mfma_f32_16x16x32_bf16 v[156:159], a[80:83], a[4:7], v[156:159]
    v_mfma_f32_16x16x32_bf16 v[160:163], a[80:83], a[8:11], v[160:163]
    ds_read_b64_tr_b16 a[120:121], v3 offset:38912
    v_mfma_f32_16x16x32_bf16 v[164:167], a[80:83], a[12:15], v[164:167]
    v_mfma_f32_16x16x32_bf16 v[168:171], a[80:83], a[16:19], v[168:171]
    ds_read_b64_tr_b16 a[122:123], v3 offset:39424
    v_mfma_f32_16x16x32_bf16 v[172:175], a[80:83], a[20:23], v[172:175]
    ds_read_b64_tr_b16 a[124:125], v4 offset:38912
    v_mfma_f32_16x16x32_bf16 v[176:179], a[80:83], a[24:27], v[176:179]
    v_mfma_f32_16x16x32_bf16 v[180:183], a[80:83], a[28:31], v[180:183]
    ds_read_b64_tr_b16 a[126:127], v4 offset:39424
    v_mfma_f32_16x16x32_bf16 v[184:187], a[84:87], a[0:3], v[184:187]
    v_mfma_f32_16x16x32_bf16 v[188:191], a[84:87], a[4:7], v[188:191]
    v_mfma_f32_16x16x32_bf16 v[192:195], a[84:87], a[8:11], v[192:195]
    v_lshlrev_b32 v15, 17, v0
    v_mov_b32 v17, 0
    v_lshl_add_u32 v16, v18, 6, v0
    v_mov_b32 v23, 1
    v_mfma_f32_16x16x32_bf16 v[196:199], a[84:87], a[12:15], v[196:199]
    v_lshlrev_b32 v16, 8, v16
    v_mfma_f32_16x16x32_bf16 v[200:203], a[84:87], a[16:19], v[200:203]
    buffer_store_dword v17, v15, s[80:83], s59 offen sc0 sc1
    v_mfma_f32_16x16x32_bf16 v[204:207], a[84:87], a[20:23], v[204:207]
    buffer_atomic_add v23, v16, s[76:79], 0 offen sc0 sc1
    v_mfma_f32_16x16x32_bf16 v[208:211], a[84:87], a[24:27], v[208:211]
    v_mfma_f32_16x16x32_bf16 v[212:215], a[84:87], a[28:31], v[212:215]
    s_add_u32 s32, s6, 4194304
    s_addc_u32 s33, s7, 0
    s_mov_b32 s34, 31457280
    s_mov_b32 s35, 0x20000
    v_lshlrev_b32 v15, 4, v0
    v_lshlrev_b32 v16, 9, v19
    v_lshl_add_u32 v17, v20, 4, v16
    v_bfe_u32 v21, v0, 3, 1
    v_lshl_add_u32 v16, v21, 8, v16
    v_and_b32 v21, 7, v0
    v_lshl_add_u32 v16, v21, 4, v16
    s_lshl_b32 s52, s63, 3
    s_lshl_b32 s53, s65, 2
    s_add_u32 s52, s52, s53
    s_lshl_b32 s53, s60, 2
    s_add_u32 s53, s53, s66
    s_mul_i32 s54, s60, 14
    s_add_u32 s54, s54, 32
    s_lshl_b32 s55, s52, 11
    s_lshl_b32 s57, s53, 18
    s_lshl_b32 s58, s52, 12
    s_add_u32 s57, s57, s58
    s_add_u32 s57, s57, 4194304
    s_add_u32 s58, s57, 524288
    s_add_u32 s59, s58, 0
    s_waitcnt lgkmcnt(0)
    v_mfma_f32_16x16x32_bf16 v[24:27], a[32:35], a[104:107], v[24:27]
    v_mfma_f32_16x16x32_bf16 v[28:31], a[36:39], a[104:107], v[28:31]
    v_mfma_f32_16x16x32_bf16 v[32:35], a[40:43], a[104:107], v[32:35]
    v_mfma_f32_16x16x32_bf16 v[36:39], a[44:47], a[104:107], v[36:39]
    v_mfma_f32_16x16x32_bf16 v[40:43], a[48:51], a[104:107], v[40:43]
    v_mfma_f32_16x16x32_bf16 v[44:47], a[52:55], a[104:107], v[44:47]
    v_mfma_f32_16x16x32_bf16 v[48:51], a[56:59], a[104:107], v[48:51]
    s_waitcnt vmcnt(18)
    v_mfma_f32_16x16x32_bf16 v[52:55], a[60:63], a[104:107], v[52:55]
    s_barrier
    v_mfma_f32_16x16x32_bf16 v[56:59], a[32:35], a[108:111], v[56:59]
    ds_read_b64_tr_b16 a[64:65], v5 offset:0
    v_mfma_f32_16x16x32_bf16 v[60:63], a[36:39], a[108:111], v[60:63]
    ds_read_b64_tr_b16 a[66:67], v5 offset:512
    v_mfma_f32_16x16x32_bf16 v[64:67], a[40:43], a[108:111], v[64:67]
    v_mfma_f32_16x16x32_bf16 v[68:71], a[44:47], a[108:111], v[68:71]
    ds_read_b128 a[0:3], v2 offset:0
    v_mfma_f32_16x16x32_bf16 v[72:75], a[48:51], a[108:111], v[72:75]
    ds_read_b128 a[4:7], v2 offset:1024
    v_mfma_f32_16x16x32_bf16 v[76:79], a[52:55], a[108:111], v[76:79]
    v_mfma_f32_16x16x32_bf16 v[80:83], a[56:59], a[108:111], v[80:83]
    ds_read_b128 a[8:11], v2 offset:2048
    v_mfma_f32_16x16x32_bf16 v[84:87], a[60:63], a[108:111], v[84:87]
    v_mfma_f32_16x16x32_bf16 v[88:91], a[32:35], a[112:115], v[88:91]
    ds_read_b128 a[12:15], v2 offset:3072
    v_mfma_f32_16x16x32_bf16 v[92:95], a[36:39], a[112:115], v[92:95]
    ds_read_b64_tr_b16 a[68:69], v6 offset:0
    v_mfma_f32_16x16x32_bf16 v[96:99], a[40:43], a[112:115], v[96:99]
    v_mfma_f32_16x16x32_bf16 v[100:103], a[44:47], a[112:115], v[100:103]
    ds_read_b64_tr_b16 a[70:71], v6 offset:512
    v_mfma_f32_16x16x32_bf16 v[104:107], a[48:51], a[112:115], v[104:107]
    v_mfma_f32_16x16x32_bf16 v[108:111], a[52:55], a[112:115], v[108:111]
    ds_read_b128 a[16:19], v2 offset:4096
    v_mfma_f32_16x16x32_bf16 v[112:115], a[56:59], a[112:115], v[112:115]
    ds_read_b128 a[20:23], v2 offset:5120
    v_mfma_f32_16x16x32_bf16 v[116:119], a[60:63], a[112:115], v[116:119]
    v_mfma_f32_16x16x32_bf16 v[120:123], a[32:35], a[116:119], v[120:123]
    ds_read_b128 a[24:27], v2 offset:6144
    v_mfma_f32_16x16x32_bf16 v[124:127], a[36:39], a[116:119], v[124:127]
    v_mfma_f32_16x16x32_bf16 v[128:131], a[40:43], a[116:119], v[128:131]
    ds_read_b128 a[28:31], v2 offset:7168
    v_mfma_f32_16x16x32_bf16 v[132:135], a[44:47], a[116:119], v[132:135]
    ds_read_b64_tr_b16 a[72:73], v5 offset:1024
    v_mfma_f32_16x16x32_bf16 v[136:139], a[48:51], a[116:119], v[136:139]
    v_mfma_f32_16x16x32_bf16 v[140:143], a[52:55], a[116:119], v[140:143]
    ds_read_b64_tr_b16 a[74:75], v5 offset:1536
    v_mfma_f32_16x16x32_bf16 v[144:147], a[56:59], a[116:119], v[144:147]
    v_mfma_f32_16x16x32_bf16 v[148:151], a[60:63], a[116:119], v[148:151]
    ds_read_b64_tr_b16 a[76:77], v6 offset:1024
    v_mfma_f32_16x16x32_bf16 v[152:155], a[120:123], a[32:35], v[152:155]
    ds_read_b64_tr_b16 a[78:79], v6 offset:1536
    v_mfma_f32_16x16x32_bf16 v[156:159], a[120:123], a[36:39], v[156:159]
    v_mfma_f32_16x16x32_bf16 v[160:163], a[120:123], a[40:43], v[160:163]
    ds_read_b64_tr_b16 a[80:81], v5 offset:2048
    v_mfma_f32_16x16x32_bf16 v[164:167], a[120:123], a[44:47], v[164:167]
    v_mfma_f32_16x16x32_bf16 v[168:171], a[120:123], a[48:51], v[168:171]
    ds_read_b64_tr_b16 a[82:83], v5 offset:2560
    v_mfma_f32_16x16x32_bf16 v[172:175], a[120:123], a[52:55], v[172:175]
    ds_read_b64_tr_b16 a[84:85], v6 offset:2048
    v_mfma_f32_16x16x32_bf16 v[176:179], a[120:123], a[56:59], v[176:179]
    v_mfma_f32_16x16x32_bf16 v[180:183], a[120:123], a[60:63], v[180:183]
    ds_read_b64_tr_b16 a[86:87], v6 offset:2560
    v_mfma_f32_16x16x32_bf16 v[184:187], a[124:127], a[32:35], v[184:187]
    v_mfma_f32_16x16x32_bf16 v[188:191], a[124:127], a[36:39], v[188:191]
    v_mfma_f32_16x16x32_bf16 v[192:195], a[124:127], a[40:43], v[192:195]
    v_mfma_f32_16x16x32_bf16 v[196:199], a[124:127], a[44:47], v[196:199]
    v_mfma_f32_16x16x32_bf16 v[200:203], a[124:127], a[48:51], v[200:203]
    v_mfma_f32_16x16x32_bf16 v[204:207], a[124:127], a[52:55], v[204:207]
    v_mfma_f32_16x16x32_bf16 v[208:211], a[124:127], a[56:59], v[208:211]
    v_mfma_f32_16x16x32_bf16 v[212:215], a[124:127], a[60:63], v[212:215]
    s_waitcnt lgkmcnt(0)
    v_mfma_f32_16x16x32_bf16 v[24:27], a[0:3], a[64:67], v[24:27]
    v_mfma_f32_16x16x32_bf16 v[28:31], a[4:7], a[64:67], v[28:31]
    v_mfma_f32_16x16x32_bf16 v[32:35], a[8:11], a[64:67], v[32:35]
    v_mfma_f32_16x16x32_bf16 v[36:39], a[12:15], a[64:67], v[36:39]
    v_mfma_f32_16x16x32_bf16 v[40:43], a[16:19], a[64:67], v[40:43]
    v_mfma_f32_16x16x32_bf16 v[44:47], a[20:23], a[64:67], v[44:47]
    v_mfma_f32_16x16x32_bf16 v[48:51], a[24:27], a[64:67], v[48:51]
    s_waitcnt vmcnt(9)
    v_mfma_f32_16x16x32_bf16 v[52:55], a[28:31], a[64:67], v[52:55]
    s_barrier
    v_mfma_f32_16x16x32_bf16 v[56:59], a[0:3], a[68:71], v[56:59]
    ds_read_b64_tr_b16 a[104:105], v5 offset:36864
    v_mfma_f32_16x16x32_bf16 v[60:63], a[4:7], a[68:71], v[60:63]
    ds_read_b64_tr_b16 a[106:107], v5 offset:37376
    v_mfma_f32_16x16x32_bf16 v[64:67], a[8:11], a[68:71], v[64:67]
    v_mfma_f32_16x16x32_bf16 v[68:71], a[12:15], a[68:71], v[68:71]
    ds_read_b128 a[32:35], v2 offset:36864
    v_mfma_f32_16x16x32_bf16 v[72:75], a[16:19], a[68:71], v[72:75]
    ds_read_b128 a[36:39], v2 offset:37888
    v_mfma_f32_16x16x32_bf16 v[76:79], a[20:23], a[68:71], v[76:79]
    v_mfma_f32_16x16x32_bf16 v[80:83], a[24:27], a[68:71], v[80:83]
    ds_read_b128 a[40:43], v2 offset:38912
    v_mfma_f32_16x16x32_bf16 v[84:87], a[28:31], a[68:71], v[84:87]
    v_mfma_f32_16x16x32_bf16 v[88:91], a[0:3], a[72:75], v[88:91]
    ds_read_b128 a[44:47], v2 offset:39936
    v_mfma_f32_16x16x32_bf16 v[92:95], a[4:7], a[72:75], v[92:95]
    ds_read_b64_tr_b16 a[108:109], v6 offset:36864
    v_mfma_f32_16x16x32_bf16 v[96:99], a[8:11], a[72:75], v[96:99]
    v_mfma_f32_16x16x32_bf16 v[100:103], a[12:15], a[72:75], v[100:103]
    ds_read_b64_tr_b16 a[110:111], v6 offset:37376
    v_mfma_f32_16x16x32_bf16 v[104:107], a[16:19], a[72:75], v[104:107]
    v_mfma_f32_16x16x32_bf16 v[108:111], a[20:23], a[72:75], v[108:111]
    ds_read_b128 a[48:51], v2 offset:40960
    v_mfma_f32_16x16x32_bf16 v[112:115], a[24:27], a[72:75], v[112:115]
    ds_read_b128 a[52:55], v2 offset:41984
    v_mfma_f32_16x16x32_bf16 v[116:119], a[28:31], a[72:75], v[116:119]
    v_mfma_f32_16x16x32_bf16 v[120:123], a[0:3], a[76:79], v[120:123]
    ds_read_b128 a[56:59], v2 offset:43008
    v_mfma_f32_16x16x32_bf16 v[124:127], a[4:7], a[76:79], v[124:127]
    v_mfma_f32_16x16x32_bf16 v[128:131], a[8:11], a[76:79], v[128:131]
    ds_read_b128 a[60:63], v2 offset:44032
    v_mfma_f32_16x16x32_bf16 v[132:135], a[12:15], a[76:79], v[132:135]
    ds_read_b64_tr_b16 a[112:113], v5 offset:37888
    v_mfma_f32_16x16x32_bf16 v[136:139], a[16:19], a[76:79], v[136:139]
    v_mfma_f32_16x16x32_bf16 v[140:143], a[20:23], a[76:79], v[140:143]
    ds_read_b64_tr_b16 a[114:115], v5 offset:38400
    v_mfma_f32_16x16x32_bf16 v[144:147], a[24:27], a[76:79], v[144:147]
    v_mfma_f32_16x16x32_bf16 v[148:151], a[28:31], a[76:79], v[148:151]
    ds_read_b64_tr_b16 a[116:117], v6 offset:37888
    v_mfma_f32_16x16x32_bf16 v[152:155], a[80:83], a[0:3], v[152:155]
    ds_read_b64_tr_b16 a[118:119], v6 offset:38400
    v_mfma_f32_16x16x32_bf16 v[156:159], a[80:83], a[4:7], v[156:159]
    v_mfma_f32_16x16x32_bf16 v[160:163], a[80:83], a[8:11], v[160:163]
    ds_read_b64_tr_b16 a[120:121], v5 offset:38912
    v_mfma_f32_16x16x32_bf16 v[164:167], a[80:83], a[12:15], v[164:167]
    v_mfma_f32_16x16x32_bf16 v[168:171], a[80:83], a[16:19], v[168:171]
    ds_read_b64_tr_b16 a[122:123], v5 offset:39424
    v_mfma_f32_16x16x32_bf16 v[172:175], a[80:83], a[20:23], v[172:175]
    ds_read_b64_tr_b16 a[124:125], v6 offset:38912
    v_mfma_f32_16x16x32_bf16 v[176:179], a[80:83], a[24:27], v[176:179]
    v_mfma_f32_16x16x32_bf16 v[180:183], a[80:83], a[28:31], v[180:183]
    ds_read_b64_tr_b16 a[126:127], v6 offset:39424
    v_mfma_f32_16x16x32_bf16 v[184:187], a[84:87], a[0:3], v[184:187]
    v_mfma_f32_16x16x32_bf16 v[188:191], a[84:87], a[4:7], v[188:191]
    v_mfma_f32_16x16x32_bf16 v[192:195], a[84:87], a[8:11], v[192:195]
    v_mfma_f32_16x16x32_bf16 v[196:199], a[84:87], a[12:15], v[196:199]
    v_mfma_f32_16x16x32_bf16 v[200:203], a[84:87], a[16:19], v[200:203]
    v_mfma_f32_16x16x32_bf16 v[204:207], a[84:87], a[20:23], v[204:207]
    v_mfma_f32_16x16x32_bf16 v[208:211], a[84:87], a[24:27], v[208:211]
    v_mfma_f32_16x16x32_bf16 v[212:215], a[84:87], a[28:31], v[212:215]
    s_waitcnt lgkmcnt(0)
    v_mfma_f32_16x16x32_bf16 v[24:27], a[32:35], a[104:107], v[24:27]
    ds_read_b64_tr_b16 a[88:89], v3 offset:3072
    v_mfma_f32_16x16x32_bf16 v[28:31], a[36:39], a[104:107], v[28:31]
    v_mfma_f32_16x16x32_bf16 v[32:35], a[40:43], a[104:107], v[32:35]
    ds_read_b64_tr_b16 a[90:91], v3 offset:3584
    v_mfma_f32_16x16x32_bf16 v[36:39], a[44:47], a[104:107], v[36:39]
    v_mfma_f32_16x16x32_bf16 v[40:43], a[48:51], a[104:107], v[40:43]
    v_mfma_f32_16x16x32_bf16 v[44:47], a[52:55], a[104:107], v[44:47]
    ds_read_b128 a[0:3], v1 offset:0
    v_mfma_f32_16x16x32_bf16 v[48:51], a[56:59], a[104:107], v[48:51]
    v_mfma_f32_16x16x32_bf16 v[52:55], a[60:63], a[104:107], v[52:55]
    ds_read_b128 a[4:7], v1 offset:1024
    v_mfma_f32_16x16x32_bf16 v[56:59], a[32:35], a[108:111], v[56:59]
    v_mfma_f32_16x16x32_bf16 v[60:63], a[36:39], a[108:111], v[60:63]
    v_mfma_f32_16x16x32_bf16 v[64:67], a[40:43], a[108:111], v[64:67]
    ds_read_b128 a[8:11], v1 offset:2048
    v_mfma_f32_16x16x32_bf16 v[68:71], a[44:47], a[108:111], v[68:71]
    v_mfma_f32_16x16x32_bf16 v[72:75], a[48:51], a[108:111], v[72:75]
    ds_read_b128 a[12:15], v1 offset:3072
    v_mfma_f32_16x16x32_bf16 v[76:79], a[52:55], a[108:111], v[76:79]
    v_mfma_f32_16x16x32_bf16 v[80:83], a[56:59], a[108:111], v[80:83]
    v_mfma_f32_16x16x32_bf16 v[84:87], a[60:63], a[108:111], v[84:87]
    ds_read_b64_tr_b16 a[92:93], v4 offset:3072
    v_mfma_f32_16x16x32_bf16 v[88:91], a[32:35], a[112:115], v[88:91]
    v_mfma_f32_16x16x32_bf16 v[92:95], a[36:39], a[112:115], v[92:95]
    ds_read_b64_tr_b16 a[94:95], v4 offset:3584
    v_mfma_f32_16x16x32_bf16 v[96:99], a[40:43], a[112:115], v[96:99]
    v_mfma_f32_16x16x32_bf16 v[100:103], a[44:47], a[112:115], v[100:103]
    v_mfma_f32_16x16x32_bf16 v[104:107], a[48:51], a[112:115], v[104:107]
    ds_read_b128 a[16:19], v1 offset:4096
    v_mfma_f32_16x16x32_bf16 v[108:111], a[52:55], a[112:115], v[108:111]
    v_mfma_f32_16x16x32_bf16 v[112:115], a[56:59], a[112:115], v[112:115]
    v_mfma_f32_16x16x32_bf16 v[116:119], a[60:63], a[112:115], v[116:119]
    ds_read_b128 a[20:23], v1 offset:5120
    v_mfma_f32_16x16x32_bf16 v[120:123], a[32:35], a[116:119], v[120:123]
    v_mfma_f32_16x16x32_bf16 v[124:127], a[36:39], a[116:119], v[124:127]
    ds_read_b128 a[24:27], v1 offset:6144
    v_mfma_f32_16x16x32_bf16 v[128:131], a[40:43], a[116:119], v[128:131]
    v_mfma_f32_16x16x32_bf16 v[132:135], a[44:47], a[116:119], v[132:135]
    v_mfma_f32_16x16x32_bf16 v[136:139], a[48:51], a[116:119], v[136:139]
    ds_read_b128 a[28:31], v1 offset:7168
    v_mfma_f32_16x16x32_bf16 v[140:143], a[52:55], a[116:119], v[140:143]
    v_mfma_f32_16x16x32_bf16 v[144:147], a[56:59], a[116:119], v[144:147]
    ds_read_b64_tr_b16 a[96:97], v3 offset:4096
    v_mfma_f32_16x16x32_bf16 v[148:151], a[60:63], a[116:119], v[148:151]
    v_mfma_f32_16x16x32_bf16 v[152:155], a[120:123], a[32:35], v[152:155]
    v_mfma_f32_16x16x32_bf16 v[156:159], a[120:123], a[36:39], v[156:159]
    ds_read_b64_tr_b16 a[98:99], v3 offset:4608
    v_mfma_f32_16x16x32_bf16 v[160:163], a[120:123], a[40:43], v[160:163]
    v_mfma_f32_16x16x32_bf16 v[164:167], a[120:123], a[44:47], v[164:167]
    ds_read_b64_tr_b16 a[100:101], v4 offset:4096
    v_mfma_f32_16x16x32_bf16 v[168:171], a[120:123], a[48:51], v[168:171]
    v_mfma_f32_16x16x32_bf16 v[172:175], a[120:123], a[52:55], v[172:175]
    v_mfma_f32_16x16x32_bf16 v[176:179], a[120:123], a[56:59], v[176:179]
    ds_read_b64_tr_b16 a[102:103], v4 offset:4608
    v_mfma_f32_16x16x32_bf16 v[180:183], a[120:123], a[60:63], v[180:183]
    v_mfma_f32_16x16x32_bf16 v[184:187], a[124:127], a[32:35], v[184:187]
    v_mfma_f32_16x16x32_bf16 v[188:191], a[124:127], a[36:39], v[188:191]
    v_mfma_f32_16x16x32_bf16 v[192:195], a[124:127], a[40:43], v[192:195]
    v_mfma_f32_16x16x32_bf16 v[196:199], a[124:127], a[44:47], v[196:199]
    v_mfma_f32_16x16x32_bf16 v[200:203], a[124:127], a[48:51], v[200:203]
    v_mfma_f32_16x16x32_bf16 v[204:207], a[124:127], a[52:55], v[204:207]
    v_mfma_f32_16x16x32_bf16 v[208:211], a[124:127], a[56:59], v[208:211]
    v_mfma_f32_16x16x32_bf16 v[212:215], a[124:127], a[60:63], v[212:215]
    s_waitcnt lgkmcnt(0)
    v_mfma_f32_16x16x32_bf16 v[216:219], a[88:91], a[0:3], v[216:219]
    ds_read_b64_tr_b16 a[128:129], v3 offset:39936
    v_mfma_f32_16x16x32_bf16 v[220:223], a[88:91], a[4:7], v[220:223]
    ds_read_b64_tr_b16 a[130:131], v3 offset:40448
    v_mfma_f32_16x16x32_bf16 v[224:227], a[88:91], a[8:11], v[224:227]
    v_mfma_f32_16x16x32_bf16 v[228:231], a[88:91], a[12:15], v[228:231]
    ds_read_b128 a[32:35], v1 offset:36864
    v_mfma_f32_16x16x32_bf16 v[232:235], a[88:91], a[16:19], v[232:235]
    ds_read_b128 a[36:39], v1 offset:37888
    v_cvt_pk_bf16_f32 v24, v24, v25
    v_cvt_pk_bf16_f32 v25, v26, v27
    v_mfma_f32_16x16x32_bf16 v[236:239], a[88:91], a[20:23], v[236:239]
    v_cvt_pk_bf16_f32 v26, v28, v29
    v_mfma_f32_16x16x32_bf16 v[240:243], a[88:91], a[24:27], v[240:243]
    ds_read_b128 a[40:43], v1 offset:38912
    v_cvt_pk_bf16_f32 v27, v30, v31
    v_mfma_f32_16x16x32_bf16 v[244:247], a[88:91], a[28:31], v[244:247]
    ds_read_b128 a[44:47], v1 offset:39936
    buffer_store_dwordx4 v[24:27], v17, s[32:35], s57 offen offset:2048 sc0 sc1
    v_mfma_f32_16x16x32_bf16 v[248:251], a[92:95], a[0:3], v[248:251]
    v_cvt_pk_bf16_f32 v56, v56, v57
    v_mfma_f32_16x16x32_bf16 v[252:255], a[92:95], a[4:7], v[252:255]
    ds_read_b64_tr_b16 a[132:133], v4 offset:39936
    v_cvt_pk_bf16_f32 v57, v58, v59
    v_cvt_pk_bf16_f32 v58, v60, v61
    v_mfma_f32_16x16x32_bf16 a[144:147], a[92:95], a[8:11], a[144:147]
    ds_read_b64_tr_b16 a[134:135], v4 offset:40448
    v_cvt_pk_bf16_f32 v59, v62, v63
    v_mfma_f32_16x16x32_bf16 a[148:151], a[92:95], a[12:15], a[148:151]
    buffer_store_dwordx4 v[56:59], v17, s[32:35], s57 offen offset:2304 sc0 sc1
    v_mfma_f32_16x16x32_bf16 a[152:155], a[92:95], a[16:19], a[152:155]
    ds_read_b128 a[48:51], v1 offset:40960
    s_add_u32 s57, s57, 4096
    v_mfma_f32_16x16x32_bf16 a[156:159], a[92:95], a[20:23], a[156:159]
    v_cvt_pk_bf16_f32 v32, v32, v33
    v_mfma_f32_16x16x32_bf16 a[160:163], a[92:95], a[24:27], a[160:163]
    ds_read_b128 a[52:55], v1 offset:41984
    v_cvt_pk_bf16_f32 v33, v34, v35
    v_mfma_f32_16x16x32_bf16 a[164:167], a[92:95], a[28:31], a[164:167]
    ds_read_b128 a[56:59], v1 offset:43008
    v_cvt_pk_bf16_f32 v34, v36, v37
    v_cvt_pk_bf16_f32 v35, v38, v39
    v_mfma_f32_16x16x32_bf16 a[168:171], a[96:99], a[0:3], a[168:171]
    buffer_store_dwordx4 v[32:35], v17, s[32:35], s57 offen offset:2048 sc0 sc1
    v_mfma_f32_16x16x32_bf16 a[172:175], a[96:99], a[4:7], a[172:175]
    ds_read_b128 a[60:63], v1 offset:44032
    v_cvt_pk_bf16_f32 v64, v64, v65
    v_mfma_f32_16x16x32_bf16 a[176:179], a[96:99], a[8:11], a[176:179]
    ds_read_b64_tr_b16 a[136:137], v3 offset:40960
    v_cvt_pk_bf16_f32 v65, v66, v67
    v_mfma_f32_16x16x32_bf16 a[180:183], a[96:99], a[12:15], a[180:183]
    v_cvt_pk_bf16_f32 v66, v68, v69
    v_mfma_f32_16x16x32_bf16 a[184:187], a[96:99], a[16:19], a[184:187]
    ds_read_b64_tr_b16 a[138:139], v3 offset:41472
    v_cvt_pk_bf16_f32 v67, v70, v71
    buffer_store_dwordx4 v[64:67], v17, s[32:35], s57 offen offset:2304 sc0 sc1
    v_mfma_f32_16x16x32_bf16 a[188:191], a[96:99], a[20:23], a[188:191]
    ds_read_b64_tr_b16 a[140:141], v4 offset:40960
    s_add_u32 s57, s57, 4096
    v_mfma_f32_16x16x32_bf16 a[192:195], a[96:99], a[24:27], a[192:195]
    v_cvt_pk_bf16_f32 v40, v40, v41
    v_mfma_f32_16x16x32_bf16 a[196:199], a[96:99], a[28:31], a[196:199]
    ds_read_b64_tr_b16 a[142:143], v4 offset:41472
    v_cvt_pk_bf16_f32 v41, v42, v43
    v_mfma_f32_16x16x32_bf16 a[200:203], a[100:103], a[0:3], a[200:203]
    v_cvt_pk_bf16_f32 v42, v44, v45
    v_mfma_f32_16x16x32_bf16 a[204:207], a[100:103], a[4:7], a[204:207]
    v_cvt_pk_bf16_f32 v43, v46, v47
    v_mfma_f32_16x16x32_bf16 a[208:211], a[100:103], a[8:11], a[208:211]
    buffer_store_dwordx4 v[40:43], v17, s[32:35], s57 offen offset:2048 sc0 sc1
    v_cvt_pk_bf16_f32 v72, v72, v73
    v_mfma_f32_16x16x32_bf16 a[212:215], a[100:103], a[12:15], a[212:215]
    v_cvt_pk_bf16_f32 v73, v74, v75
    v_mfma_f32_16x16x32_bf16 a[216:219], a[100:103], a[16:19], a[216:219]
    v_cvt_pk_bf16_f32 v74, v76, v77
    v_mfma_f32_16x16x32_bf16 a[220:223], a[100:103], a[20:23], a[220:223]
    v_cvt_pk_bf16_f32 v75, v78, v79
    v_mfma_f32_16x16x32_bf16 a[224:227], a[100:103], a[24:27], a[224:227]
    buffer_store_dwordx4 v[72:75], v17, s[32:35], s57 offen offset:2304 sc0 sc1
    v_mfma_f32_16x16x32_bf16 a[228:231], a[100:103], a[28:31], a[228:231]
    s_add_u32 s57, s57, 4096
    s_waitcnt lgkmcnt(0)
    v_mfma_f32_16x16x32_bf16 v[216:219], a[128:131], a[32:35], v[216:219]
    ds_read_b64_tr_b16 a[88:89], v5 offset:3072
    v_cvt_pk_bf16_f32 v48, v48, v49
    v_cvt_pk_bf16_f32 v49, v50, v51
    v_mfma_f32_16x16x32_bf16 v[220:223], a[128:131], a[36:39], v[220:223]
    ds_read_b64_tr_b16 a[90:91], v5 offset:3584
    v_cvt_pk_bf16_f32 v50, v52, v53
    v_mfma_f32_16x16x32_bf16 v[224:227], a[128:131], a[40:43], v[224:227]
    v_cvt_pk_bf16_f32 v51, v54, v55
    v_mfma_f32_16x16x32_bf16 v[228:231], a[128:131], a[44:47], v[228:231]
    ds_read_b128 a[0:3], v2 offset:0
    buffer_store_dwordx4 v[48:51], v17, s[32:35], s57 offen offset:2048 sc0 sc1
    v_mfma_f32_16x16x32_bf16 v[232:235], a[128:131], a[48:51], v[232:235]
    ds_read_b128 a[4:7], v2 offset:1024
    v_cvt_pk_bf16_f32 v80, v80, v81
    v_mfma_f32_16x16x32_bf16 v[236:239], a[128:131], a[52:55], v[236:239]
    v_cvt_pk_bf16_f32 v81, v82, v83
    v_mfma_f32_16x16x32_bf16 v[240:243], a[128:131], a[56:59], v[240:243]
    ds_read_b128 a[8:11], v2 offset:2048
    v_cvt_pk_bf16_f32 v82, v84, v85
    v_mfma_f32_16x16x32_bf16 v[244:247], a[128:131], a[60:63], v[244:247]
    ds_read_b128 a[12:15], v2 offset:3072
    v_cvt_pk_bf16_f32 v83, v86, v87
    v_mfma_f32_16x16x32_bf16 v[248:251], a[132:135], a[32:35], v[248:251]
    buffer_store_dwordx4 v[80:83], v17, s[32:35], s57 offen offset:2304 sc0 sc1
    v_mfma_f32_16x16x32_bf16 v[252:255], a[132:135], a[36:39], v[252:255]
    ds_read_b64_tr_b16 a[92:93], v6 offset:3072
    s_add_u32 s57, s57, 4096
    v_mfma_f32_16x16x32_bf16 a[144:147], a[132:135], a[40:43], a[144:147]
    ds_read_b64_tr_b16 a[94:95], v6 offset:3584
    v_cvt_pk_bf16_f32 v88, v88, v89
    v_mfma_f32_16x16x32_bf16 a[148:151], a[132:135], a[44:47], a[148:151]
    v_cvt_pk_bf16_f32 v89, v90, v91
    v_mfma_f32_16x16x32_bf16 a[152:155], a[132:135], a[48:51], a[152:155]
    ds_read_b128 a[16:19], v2 offset:4096
    v_cvt_pk_bf16_f32 v90, v92, v93
    v_mfma_f32_16x16x32_bf16 a[156:159], a[132:135], a[52:55], a[156:159]
    v_cvt_pk_bf16_f32 v91, v94, v95
    v_mfma_f32_16x16x32_bf16 a[160:163], a[132:135], a[56:59], a[160:163]
    ds_read_b128 a[20:23], v2 offset:5120
    buffer_store_dwordx4 v[88:91], v17, s[32:35], s58 offen offset:2048 sc0 sc1
    v_mfma_f32_16x16x32_bf16 a[164:167], a[132:135], a[60:63], a[164:167]
    ds_read_b128 a[24:27], v2 offset:6144
    v_cvt_pk_bf16_f32 v120, v120, v121
    v_mfma_f32_16x16x32_bf16 a[168:171], a[136:139], a[32:35], a[168:171]
    v_cvt_pk_bf16_f32 v121, v122, v123
    v_mfma_f32_16x16x32_bf16 a[172:175], a[136:139], a[36:39], a[172:175]
    ds_read_b128 a[28:31], v2 offset:7168
    v_cvt_pk_bf16_f32 v122, v124, v125
    v_mfma_f32_16x16x32_bf16 a[176:179], a[136:139], a[40:43], a[176:179]
    ds_read_b64_tr_b16 a[96:97], v5 offset:4096
    v_cvt_pk_bf16_f32 v123, v126, v127
    v_mfma_f32_16x16x32_bf16 a[180:183], a[136:139], a[44:47], a[180:183]
    buffer_store_dwordx4 v[120:123], v17, s[32:35], s58 offen offset:2304 sc0 sc1
    v_mfma_f32_16x16x32_bf16 a[184:187], a[136:139], a[48:51], a[184:187]
    ds_read_b64_tr_b16 a[98:99], v5 offset:4608
    s_add_u32 s58, s58, 4096
    v_mfma_f32_16x16x32_bf16 a[188:191], a[136:139], a[52:55], a[188:191]
    ds_read_b64_tr_b16 a[100:101], v6 offset:4096
    v_cvt_pk_bf16_f32 v96, v96, v97
    v_mfma_f32_16x16x32_bf16 a[192:195], a[136:139], a[56:59], a[192:195]
    v_cvt_pk_bf16_f32 v97, v98, v99
    v_mfma_f32_16x16x32_bf16 a[196:199], a[136:139], a[60:63], a[196:199]
    ds_read_b64_tr_b16 a[102:103], v6 offset:4608
    v_cvt_pk_bf16_f32 v98, v100, v101
    v_mfma_f32_16x16x32_bf16 a[200:203], a[140:143], a[32:35], a[200:203]
    v_cvt_pk_bf16_f32 v99, v102, v103
    v_mfma_f32_16x16x32_bf16 a[204:207], a[140:143], a[36:39], a[204:207]
    buffer_store_dwordx4 v[96:99], v17, s[32:35], s58 offen offset:2048 sc0 sc1
    v_mfma_f32_16x16x32_bf16 a[208:211], a[140:143], a[40:43], a[208:211]
    v_cvt_pk_bf16_f32 v128, v128, v129
    v_mfma_f32_16x16x32_bf16 a[212:215], a[140:143], a[44:47], a[212:215]
    v_cvt_pk_bf16_f32 v129, v130, v131
    v_mfma_f32_16x16x32_bf16 a[216:219], a[140:143], a[48:51], a[216:219]
    v_cvt_pk_bf16_f32 v130, v132, v133
    v_mfma_f32_16x16x32_bf16 a[220:223], a[140:143], a[52:55], a[220:223]
    v_cvt_pk_bf16_f32 v131, v134, v135
    v_mfma_f32_16x16x32_bf16 a[224:227], a[140:143], a[56:59], a[224:227]
    buffer_store_dwordx4 v[128:131], v17, s[32:35], s58 offen offset:2304 sc0 sc1
    v_mfma_f32_16x16x32_bf16 a[228:231], a[140:143], a[60:63], a[228:231]
    s_add_u32 s58, s58, 4096
    s_waitcnt lgkmcnt(0)
    v_mfma_f32_16x16x32_bf16 v[216:219], a[88:91], a[0:3], v[216:219]
    ds_read_b64_tr_b16 a[128:129], v5 offset:39936
    v_cvt_pk_bf16_f32 v104, v104, v105
    v_cvt_pk_bf16_f32 v105, v106, v107
    v_mfma_f32_16x16x32_bf16 v[220:223], a[88:91], a[4:7], v[220:223]
    ds_read_b64_tr_b16 a[130:131], v5 offset:40448
    v_cvt_pk_bf16_f32 v106, v108, v109
    v_mfma_f32_16x16x32_bf16 v[224:227], a[88:91], a[8:11], v[224:227]
    v_cvt_pk_bf16_f32 v107, v110, v111
    v_mfma_f32_16x16x32_bf16 v[228:231], a[88:91], a[12:15], v[228:231]
    ds_read_b128 a[32:35], v2 offset:36864
    buffer_store_dwordx4 v[104:107], v17, s[32:35], s58 offen offset:2048 sc0 sc1
    v_mfma_f32_16x16x32_bf16 v[232:235], a[88:91], a[16:19], v[232:235]
    ds_read_b128 a[36:39], v2 offset:37888
    v_cvt_pk_bf16_f32 v136, v136, v137
    v_mfma_f32_16x16x32_bf16 v[236:239], a[88:91], a[20:23], v[236:239]
    v_cvt_pk_bf16_f32 v137, v138, v139
    v_mfma_f32_16x16x32_bf16 v[240:243], a[88:91], a[24:27], v[240:243]
    ds_read_b128 a[40:43], v2 offset:38912
    v_cvt_pk_bf16_f32 v138, v140, v141
    v_mfma_f32_16x16x32_bf16 v[244:247], a[88:91], a[28:31], v[244:247]
    ds_read_b128 a[44:47], v2 offset:39936
    v_cvt_pk_bf16_f32 v139, v142, v143
    v_mfma_f32_16x16x32_bf16 v[248:251], a[92:95], a[0:3], v[248:251]
    buffer_store_dwordx4 v[136:139], v17, s[32:35], s58 offen offset:2304 sc0 sc1
    v_mfma_f32_16x16x32_bf16 v[252:255], a[92:95], a[4:7], v[252:255]
    ds_read_b64_tr_b16 a[132:133], v6 offset:39936
    s_add_u32 s58, s58, 4096
    v_mfma_f32_16x16x32_bf16 a[144:147], a[92:95], a[8:11], a[144:147]
    ds_read_b64_tr_b16 a[134:135], v6 offset:40448
    v_cvt_pk_bf16_f32 v112, v112, v113
    v_mfma_f32_16x16x32_bf16 a[148:151], a[92:95], a[12:15], a[148:151]
    v_cvt_pk_bf16_f32 v113, v114, v115
    v_mfma_f32_16x16x32_bf16 a[152:155], a[92:95], a[16:19], a[152:155]
    ds_read_b128 a[48:51], v2 offset:40960
    v_cvt_pk_bf16_f32 v114, v116, v117
    v_mfma_f32_16x16x32_bf16 a[156:159], a[92:95], a[20:23], a[156:159]
    v_cvt_pk_bf16_f32 v115, v118, v119
    v_mfma_f32_16x16x32_bf16 a[160:163], a[92:95], a[24:27], a[160:163]
    ds_read_b128 a[52:55], v2 offset:41984
    buffer_store_dwordx4 v[112:115], v17, s[32:35], s58 offen offset:2048 sc0 sc1
    v_mfma_f32_16x16x32_bf16 a[164:167], a[92:95], a[28:31], a[164:167]
    ds_read_b128 a[56:59], v2 offset:43008
    v_cvt_pk_bf16_f32 v144, v144, v145
    v_mfma_f32_16x16x32_bf16 a[168:171], a[96:99], a[0:3], a[168:171]
    v_cvt_pk_bf16_f32 v145, v146, v147
    v_mfma_f32_16x16x32_bf16 a[172:175], a[96:99], a[4:7], a[172:175]
    ds_read_b128 a[60:63], v2 offset:44032
    v_cvt_pk_bf16_f32 v146, v148, v149
    v_mfma_f32_16x16x32_bf16 a[176:179], a[96:99], a[8:11], a[176:179]
    ds_read_b64_tr_b16 a[136:137], v5 offset:40960
    v_cvt_pk_bf16_f32 v147, v150, v151
    v_mfma_f32_16x16x32_bf16 a[180:183], a[96:99], a[12:15], a[180:183]
    buffer_store_dwordx4 v[144:147], v17, s[32:35], s58 offen offset:2304 sc0 sc1
    v_mfma_f32_16x16x32_bf16 a[184:187], a[96:99], a[16:19], a[184:187]
    ds_read_b64_tr_b16 a[138:139], v5 offset:41472
    s_add_u32 s58, s58, 4096
    v_mfma_f32_16x16x32_bf16 a[188:191], a[96:99], a[20:23], a[188:191]
    ds_read_b64_tr_b16 a[140:141], v6 offset:40960
    v_cvt_pk_bf16_f32 v152, v152, v153
    v_mfma_f32_16x16x32_bf16 a[192:195], a[96:99], a[24:27], a[192:195]
    v_cvt_pk_bf16_f32 v153, v154, v155
    v_mfma_f32_16x16x32_bf16 a[196:199], a[96:99], a[28:31], a[196:199]
    ds_read_b64_tr_b16 a[142:143], v6 offset:41472
    v_cvt_pk_bf16_f32 v154, v184, v185
    v_mfma_f32_16x16x32_bf16 a[200:203], a[100:103], a[0:3], a[200:203]
    v_cvt_pk_bf16_f32 v155, v186, v187
    v_mfma_f32_16x16x32_bf16 a[204:207], a[100:103], a[4:7], a[204:207]
    buffer_store_dwordx4 v[152:155], v16, s[32:35], s59 offen offset:0 sc0 sc1
    v_mfma_f32_16x16x32_bf16 a[208:211], a[100:103], a[8:11], a[208:211]
    v_cvt_pk_bf16_f32 v156, v156, v157
    v_mfma_f32_16x16x32_bf16 a[212:215], a[100:103], a[12:15], a[212:215]
    v_cvt_pk_bf16_f32 v157, v158, v159
    v_mfma_f32_16x16x32_bf16 a[216:219], a[100:103], a[16:19], a[216:219]
    v_cvt_pk_bf16_f32 v158, v188, v189
    v_mfma_f32_16x16x32_bf16 a[220:223], a[100:103], a[20:23], a[220:223]
    v_cvt_pk_bf16_f32 v159, v190, v191
    v_mfma_f32_16x16x32_bf16 a[224:227], a[100:103], a[24:27], a[224:227]
    buffer_store_dwordx4 v[156:159], v16, s[32:35], s59 offen offset:128 sc0 sc1
    v_mfma_f32_16x16x32_bf16 a[228:231], a[100:103], a[28:31], a[228:231]
    s_add_u32 s59, s59, 4096
    s_waitcnt lgkmcnt(0)
    v_mfma_f32_16x16x32_bf16 v[216:219], a[128:131], a[32:35], v[216:219]
    v_cvt_pk_bf16_f32 v160, v160, v161
    v_cvt_pk_bf16_f32 v161, v162, v163
    v_mfma_f32_16x16x32_bf16 v[220:223], a[128:131], a[36:39], v[220:223]
    v_cvt_pk_bf16_f32 v162, v192, v193
    v_mfma_f32_16x16x32_bf16 v[224:227], a[128:131], a[40:43], v[224:227]
    v_cvt_pk_bf16_f32 v163, v194, v195
    v_mfma_f32_16x16x32_bf16 v[228:231], a[128:131], a[44:47], v[228:231]
    buffer_store_dwordx4 v[160:163], v16, s[32:35], s59 offen offset:0 sc0 sc1
    v_mfma_f32_16x16x32_bf16 v[232:235], a[128:131], a[48:51], v[232:235]
    v_cvt_pk_bf16_f32 v164, v164, v165
    v_mfma_f32_16x16x32_bf16 v[236:239], a[128:131], a[52:55], v[236:239]
    v_cvt_pk_bf16_f32 v165, v166, v167
    v_mfma_f32_16x16x32_bf16 v[240:243], a[128:131], a[56:59], v[240:243]
    v_cvt_pk_bf16_f32 v166, v196, v197
    v_mfma_f32_16x16x32_bf16 v[244:247], a[128:131], a[60:63], v[244:247]
    v_cvt_pk_bf16_f32 v167, v198, v199
    v_mfma_f32_16x16x32_bf16 v[248:251], a[132:135], a[32:35], v[248:251]
    buffer_store_dwordx4 v[164:167], v16, s[32:35], s59 offen offset:128 sc0 sc1
    v_mfma_f32_16x16x32_bf16 v[252:255], a[132:135], a[36:39], v[252:255]
    s_add_u32 s59, s59, 4096
    v_mfma_f32_16x16x32_bf16 a[144:147], a[132:135], a[40:43], a[144:147]
    v_cvt_pk_bf16_f32 v168, v168, v169
    v_mfma_f32_16x16x32_bf16 a[148:151], a[132:135], a[44:47], a[148:151]
    v_cvt_pk_bf16_f32 v169, v170, v171
    v_mfma_f32_16x16x32_bf16 a[152:155], a[132:135], a[48:51], a[152:155]
    v_cvt_pk_bf16_f32 v170, v200, v201
    v_mfma_f32_16x16x32_bf16 a[156:159], a[132:135], a[52:55], a[156:159]
    v_cvt_pk_bf16_f32 v171, v202, v203
    v_mfma_f32_16x16x32_bf16 a[160:163], a[132:135], a[56:59], a[160:163]
    buffer_store_dwordx4 v[168:171], v16, s[32:35], s59 offen offset:0 sc0 sc1
    v_mfma_f32_16x16x32_bf16 a[164:167], a[132:135], a[60:63], a[164:167]
    v_cvt_pk_bf16_f32 v172, v172, v173
    v_mfma_f32_16x16x32_bf16 a[168:171], a[136:139], a[32:35], a[168:171]
    v_cvt_pk_bf16_f32 v173, v174, v175
    v_mfma_f32_16x16x32_bf16 a[172:175], a[136:139], a[36:39], a[172:175]
    v_cvt_pk_bf16_f32 v174, v204, v205
    v_mfma_f32_16x16x32_bf16 a[176:179], a[136:139], a[40:43], a[176:179]
    v_cvt_pk_bf16_f32 v175, v206, v207
    v_mfma_f32_16x16x32_bf16 a[180:183], a[136:139], a[44:47], a[180:183]
    buffer_store_dwordx4 v[172:175], v16, s[32:35], s59 offen offset:128 sc0 sc1
    v_mfma_f32_16x16x32_bf16 a[184:187], a[136:139], a[48:51], a[184:187]
    s_add_u32 s59, s59, 4096
    v_mfma_f32_16x16x32_bf16 a[188:191], a[136:139], a[52:55], a[188:191]
    v_cvt_pk_bf16_f32 v176, v176, v177
    v_mfma_f32_16x16x32_bf16 a[192:195], a[136:139], a[56:59], a[192:195]
    v_cvt_pk_bf16_f32 v177, v178, v179
    v_mfma_f32_16x16x32_bf16 a[196:199], a[136:139], a[60:63], a[196:199]
    v_cvt_pk_bf16_f32 v178, v208, v209
    v_mfma_f32_16x16x32_bf16 a[200:203], a[140:143], a[32:35], a[200:203]
    v_cvt_pk_bf16_f32 v179, v210, v211
    v_mfma_f32_16x16x32_bf16 a[204:207], a[140:143], a[36:39], a[204:207]
    buffer_store_dwordx4 v[176:179], v16, s[32:35], s59 offen offset:0 sc0 sc1
    v_mfma_f32_16x16x32_bf16 a[208:211], a[140:143], a[40:43], a[208:211]
    v_cvt_pk_bf16_f32 v180, v180, v181
    v_mfma_f32_16x16x32_bf16 a[212:215], a[140:143], a[44:47], a[212:215]
    v_cvt_pk_bf16_f32 v181, v182, v183
    v_mfma_f32_16x16x32_bf16 a[216:219], a[140:143], a[48:51], a[216:219]
    v_cvt_pk_bf16_f32 v182, v212, v213
    v_mfma_f32_16x16x32_bf16 a[220:223], a[140:143], a[52:55], a[220:223]
    v_cvt_pk_bf16_f32 v183, v214, v215
    v_mfma_f32_16x16x32_bf16 a[224:227], a[140:143], a[56:59], a[224:227]
    buffer_store_dwordx4 v[180:183], v16, s[32:35], s59 offen offset:128 sc0 sc1
    v_mfma_f32_16x16x32_bf16 a[228:231], a[140:143], a[60:63], a[228:231]
    s_add_u32 s59, s59, 4096
    s_nop 7
    s_add_u32 s57, s54, 12
    s_add_u32 s57, s57, s66
    s_lshl_b32 s56, s57, 17
    s_add_u32 s56, s56, s55
    s_add_u32 s56, s56, 12582912
    v_accvgpr_read_b32 v24, a168
    v_accvgpr_read_b32 v25, a169
    v_accvgpr_read_b32 v26, a170
    v_accvgpr_read_b32 v27, a171
    v_accvgpr_read_b32 v28, a200
    v_accvgpr_read_b32 v29, a201
    v_accvgpr_read_b32 v30, a202
    v_accvgpr_read_b32 v31, a203
    v_mul_f32 v216, v24, v216
    v_mul_f32 v217, v25, v217
    v_mul_f32 v218, v26, v218
    v_mul_f32 v219, v27, v219
    v_mul_f32 v248, v28, v248
    v_mul_f32 v249, v29, v249
    v_mul_f32 v250, v30, v250
    v_mul_f32 v251, v31, v251
    v_cvt_pk_bf16_f32 v216, v216, v217
    v_cvt_pk_bf16_f32 v217, v218, v219
    v_cvt_pk_bf16_f32 v218, v248, v249
    v_cvt_pk_bf16_f32 v219, v250, v251
    buffer_store_dwordx4 v[216:219], v15, s[32:35], s56 offen offset:0 sc0 sc1
    v_accvgpr_read_b32 v32, a172
    v_accvgpr_read_b32 v33, a173
    v_accvgpr_read_b32 v34, a174
    v_accvgpr_read_b32 v35, a175
    v_accvgpr_read_b32 v36, a204
    v_accvgpr_read_b32 v37, a205
    v_accvgpr_read_b32 v38, a206
    v_accvgpr_read_b32 v39, a207
    v_mul_f32 v220, v32, v220
    v_mul_f32 v221, v33, v221
    v_mul_f32 v222, v34, v222
    v_mul_f32 v223, v35, v223
    v_mul_f32 v252, v36, v252
    v_mul_f32 v253, v37, v253
    v_mul_f32 v254, v38, v254
    v_mul_f32 v255, v39, v255
    v_cvt_pk_bf16_f32 v220, v220, v221
    v_cvt_pk_bf16_f32 v221, v222, v223
    v_cvt_pk_bf16_f32 v222, v252, v253
    v_cvt_pk_bf16_f32 v223, v254, v255
    buffer_store_dwordx4 v[220:223], v15, s[32:35], s56 offen offset:1024 sc0 sc1
    v_accvgpr_read_b32 v40, a144
    v_accvgpr_read_b32 v41, a145
    v_accvgpr_read_b32 v42, a146
    v_accvgpr_read_b32 v43, a147
    v_accvgpr_read_b32 v44, a176
    v_accvgpr_read_b32 v45, a177
    v_accvgpr_read_b32 v46, a178
    v_accvgpr_read_b32 v47, a179
    v_accvgpr_read_b32 v48, a208
    v_accvgpr_read_b32 v49, a209
    v_accvgpr_read_b32 v50, a210
    v_accvgpr_read_b32 v51, a211
    v_mul_f32 v224, v44, v224
    v_mul_f32 v225, v45, v225
    v_mul_f32 v226, v46, v226
    v_mul_f32 v227, v47, v227
    v_mul_f32 v40, v48, v40
    v_mul_f32 v41, v49, v41
    v_mul_f32 v42, v50, v42
    v_mul_f32 v43, v51, v43
    v_cvt_pk_bf16_f32 v224, v224, v225
    v_cvt_pk_bf16_f32 v225, v226, v227
    v_cvt_pk_bf16_f32 v226, v40, v41
    v_cvt_pk_bf16_f32 v227, v42, v43
    buffer_store_dwordx4 v[224:227], v15, s[32:35], s56 offen offset:2048 sc0 sc1
    v_accvgpr_read_b32 v52, a148
    v_accvgpr_read_b32 v53, a149
    v_accvgpr_read_b32 v54, a150
    v_accvgpr_read_b32 v55, a151
    v_accvgpr_read_b32 v24, a180
    v_accvgpr_read_b32 v25, a181
    v_accvgpr_read_b32 v26, a182
    v_accvgpr_read_b32 v27, a183
    v_accvgpr_read_b32 v28, a212
    v_accvgpr_read_b32 v29, a213
    v_accvgpr_read_b32 v30, a214
    v_accvgpr_read_b32 v31, a215
    v_mul_f32 v228, v24, v228
    v_mul_f32 v229, v25, v229
    v_mul_f32 v230, v26, v230
    v_mul_f32 v231, v27, v231
    v_mul_f32 v52, v28, v52
    v_mul_f32 v53, v29, v53
    v_mul_f32 v54, v30, v54
    v_mul_f32 v55, v31, v55
    v_cvt_pk_bf16_f32 v228, v228, v229
    v_cvt_pk_bf16_f32 v229, v230, v231
    v_cvt_pk_bf16_f32 v230, v52, v53
    v_cvt_pk_bf16_f32 v231, v54, v55
    buffer_store_dwordx4 v[228:231], v15, s[32:35], s56 offen offset:3072 sc0 sc1
    s_add_u32 s56, s56, 4096
    v_accvgpr_read_b32 v32, a152
    v_accvgpr_read_b32 v33, a153
    v_accvgpr_read_b32 v34, a154
    v_accvgpr_read_b32 v35, a155
    v_accvgpr_read_b32 v36, a184
    v_accvgpr_read_b32 v37, a185
    v_accvgpr_read_b32 v38, a186
    v_accvgpr_read_b32 v39, a187
    v_accvgpr_read_b32 v40, a216
    v_accvgpr_read_b32 v41, a217
    v_accvgpr_read_b32 v42, a218
    v_accvgpr_read_b32 v43, a219
    v_mul_f32 v232, v36, v232
    v_mul_f32 v233, v37, v233
    v_mul_f32 v234, v38, v234
    v_mul_f32 v235, v39, v235
    v_mul_f32 v32, v40, v32
    v_mul_f32 v33, v41, v33
    v_mul_f32 v34, v42, v34
    v_mul_f32 v35, v43, v35
    v_cvt_pk_bf16_f32 v232, v232, v233
    v_cvt_pk_bf16_f32 v233, v234, v235
    v_cvt_pk_bf16_f32 v234, v32, v33
    v_cvt_pk_bf16_f32 v235, v34, v35
    buffer_store_dwordx4 v[232:235], v15, s[32:35], s56 offen offset:0 sc0 sc1
    v_accvgpr_read_b32 v44, a156
    v_accvgpr_read_b32 v45, a157
    v_accvgpr_read_b32 v46, a158
    v_accvgpr_read_b32 v47, a159
    v_accvgpr_read_b32 v48, a188
    v_accvgpr_read_b32 v49, a189
    v_accvgpr_read_b32 v50, a190
    v_accvgpr_read_b32 v51, a191
    v_accvgpr_read_b32 v52, a220
    v_accvgpr_read_b32 v53, a221
    v_accvgpr_read_b32 v54, a222
    v_accvgpr_read_b32 v55, a223
    v_mul_f32 v236, v48, v236
    v_mul_f32 v237, v49, v237
    v_mul_f32 v238, v50, v238
    v_mul_f32 v239, v51, v239
    v_mul_f32 v44, v52, v44
    v_mul_f32 v45, v53, v45
    v_mul_f32 v46, v54, v46
    v_mul_f32 v47, v55, v47
    v_cvt_pk_bf16_f32 v236, v236, v237
    v_cvt_pk_bf16_f32 v237, v238, v239
    v_cvt_pk_bf16_f32 v238, v44, v45
    v_cvt_pk_bf16_f32 v239, v46, v47
    buffer_store_dwordx4 v[236:239], v15, s[32:35], s56 offen offset:1024 sc0 sc1
    v_accvgpr_read_b32 v24, a160
    v_accvgpr_read_b32 v25, a161
    v_accvgpr_read_b32 v26, a162
    v_accvgpr_read_b32 v27, a163
    v_accvgpr_read_b32 v28, a192
    v_accvgpr_read_b32 v29, a193
    v_accvgpr_read_b32 v30, a194
    v_accvgpr_read_b32 v31, a195
    v_accvgpr_read_b32 v32, a224
    v_accvgpr_read_b32 v33, a225
    v_accvgpr_read_b32 v34, a226
    v_accvgpr_read_b32 v35, a227
    v_mul_f32 v240, v28, v240
    v_mul_f32 v241, v29, v241
    v_mul_f32 v242, v30, v242
    v_mul_f32 v243, v31, v243
    v_mul_f32 v24, v32, v24
    v_mul_f32 v25, v33, v25
    v_mul_f32 v26, v34, v26
    v_mul_f32 v27, v35, v27
    v_cvt_pk_bf16_f32 v240, v240, v241
    v_cvt_pk_bf16_f32 v241, v242, v243
    v_cvt_pk_bf16_f32 v242, v24, v25
    v_cvt_pk_bf16_f32 v243, v26, v27
    buffer_store_dwordx4 v[240:243], v15, s[32:35], s56 offen offset:2048 sc0 sc1
    v_accvgpr_read_b32 v36, a164
    v_accvgpr_read_b32 v37, a165
    v_accvgpr_read_b32 v38, a166
    v_accvgpr_read_b32 v39, a167
    v_accvgpr_read_b32 v40, a196
    v_accvgpr_read_b32 v41, a197
    v_accvgpr_read_b32 v42, a198
    v_accvgpr_read_b32 v43, a199
    v_accvgpr_read_b32 v44, a228
    v_accvgpr_read_b32 v45, a229
    v_accvgpr_read_b32 v46, a230
    v_accvgpr_read_b32 v47, a231
    v_mul_f32 v244, v40, v244
    v_mul_f32 v245, v41, v245
    v_mul_f32 v246, v42, v246
    v_mul_f32 v247, v43, v247
    v_mul_f32 v36, v44, v36
    v_mul_f32 v37, v45, v37
    v_mul_f32 v38, v46, v38
    v_mul_f32 v39, v47, v39
    v_cvt_pk_bf16_f32 v244, v244, v245
    v_cvt_pk_bf16_f32 v245, v246, v247
    v_cvt_pk_bf16_f32 v246, v36, v37
    v_cvt_pk_bf16_f32 v247, v38, v39
    buffer_store_dwordx4 v[244:247], v15, s[32:35], s56 offen offset:3072 sc0 sc1
    s_waitcnt vmcnt(0)
    v_readfirstlane_b32 s58, v23
    s_cmp_lg_u32 s58, 255
    s_cbranch_scc1 L_gemm1_kernel_neB
    v_mov_b32 v22, 32768
    v_mov_b32 v23, s69
    s_mov_b64 exec, 1
    buffer_store_dword v23, v22, s[36:39], 0 offen sc0 sc1
    s_mov_b64 exec, -1
L_gemm1_kernel_neB:
    s_endpgm
L_gemm1_kernel_end:
    s_endpgm
.text
.globl parallel_sum__softmax_full_mha__glu_gated_bilinear__prompt_kernel
.p2align 8
.type parallel_sum__softmax_full_mha__glu_gated_bilinear__prompt_kernel,@function
parallel_sum__softmax_full_mha__glu_gated_bilinear__prompt_kernel:
    s_cmp_ge_u32 s2, 256
    s_cbranch_scc1 L_parallel_sum__softmax_full_mha__glu_gated_bilinear__prompt_kernel_end
    s_load_dwordx2 s[6:7], s[0:1], 72
    s_load_dwordx2 s[56:57], s[0:1], 16
    s_load_dwordx2 s[58:59], s[0:1], 48
    s_and_b32 s30, s2, 7
    s_lshr_b32 s31, s2, 3
    s_and_b32 s32, s31, 3
    s_lshl_b32 s30, s30, 2
    s_add_u32 s30, s30, s32
    s_lshr_b32 s31, s31, 2
    v_lshrrev_b32 v3, 6, v0
    v_and_b32 v0, 63, v0
    v_readfirstlane_b32 s33, v3
    v_lshlrev_b32 v1, 4, v0
    s_cmp_ge_u32 s33, 4
    s_cbranch_scc1 L_parallel_sum__softmax_full_mha__glu_gated_bilinear__prompt_kernel_role2
    s_setprio 1
    s_lshl_b32 s20, s33, 12
    v_add_u32 v2, s20, v1
    s_lshl_b32 s34, s31, 3
    s_lshl_b32 s35, s33, 1
    s_add_u32 s34, s34, s35
    s_lshl_b32 s35, s30, 18
    s_add_u32 s35, s35, 8388608
    s_lshl_b32 s36, s30, 17
    s_lshl_b32 s37, s34, 11
    s_add_u32 s36, s36, s37
    s_mov_b32 s40, 0
    s_waitcnt lgkmcnt(0)
    s_add_u32 s8, s6, s35
    s_addc_u32 s9, s7, 0
    s_mov_b32 s10, 262144
    s_mov_b32 s11, 0x20000
    s_add_u32 s12, s6, 4194304
    s_addc_u32 s13, s7, 0
    s_mov_b32 s14, 4194304
    s_mov_b32 s15, 0x20000
    s_add_u32 s16, s6, 16777216
    s_addc_u32 s17, s7, 0
    s_mov_b32 s18, 4194304
    s_mov_b32 s19, 0x20000
    s_add_u32 s24, s6, 41943040
    s_addc_u32 s25, s7, 0
    s_mov_b32 s26, 131072
    s_mov_b32 s27, 0x20000
    s_lshl_b32 s28, s30, 5
    s_lshr_b32 s29, s34, 1
    s_add_u32 s28, s28, s29
    s_lshl_b32 s28, s28, 7
    s_mov_b32 s52, s56
    s_mov_b32 s53, s57
    s_mov_b32 s54, 2097152
    s_mov_b32 s55, 0x20000
    s_mov_b32 s60, s58
    s_mov_b32 s61, s59
    s_mov_b32 s62, 7340032
    s_mov_b32 s63, 0x20000
    s_lshl_b32 s50, s2, 2
    s_add_u32 s50, s50, s33
    s_lshl_b32 s51, s50, 11
    s_mul_i32 s50, s50, 7168
L_parallel_sum__softmax_full_mha__glu_gated_bilinear__prompt_kernel_restart:
    s_mov_b32 s21, 0
    s_add_u32 m0, s20, 0
    s_nop 0
    buffer_load_dwordx4 v2, s[8:11], s21 offen offset:0 lds
    buffer_load_dwordx4 v2, s[8:11], s21 offen offset:1024 lds
    buffer_load_dwordx4 v2, s[8:11], s21 offen offset:2048 lds
    buffer_load_dwordx4 v2, s[8:11], s21 offen offset:3072 lds
    s_add_u32 s21, s21, 16384
    buffer_load_dwordx4 v[8:11], v1, s[12:15], s36 offen offset:0
    buffer_load_dwordx4 v[12:15], v1, s[12:15], s36 offen offset:1024
    buffer_load_dwordx4 v[16:19], v1, s[12:15], s36 offen offset:2048
    buffer_load_dwordx4 v[20:23], v1, s[12:15], s36 offen offset:3072
    s_cmp_lg_u32 s40, 0
    s_cbranch_scc1 L_parallel_sum__softmax_full_mha__glu_gated_bilinear__prompt_kernel_keepm
    v_mov_b32 v156, 0
    v_mov_b32 v157, 0
    v_mov_b32 v158, 0
    v_mov_b32 v159, 0
    v_mov_b32 v160, 0
    v_mov_b32 v161, 0
    v_mov_b32 v162, 0
    v_mov_b32 v163, 0
    v_mov_b32 v164, 0
    v_mov_b32 v165, 0
    v_mov_b32 v166, 0
    v_mov_b32 v167, 0
    v_mov_b32 v168, 0
    v_mov_b32 v169, 0
    v_mov_b32 v170, 0
    v_mov_b32 v171, 0
    v_mov_b32 v172, 0
    v_mov_b32 v173, 0
    v_mov_b32 v174, 0
    v_mov_b32 v175, 0
    v_mov_b32 v176, 0
    v_mov_b32 v177, 0
    v_mov_b32 v178, 0
    v_mov_b32 v179, 0
    v_mov_b32 v180, 0
    v_mov_b32 v181, 0
    v_mov_b32 v182, 0
    v_mov_b32 v183, 0
    v_mov_b32 v184, 0
    v_mov_b32 v185, 0
    v_mov_b32 v186, 0
    v_mov_b32 v187, 0
L_parallel_sum__softmax_full_mha__glu_gated_bilinear__prompt_kernel_keepm:
    s_and_b32 s64, s2, 1
    s_lshl_b32 s64, s64, 3
    s_lshr_b32 s65, s2, 3
    s_and_b32 s65, s65, 7
    s_add_u32 s64, s64, s65
    s_lshl_b32 s66, s64, 7
    s_add_u32 s64, s56, s66
    s_addc_u32 s65, s57, 0
    s_sub_u32 s66, 2097152, s66
    s_lshl_b32 s67, s33, 16
    s_add_u32 s67, s67, 1310720
    s_mov_b32 s68, 262144
    s_mov_b32 s23, 16384
    s_mov_b32 s69, 0x800000
    s_sub_u32 s70, s67, 786432
    v_lshrrev_b32 v4, 4, v0
    v_bfe_u32 v5, v0, 1, 2
    v_xor_b32 v5, v5, v4
    v_lshlrev_b32 v5, 5, v5
    v_and_b32 v4, 1, v0
    v_lshl_or_b32 v5, v4, 4, v5
    v_lshrrev_b32 v4, 3, v0
    v_lshl_add_u32 v200, v4, 11, v5
    v_add_u32 v201, 15360, v200
    v_add_u32 v202, 30720, v200
    v_add_u32 v203, 46080, v200
    v_mov_b32 v196, v2
    v_mov_b32 v197, v2
    v_mov_b32 v198, v2
    v_mov_b32 v199, v2
    v_lshrrev_b32 v4, 2, v0
    v_xor_b32 v4, v4, v0
    v_bfe_u32 v4, v4, 2, 1
    v_add_u32 v4, -1, v4
    v_and_b32 v152, 0x3f803f80, v4
    v_mov_b32 v153, v152
    v_mov_b32 v154, v152
    v_mov_b32 v155, v152
    v_mov_b32 v40, 0
    v_mov_b32 v41, 0
    v_mov_b32 v42, 0
    v_mov_b32 v43, 0
    v_mov_b32 v44, 0
    v_mov_b32 v45, 0
    v_mov_b32 v46, 0
    v_mov_b32 v47, 0
    v_mov_b32 v48, 0
    v_mov_b32 v49, 0
    v_mov_b32 v50, 0
    v_mov_b32 v51, 0
    v_mov_b32 v52, 0
    v_mov_b32 v53, 0
    v_mov_b32 v54, 0
    v_mov_b32 v55, 0
    v_mov_b32 v56, 0
    v_mov_b32 v57, 0
    v_mov_b32 v58, 0
    v_mov_b32 v59, 0
    v_mov_b32 v60, 0
    v_mov_b32 v61, 0
    v_mov_b32 v62, 0
    v_mov_b32 v63, 0
    v_mov_b32 v188, 0
    v_mov_b32 v189, 0
    v_mov_b32 v190, 0
    v_mov_b32 v191, 0
    v_mov_b32 v192, 0
    v_mov_b32 v193, 0
    v_mov_b32 v194, 0
    v_mov_b32 v195, 0
    v_mov_b32 v76, 0
    v_mov_b32 v77, 0
    v_mov_b32 v78, 0
    v_mov_b32 v79, 0
    v_mov_b32 v112, 0
    v_mov_b32 v113, 0
    v_mov_b32 v114, 0
    v_mov_b32 v115, 0
    v_mov_b32 v116, 0
    v_mov_b32 v117, 0
    v_mov_b32 v118, 0
    v_mov_b32 v119, 0
    v_mov_b32 v120, 0
    v_mov_b32 v121, 0
    v_mov_b32 v122, 0
    v_mov_b32 v123, 0
    v_mov_b32 v124, 0
    v_mov_b32 v125, 0
    v_mov_b32 v126, 0
    v_mov_b32 v127, 0
    v_mov_b32 v128, 0
    v_mov_b32 v129, 0
    v_mov_b32 v130, 0
    v_mov_b32 v131, 0
    v_mov_b32 v132, 0
    v_mov_b32 v133, 0
    v_mov_b32 v134, 0
    v_mov_b32 v135, 0
    v_mov_b32 v136, 0
    v_mov_b32 v137, 0
    v_mov_b32 v138, 0
    v_mov_b32 v139, 0
    v_mov_b32 v140, 0
    v_mov_b32 v141, 0
    v_mov_b32 v142, 0
    v_mov_b32 v143, 0
    v_mov_b32 v144, 0
    v_mov_b32 v145, 0
    v_mov_b32 v146, 0
    v_mov_b32 v147, 0
    v_mov_b32 v148, 0
    v_mov_b32 v149, 0
    v_mov_b32 v150, 0
    v_mov_b32 v151, 0
    v_lshlrev_b32 v5, 5, v0
    s_mov_b32 s22, 4
    s_waitcnt vmcnt(0)
    s_barrier
    ds_read_b128 v[24:27], v1 offset:0
    ds_read_b128 v[28:31], v1 offset:1024
    ds_read_b128 v[40:43], v1 offset:2048
    ds_read_b128 v[44:47], v1 offset:3072
    s_add_u32 m0, s20, 16384
    s_nop 0
    buffer_load_dwordx4 v2, s[8:11], s21 offen offset:0 lds
    buffer_load_dwordx4 v2, s[8:11], s21 offen offset:1024 lds
    buffer_load_dwordx4 v2, s[8:11], s21 offen offset:2048 lds
    buffer_load_dwordx4 v2, s[8:11], s21 offen offset:3072 lds
    s_add_u32 s21, s21, 16384
    s_add_u32 m0, s20, 32768
    s_nop 0
    buffer_load_dwordx4 v2, s[8:11], s21 offen offset:0 lds
    buffer_load_dwordx4 v2, s[8:11], s21 offen offset:1024 lds
    buffer_load_dwordx4 v2, s[8:11], s21 offen offset:2048 lds
    buffer_load_dwordx4 v2, s[8:11], s21 offen offset:3072 lds
    s_add_u32 s21, s21, 16384
    s_waitcnt lgkmcnt(0)
    v_mfma_f32_32x32x16_bf16 v[80:95], v[24:27], v[8:11], v[156:171]
    v_mfma_f32_32x32x16_bf16 v[80:95], v[28:31], v[12:15], v[80:95]
    s_nop 7
    s_nop 3
L_parallel_sum__softmax_full_mha__glu_gated_bilinear__prompt_kernel_loop:
    v_mfma_f32_32x32x16_bf16 v[96:111], v[24:27], v[16:19], v[172:187]
    v_exp_f32 v64, v80
    v_exp_f32 v65, v81
    ds_read_b128 v[32:35], v1 offset:4096
    v_cvt_pk_bf16_f32 v195, v78, v79
    v_exp_f32 v66, v82
    v_exp_f32 v67, v83
    v_mfma_f32_32x32x16_bf16 v[96:111], v[28:31], v[20:23], v[96:111]
    ds_read_b128 v[36:39], v1 offset:5120
    v_cvt_pk_bf16_f32 v56, v64, v65
    v_exp_f32 v68, v84
    v_exp_f32 v69, v85
    v_cvt_pk_bf16_f32 v57, v66, v67
    v_mfma_f32_16x16x32_bf16 v[148:151], v[152:155], v[188:191], v[148:151]
    v_exp_f32 v70, v86
    v_mfma_f32_32x32x16_bf16 v[128:143], v[48:51], v[188:191], v[128:143]
    v_exp_f32 v71, v87
    v_cvt_pk_bf16_f32 v58, v68, v69
    v_exp_f32 v72, v88
    v_exp_f32 v73, v89
    v_mfma_f32_16x16x32_bf16 v[148:151], v[152:155], v[192:195], v[148:151]
    v_cvt_pk_bf16_f32 v59, v70, v71
    v_exp_f32 v74, v90
    v_mfma_f32_32x32x16_bf16 v[128:143], v[52:55], v[192:195], v[128:143]
    v_exp_f32 v75, v91
    v_cvt_pk_bf16_f32 v60, v72, v73
    v_exp_f32 v76, v92
    v_exp_f32 v77, v93
    v_cvt_pk_bf16_f32 v61, v74, v75
    v_exp_f32 v78, v94
    v_exp_f32 v79, v95
    v_cvt_pk_bf16_f32 v62, v76, v77
    s_waitcnt lgkmcnt(0)
    v_mfma_f32_32x32x16_bf16 v[80:95], v[32:35], v[8:11], v[156:171]
    v_exp_f32 v64, v96
    v_exp_f32 v65, v97
    v_cvt_pk_bf16_f32 v63, v78, v79
    v_exp_f32 v66, v98
    v_exp_f32 v67, v99
    v_mfma_f32_32x32x16_bf16 v[80:95], v[36:39], v[12:15], v[80:95]
    v_cvt_pk_bf16_f32 v188, v64, v65
    v_exp_f32 v68, v100
    v_exp_f32 v69, v101
    v_cvt_pk_bf16_f32 v189, v66, v67
    v_mfma_f32_16x16x32_bf16 v[144:147], v[152:155], v[56:59], v[144:147]
    ds_read_b128 v[48:51], v1 offset:6144
    v_exp_f32 v70, v102
    v_mfma_f32_32x32x16_bf16 v[112:127], v[40:43], v[56:59], v[112:127]
    ds_read_b128 v[52:55], v1 offset:7168
    v_exp_f32 v71, v103
    v_cvt_pk_bf16_f32 v190, v68, v69
    v_exp_f32 v72, v104
    v_exp_f32 v73, v105
    v_mfma_f32_16x16x32_bf16 v[144:147], v[152:155], v[60:63], v[144:147]
    v_cvt_pk_bf16_f32 v191, v70, v71
    v_exp_f32 v74, v106
    v_mfma_f32_32x32x16_bf16 v[112:127], v[44:47], v[60:63], v[112:127]
    v_exp_f32 v75, v107
    v_cvt_pk_bf16_f32 v192, v72, v73
    v_exp_f32 v76, v108
    v_exp_f32 v77, v109
    v_cvt_pk_bf16_f32 v193, v74, v75
    v_exp_f32 v78, v110
    v_exp_f32 v79, v111
    v_cvt_pk_bf16_f32 v194, v76, v77
    v_mfma_f32_32x32x16_bf16 v[96:111], v[32:35], v[16:19], v[172:187]
    v_exp_f32 v64, v80
    v_exp_f32 v65, v81
    ds_read_b128 v[24:27], v1 offset:8192
    v_cvt_pk_bf16_f32 v195, v78, v79
    v_exp_f32 v66, v82
    v_exp_f32 v67, v83
    v_mfma_f32_32x32x16_bf16 v[96:111], v[36:39], v[20:23], v[96:111]
    ds_read_b128 v[28:31], v1 offset:9216
    v_cvt_pk_bf16_f32 v56, v64, v65
    v_exp_f32 v68, v84
    v_exp_f32 v69, v85
    v_cvt_pk_bf16_f32 v57, v66, v67
    v_mfma_f32_16x16x32_bf16 v[148:151], v[152:155], v[188:191], v[148:151]
    v_exp_f32 v70, v86
    v_mfma_f32_32x32x16_bf16 v[128:143], v[40:43], v[188:191], v[128:143]
    v_exp_f32 v71, v87
    v_cvt_pk_bf16_f32 v58, v68, v69
    v_exp_f32 v72, v88
    v_exp_f32 v73, v89
    v_mfma_f32_16x16x32_bf16 v[148:151], v[152:155], v[192:195], v[148:151]
    v_cvt_pk_bf16_f32 v59, v70, v71
    v_exp_f32 v74, v90
    v_mfma_f32_32x32x16_bf16 v[128:143], v[44:47], v[192:195], v[128:143]
    v_exp_f32 v75, v91
    v_cvt_pk_bf16_f32 v60, v72, v73
    v_exp_f32 v76, v92
    v_exp_f32 v77, v93
    v_cvt_pk_bf16_f32 v61, v74, v75
    v_exp_f32 v78, v94
    v_exp_f32 v79, v95
    v_cvt_pk_bf16_f32 v62, v76, v77
    s_waitcnt lgkmcnt(0)
    v_mfma_f32_32x32x16_bf16 v[80:95], v[24:27], v[8:11], v[156:171]
    v_exp_f32 v64, v96
    v_exp_f32 v65, v97
    v_cvt_pk_bf16_f32 v63, v78, v79
    v_exp_f32 v66, v98
    v_exp_f32 v67, v99
    v_mfma_f32_32x32x16_bf16 v[80:95], v[28:31], v[12:15], v[80:95]
    v_cvt_pk_bf16_f32 v188, v64, v65
    v_exp_f32 v68, v100
    v_exp_f32 v69, v101
    v_cvt_pk_bf16_f32 v189, v66, v67
    v_mfma_f32_16x16x32_bf16 v[144:147], v[152:155], v[56:59], v[144:147]
    ds_read_b128 v[40:43], v1 offset:10240
    v_exp_f32 v70, v102
    v_mfma_f32_32x32x16_bf16 v[112:127], v[48:51], v[56:59], v[112:127]
    ds_read_b128 v[44:47], v1 offset:11264
    v_exp_f32 v71, v103
    v_cvt_pk_bf16_f32 v190, v68, v69
    v_exp_f32 v72, v104
    v_exp_f32 v73, v105
    v_mfma_f32_16x16x32_bf16 v[144:147], v[152:155], v[60:63], v[144:147]
    v_cvt_pk_bf16_f32 v191, v70, v71
    v_exp_f32 v74, v106
    v_mfma_f32_32x32x16_bf16 v[112:127], v[52:55], v[60:63], v[112:127]
    v_exp_f32 v75, v107
    v_cvt_pk_bf16_f32 v192, v72, v73
    v_exp_f32 v76, v108
    v_exp_f32 v77, v109
    v_cvt_pk_bf16_f32 v193, v74, v75
    v_exp_f32 v78, v110
    v_exp_f32 v79, v111
    v_cvt_pk_bf16_f32 v194, v76, v77
    v_mfma_f32_32x32x16_bf16 v[96:111], v[24:27], v[16:19], v[172:187]
    v_exp_f32 v64, v80
    v_exp_f32 v65, v81
    ds_read_b128 v[32:35], v1 offset:12288
    v_cvt_pk_bf16_f32 v195, v78, v79
    v_exp_f32 v66, v82
    v_exp_f32 v67, v83
    v_mfma_f32_32x32x16_bf16 v[96:111], v[28:31], v[20:23], v[96:111]
    ds_read_b128 v[36:39], v1 offset:13312
    v_cvt_pk_bf16_f32 v56, v64, v65
    v_exp_f32 v68, v84
    v_exp_f32 v69, v85
    v_cvt_pk_bf16_f32 v57, v66, v67
    v_mfma_f32_16x16x32_bf16 v[148:151], v[152:155], v[188:191], v[148:151]
    v_exp_f32 v70, v86
    v_mfma_f32_32x32x16_bf16 v[128:143], v[48:51], v[188:191], v[128:143]
    v_exp_f32 v71, v87
    v_cvt_pk_bf16_f32 v58, v68, v69
    v_exp_f32 v72, v88
    v_exp_f32 v73, v89
    v_mfma_f32_16x16x32_bf16 v[148:151], v[152:155], v[192:195], v[148:151]
    v_cvt_pk_bf16_f32 v59, v70, v71
    v_exp_f32 v74, v90
    v_mfma_f32_32x32x16_bf16 v[128:143], v[52:55], v[192:195], v[128:143]
    v_exp_f32 v75, v91
    v_cvt_pk_bf16_f32 v60, v72, v73
    v_exp_f32 v76, v92
    v_exp_f32 v77, v93
    v_cvt_pk_bf16_f32 v61, v74, v75
    v_exp_f32 v78, v94
    v_exp_f32 v79, v95
    v_cvt_pk_bf16_f32 v62, v76, v77
    s_waitcnt lgkmcnt(0)
    v_mfma_f32_32x32x16_bf16 v[80:95], v[32:35], v[8:11], v[156:171]
    v_exp_f32 v64, v96
    v_exp_f32 v65, v97
    v_cvt_pk_bf16_f32 v63, v78, v79
    v_exp_f32 v66, v98
    v_exp_f32 v67, v99
    v_mfma_f32_32x32x16_bf16 v[80:95], v[36:39], v[12:15], v[80:95]
    v_cvt_pk_bf16_f32 v188, v64, v65
    v_exp_f32 v68, v100
    v_exp_f32 v69, v101
    v_cvt_pk_bf16_f32 v189, v66, v67
    v_mfma_f32_16x16x32_bf16 v[144:147], v[152:155], v[56:59], v[144:147]
    ds_read_b128 v[48:51], v1 offset:14336
    v_exp_f32 v70, v102
    v_mfma_f32_32x32x16_bf16 v[112:127], v[40:43], v[56:59], v[112:127]
    ds_read_b128 v[52:55], v1 offset:15360
    v_exp_f32 v71, v103
    v_cvt_pk_bf16_f32 v190, v68, v69
    v_exp_f32 v72, v104
    v_exp_f32 v73, v105
    v_mfma_f32_16x16x32_bf16 v[144:147], v[152:155], v[60:63], v[144:147]
    v_cvt_pk_bf16_f32 v191, v70, v71
    v_exp_f32 v74, v106
    s_waitcnt vmcnt(4)
    v_mfma_f32_32x32x16_bf16 v[112:127], v[44:47], v[60:63], v[112:127]
    s_barrier
    v_exp_f32 v75, v107
    s_add_u32 m0, s20, 49152
    v_cvt_pk_bf16_f32 v192, v72, v73
    v_exp_f32 v76, v108
    v_exp_f32 v77, v109
    buffer_load_dwordx4 v196, s[8:11], s21 offen offset:0 lds
    v_cvt_pk_bf16_f32 v193, v74, v75
    buffer_load_dwordx4 v197, s[8:11], s21 offen offset:1024 lds
    v_exp_f32 v78, v110
    buffer_load_dwordx4 v198, s[8:11], s21 offen offset:2048 lds
    v_exp_f32 v79, v111
    buffer_load_dwordx4 v199, s[8:11], s21 offen offset:3072 lds
    s_add_u32 s21, s21, s23
    v_cvt_pk_bf16_f32 v194, v76, v77
    v_mfma_f32_32x32x16_bf16 v[96:111], v[32:35], v[16:19], v[172:187]
    v_exp_f32 v64, v80
    v_exp_f32 v65, v81
    ds_read_b128 v[24:27], v1 offset:16384
    v_cvt_pk_bf16_f32 v195, v78, v79
    v_exp_f32 v66, v82
    v_exp_f32 v67, v83
    v_mfma_f32_32x32x16_bf16 v[96:111], v[36:39], v[20:23], v[96:111]
    ds_read_b128 v[28:31], v1 offset:17408
    v_cvt_pk_bf16_f32 v56, v64, v65
    v_exp_f32 v68, v84
    v_exp_f32 v69, v85
    v_cvt_pk_bf16_f32 v57, v66, v67
    v_mfma_f32_16x16x32_bf16 v[148:151], v[152:155], v[188:191], v[148:151]
    v_exp_f32 v70, v86
    buffer_load_dword v3, v1, s[52:55], s51 offen
    v_mfma_f32_32x32x16_bf16 v[128:143], v[40:43], v[188:191], v[128:143]
    v_exp_f32 v71, v87
    v_cvt_pk_bf16_f32 v58, v68, v69
    v_exp_f32 v72, v88
    s_add_u32 s50, s50, 1792
    v_exp_f32 v73, v89
    s_add_u32 s51, s51, 512
    v_mfma_f32_16x16x32_bf16 v[148:151], v[152:155], v[192:195], v[148:151]
    v_cvt_pk_bf16_f32 v59, v70, v71
    v_exp_f32 v74, v90
    v_mfma_f32_32x32x16_bf16 v[128:143], v[44:47], v[192:195], v[128:143]
    v_exp_f32 v75, v91
    v_cvt_pk_bf16_f32 v60, v72, v73
    v_exp_f32 v76, v92
    v_exp_f32 v77, v93
    v_cvt_pk_bf16_f32 v61, v74, v75
    v_exp_f32 v78, v94
    v_exp_f32 v79, v95
    v_cvt_pk_bf16_f32 v62, v76, v77
    s_waitcnt lgkmcnt(0)
    v_mfma_f32_32x32x16_bf16 v[80:95], v[24:27], v[8:11], v[156:171]
    v_exp_f32 v64, v96
    v_exp_f32 v65, v97
    v_cvt_pk_bf16_f32 v63, v78, v79
    v_exp_f32 v66, v98
    v_exp_f32 v67, v99
    v_mfma_f32_32x32x16_bf16 v[80:95], v[28:31], v[12:15], v[80:95]
    v_cvt_pk_bf16_f32 v188, v64, v65
    v_exp_f32 v68, v100
    v_exp_f32 v69, v101
    v_cvt_pk_bf16_f32 v189, v66, v67
    v_mfma_f32_16x16x32_bf16 v[144:147], v[152:155], v[56:59], v[144:147]
    ds_read_b128 v[40:43], v1 offset:18432
    v_exp_f32 v70, v102
    v_mfma_f32_32x32x16_bf16 v[112:127], v[48:51], v[56:59], v[112:127]
    ds_read_b128 v[44:47], v1 offset:19456
    v_exp_f32 v71, v103
    v_cvt_pk_bf16_f32 v190, v68, v69
    v_exp_f32 v72, v104
    v_exp_f32 v73, v105
    v_mfma_f32_16x16x32_bf16 v[144:147], v[152:155], v[60:63], v[144:147]
    v_cvt_pk_bf16_f32 v191, v70, v71
    v_exp_f32 v74, v106
    v_mfma_f32_32x32x16_bf16 v[112:127], v[52:55], v[60:63], v[112:127]
    v_exp_f32 v75, v107
    v_cvt_pk_bf16_f32 v192, v72, v73
    v_exp_f32 v76, v108
    v_exp_f32 v77, v109
    v_cvt_pk_bf16_f32 v193, v74, v75
    v_exp_f32 v78, v110
    v_exp_f32 v79, v111
    v_cvt_pk_bf16_f32 v194, v76, v77
    v_mfma_f32_32x32x16_bf16 v[96:111], v[24:27], v[16:19], v[172:187]
    v_exp_f32 v64, v80
    v_exp_f32 v65, v81
    ds_read_b128 v[32:35], v1 offset:20480
    v_cvt_pk_bf16_f32 v195, v78, v79
    v_exp_f32 v66, v82
    v_exp_f32 v67, v83
    v_mfma_f32_32x32x16_bf16 v[96:111], v[28:31], v[20:23], v[96:111]
    ds_read_b128 v[36:39], v1 offset:21504
    v_cvt_pk_bf16_f32 v56, v64, v65
    v_exp_f32 v68, v84
    v_exp_f32 v69, v85
    v_cvt_pk_bf16_f32 v57, v66, v67
    v_mfma_f32_16x16x32_bf16 v[148:151], v[152:155], v[188:191], v[148:151]
    v_exp_f32 v70, v86
    v_mfma_f32_32x32x16_bf16 v[128:143], v[48:51], v[188:191], v[128:143]
    v_exp_f32 v71, v87
    v_cvt_pk_bf16_f32 v58, v68, v69
    v_exp_f32 v72, v88
    v_exp_f32 v73, v89
    v_mfma_f32_16x16x32_bf16 v[148:151], v[152:155], v[192:195], v[148:151]
    v_cvt_pk_bf16_f32 v59, v70, v71
    v_exp_f32 v74, v90
    v_mfma_f32_32x32x16_bf16 v[128:143], v[52:55], v[192:195], v[128:143]
    v_exp_f32 v75, v91
    v_cvt_pk_bf16_f32 v60, v72, v73
    v_exp_f32 v76, v92
    v_exp_f32 v77, v93
    v_cvt_pk_bf16_f32 v61, v74, v75
    v_exp_f32 v78, v94
    v_exp_f32 v79, v95
    v_cvt_pk_bf16_f32 v62, v76, v77
    s_waitcnt lgkmcnt(0)
    v_mfma_f32_32x32x16_bf16 v[80:95], v[32:35], v[8:11], v[156:171]
    v_exp_f32 v64, v96
    v_exp_f32 v65, v97
    v_cvt_pk_bf16_f32 v63, v78, v79
    s_cmp_eq_u32 s22, 1
    s_cmov_b64 s[8:9], s[64:65]
    s_cmov_b32 s10, s66
    s_cmov_b32 s21, s67
    s_cmov_b32 s23, s68
    s_cselect_b64 vcc, -1, 0
    v_exp_f32 v66, v98
    v_exp_f32 v67, v99
    v_mfma_f32_32x32x16_bf16 v[80:95], v[36:39], v[12:15], v[80:95]
    v_cvt_pk_bf16_f32 v188, v64, v65
    v_exp_f32 v68, v100
    v_exp_f32 v69, v101
    v_cvt_pk_bf16_f32 v189, v66, v67
    v_mfma_f32_16x16x32_bf16 v[144:147], v[152:155], v[56:59], v[144:147]
    ds_read_b128 v[48:51], v1 offset:22528
    v_exp_f32 v70, v102
    v_mfma_f32_32x32x16_bf16 v[112:127], v[40:43], v[56:59], v[112:127]
    ds_read_b128 v[52:55], v1 offset:23552
    v_exp_f32 v71, v103
    v_cvt_pk_bf16_f32 v190, v68, v69
    v_cndmask_b32 v196, v196, v200, vcc
    v_exp_f32 v72, v104
    v_exp_f32 v73, v105
    v_cndmask_b32 v197, v197, v201, vcc
    v_mfma_f32_16x16x32_bf16 v[144:147], v[152:155], v[60:63], v[144:147]
    v_cvt_pk_bf16_f32 v191, v70, v71
    v_cndmask_b32 v198, v198, v202, vcc
    v_exp_f32 v74, v106
    v_mfma_f32_32x32x16_bf16 v[112:127], v[44:47], v[60:63], v[112:127]
    v_cndmask_b32 v199, v199, v203, vcc
    v_exp_f32 v75, v107
    v_cvt_pk_bf16_f32 v192, v72, v73
    v_exp_f32 v76, v108
    v_exp_f32 v77, v109
    v_cvt_pk_bf16_f32 v193, v74, v75
    v_exp_f32 v78, v110
    v_exp_f32 v79, v111
    v_cvt_pk_bf16_f32 v194, v76, v77
    v_mfma_f32_32x32x16_bf16 v[96:111], v[32:35], v[16:19], v[172:187]
    v_exp_f32 v64, v80
    v_exp_f32 v65, v81
    ds_read_b128 v[24:27], v1 offset:24576
    v_cvt_pk_bf16_f32 v195, v78, v79
    v_exp_f32 v66, v82
    v_exp_f32 v67, v83
    v_mfma_f32_32x32x16_bf16 v[96:111], v[36:39], v[20:23], v[96:111]
    ds_read_b128 v[28:31], v1 offset:25600
    v_cvt_pk_bf16_f32 v56, v64, v65
    v_exp_f32 v68, v84
    v_exp_f32 v69, v85
    v_cvt_pk_bf16_f32 v57, v66, v67
    v_mfma_f32_16x16x32_bf16 v[148:151], v[152:155], v[188:191], v[148:151]
    v_exp_f32 v70, v86
    v_mfma_f32_32x32x16_bf16 v[128:143], v[40:43], v[188:191], v[128:143]
    v_exp_f32 v71, v87
    v_cvt_pk_bf16_f32 v58, v68, v69
    v_exp_f32 v72, v88
    v_exp_f32 v73, v89
    v_mfma_f32_16x16x32_bf16 v[148:151], v[152:155], v[192:195], v[148:151]
    v_cvt_pk_bf16_f32 v59, v70, v71
    v_exp_f32 v74, v90
    v_mfma_f32_32x32x16_bf16 v[128:143], v[44:47], v[192:195], v[128:143]
    v_exp_f32 v75, v91
    v_cvt_pk_bf16_f32 v60, v72, v73
    v_exp_f32 v76, v92
    v_exp_f32 v77, v93
    v_cvt_pk_bf16_f32 v61, v74, v75
    v_exp_f32 v78, v94
    v_exp_f32 v79, v95
    v_cvt_pk_bf16_f32 v62, v76, v77
    s_waitcnt lgkmcnt(0)
    v_mfma_f32_32x32x16_bf16 v[80:95], v[24:27], v[8:11], v[156:171]
    v_exp_f32 v64, v96
    v_exp_f32 v65, v97
    v_cvt_pk_bf16_f32 v63, v78, v79
    v_exp_f32 v66, v98
    v_exp_f32 v67, v99
    v_mfma_f32_32x32x16_bf16 v[80:95], v[28:31], v[12:15], v[80:95]
    v_cvt_pk_bf16_f32 v188, v64, v65
    v_exp_f32 v68, v100
    v_exp_f32 v69, v101
    v_cvt_pk_bf16_f32 v189, v66, v67
    v_mfma_f32_16x16x32_bf16 v[144:147], v[152:155], v[56:59], v[144:147]
    ds_read_b128 v[40:43], v1 offset:26624
    v_exp_f32 v70, v102
    v_mfma_f32_32x32x16_bf16 v[112:127], v[48:51], v[56:59], v[112:127]
    ds_read_b128 v[44:47], v1 offset:27648
    v_exp_f32 v71, v103
    v_cvt_pk_bf16_f32 v190, v68, v69
    v_exp_f32 v72, v104
    v_exp_f32 v73, v105
    v_mfma_f32_16x16x32_bf16 v[144:147], v[152:155], v[60:63], v[144:147]
    v_cvt_pk_bf16_f32 v191, v70, v71
    v_exp_f32 v74, v106
    v_mfma_f32_32x32x16_bf16 v[112:127], v[52:55], v[60:63], v[112:127]
    v_exp_f32 v75, v107
    v_cvt_pk_bf16_f32 v192, v72, v73
    v_exp_f32 v76, v108
    v_exp_f32 v77, v109
    v_cvt_pk_bf16_f32 v193, v74, v75
    v_exp_f32 v78, v110
    v_exp_f32 v79, v111
    v_cvt_pk_bf16_f32 v194, v76, v77
    v_mfma_f32_32x32x16_bf16 v[96:111], v[24:27], v[16:19], v[172:187]
    v_exp_f32 v64, v80
    v_exp_f32 v65, v81
    ds_read_b128 v[32:35], v1 offset:28672
    v_cvt_pk_bf16_f32 v195, v78, v79
    v_exp_f32 v66, v82
    v_exp_f32 v67, v83
    v_mfma_f32_32x32x16_bf16 v[96:111], v[28:31], v[20:23], v[96:111]
    ds_read_b128 v[36:39], v1 offset:29696
    v_cvt_pk_bf16_f32 v56, v64, v65
    v_exp_f32 v68, v84
    v_exp_f32 v69, v85
    v_cvt_pk_bf16_f32 v57, v66, v67
    v_mfma_f32_16x16x32_bf16 v[148:151], v[152:155], v[188:191], v[148:151]
    v_exp_f32 v70, v86
    v_mfma_f32_32x32x16_bf16 v[128:143], v[48:51], v[188:191], v[128:143]
    v_exp_f32 v71, v87
    v_cvt_pk_bf16_f32 v58, v68, v69
    v_exp_f32 v72, v88
    v_exp_f32 v73, v89
    v_mfma_f32_16x16x32_bf16 v[148:151], v[152:155], v[192:195], v[148:151]
    v_cvt_pk_bf16_f32 v59, v70, v71
    v_exp_f32 v74, v90
    v_mfma_f32_32x32x16_bf16 v[128:143], v[52:55], v[192:195], v[128:143]
    v_exp_f32 v75, v91
    v_cvt_pk_bf16_f32 v60, v72, v73
    v_exp_f32 v76, v92
    v_exp_f32 v77, v93
    v_cvt_pk_bf16_f32 v61, v74, v75
    v_exp_f32 v78, v94
    v_exp_f32 v79, v95
    v_cvt_pk_bf16_f32 v62, v76, v77
    s_waitcnt lgkmcnt(0)
    v_mfma_f32_32x32x16_bf16 v[80:95], v[32:35], v[8:11], v[156:171]
    v_exp_f32 v64, v96
    v_exp_f32 v65, v97
    v_cvt_pk_bf16_f32 v63, v78, v79
    v_exp_f32 v66, v98
    v_exp_f32 v67, v99
    v_mfma_f32_32x32x16_bf16 v[80:95], v[36:39], v[12:15], v[80:95]
    v_cvt_pk_bf16_f32 v188, v64, v65
    v_exp_f32 v68, v100
    v_exp_f32 v69, v101
    v_cvt_pk_bf16_f32 v189, v66, v67
    v_mfma_f32_16x16x32_bf16 v[144:147], v[152:155], v[56:59], v[144:147]
    ds_read_b128 v[48:51], v1 offset:30720
    v_exp_f32 v70, v102
    v_mfma_f32_32x32x16_bf16 v[112:127], v[40:43], v[56:59], v[112:127]
    ds_read_b128 v[52:55], v1 offset:31744
    v_exp_f32 v71, v103
    v_cvt_pk_bf16_f32 v190, v68, v69
    v_exp_f32 v72, v104
    v_exp_f32 v73, v105
    v_mfma_f32_16x16x32_bf16 v[144:147], v[152:155], v[60:63], v[144:147]
    v_cvt_pk_bf16_f32 v191, v70, v71
    v_exp_f32 v74, v106
    s_waitcnt vmcnt(5)
    v_mfma_f32_32x32x16_bf16 v[112:127], v[44:47], v[60:63], v[112:127]
    s_barrier
    v_exp_f32 v75, v107
    s_add_u32 m0, s20, 0
    v_cvt_pk_bf16_f32 v192, v72, v73
    v_exp_f32 v76, v108
    v_exp_f32 v77, v109
    buffer_load_dwordx4 v196, s[8:11], s21 offen offset:0 lds
    v_cvt_pk_bf16_f32 v193, v74, v75
    buffer_load_dwordx4 v197, s[8:11], s21 offen offset:1024 lds
    v_exp_f32 v78, v110
    buffer_load_dwordx4 v198, s[8:11], s21 offen offset:2048 lds
    v_exp_f32 v79, v111
    buffer_load_dwordx4 v199, s[8:11], s21 offen offset:3072 lds
    s_add_u32 s21, s21, s23
    v_cvt_pk_bf16_f32 v194, v76, v77
    v_mfma_f32_32x32x16_bf16 v[96:111], v[32:35], v[16:19], v[172:187]
    v_exp_f32 v64, v80
    v_exp_f32 v65, v81
    ds_read_b128 v[24:27], v1 offset:32768
    v_cvt_pk_bf16_f32 v195, v78, v79
    v_exp_f32 v66, v82
    v_exp_f32 v67, v83
    v_mfma_f32_32x32x16_bf16 v[96:111], v[36:39], v[20:23], v[96:111]
    ds_read_b128 v[28:31], v1 offset:33792
    v_cvt_pk_bf16_f32 v56, v64, v65
    v_exp_f32 v68, v84
    v_exp_f32 v69, v85
    v_cvt_pk_bf16_f32 v57, v66, v67
    v_mfma_f32_16x16x32_bf16 v[148:151], v[152:155], v[188:191], v[148:151]
    v_exp_f32 v70, v86
    v_mfma_f32_32x32x16_bf16 v[128:143], v[40:43], v[188:191], v[128:143]
    v_exp_f32 v71, v87
    v_cvt_pk_bf16_f32 v58, v68, v69
    v_exp_f32 v72, v88
    v_exp_f32 v73, v89
    v_mfma_f32_16x16x32_bf16 v[148:151], v[152:155], v[192:195], v[148:151]
    v_cvt_pk_bf16_f32 v59, v70, v71
    v_exp_f32 v74, v90
    v_mfma_f32_32x32x16_bf16 v[128:143], v[44:47], v[192:195], v[128:143]
    v_exp_f32 v75, v91
    v_cvt_pk_bf16_f32 v60, v72, v73
    v_exp_f32 v76, v92
    v_exp_f32 v77, v93
    v_cvt_pk_bf16_f32 v61, v74, v75
    v_exp_f32 v78, v94
    v_exp_f32 v79, v95
    v_cvt_pk_bf16_f32 v62, v76, v77
    s_waitcnt lgkmcnt(0)
    v_mfma_f32_32x32x16_bf16 v[80:95], v[24:27], v[8:11], v[156:171]
    v_exp_f32 v64, v96
    v_exp_f32 v65, v97
    v_cvt_pk_bf16_f32 v63, v78, v79
    v_exp_f32 v66, v98
    v_exp_f32 v67, v99
    v_mfma_f32_32x32x16_bf16 v[80:95], v[28:31], v[12:15], v[80:95]
    v_cvt_pk_bf16_f32 v188, v64, v65
    v_exp_f32 v68, v100
    v_exp_f32 v69, v101
    v_cvt_pk_bf16_f32 v189, v66, v67
    v_mfma_f32_16x16x32_bf16 v[144:147], v[152:155], v[56:59], v[144:147]
    ds_read_b128 v[40:43], v1 offset:34816
    v_exp_f32 v70, v102
    v_mfma_f32_32x32x16_bf16 v[112:127], v[48:51], v[56:59], v[112:127]
    ds_read_b128 v[44:47], v1 offset:35840
    v_exp_f32 v71, v103
    v_cvt_pk_bf16_f32 v190, v68, v69
    v_exp_f32 v72, v104
    v_exp_f32 v73, v105
    v_mfma_f32_16x16x32_bf16 v[144:147], v[152:155], v[60:63], v[144:147]
    v_cvt_pk_bf16_f32 v191, v70, v71
    v_exp_f32 v74, v106
    v_mfma_f32_32x32x16_bf16 v[112:127], v[52:55], v[60:63], v[112:127]
    v_exp_f32 v75, v107
    v_cvt_pk_bf16_f32 v192, v72, v73
    v_exp_f32 v76, v108
    v_exp_f32 v77, v109
    v_cvt_pk_bf16_f32 v193, v74, v75
    v_exp_f32 v78, v110
    v_exp_f32 v79, v111
    v_cvt_pk_bf16_f32 v194, v76, v77
    v_mfma_f32_32x32x16_bf16 v[96:111], v[24:27], v[16:19], v[172:187]
    v_exp_f32 v64, v80
    v_exp_f32 v65, v81
    ds_read_b128 v[32:35], v1 offset:36864
    v_cvt_pk_bf16_f32 v195, v78, v79
    v_exp_f32 v66, v82
    v_exp_f32 v67, v83
    v_mfma_f32_32x32x16_bf16 v[96:111], v[28:31], v[20:23], v[96:111]
    ds_read_b128 v[36:39], v1 offset:37888
    v_cvt_pk_bf16_f32 v56, v64, v65
    v_exp_f32 v68, v84
    v_exp_f32 v69, v85
    v_cvt_pk_bf16_f32 v57, v66, v67
    v_mfma_f32_16x16x32_bf16 v[148:151], v[152:155], v[188:191], v[148:151]
    v_exp_f32 v70, v86
    v_mfma_f32_32x32x16_bf16 v[128:143], v[48:51], v[188:191], v[128:143]
    v_exp_f32 v71, v87
    v_cvt_pk_bf16_f32 v58, v68, v69
    v_exp_f32 v72, v88
    v_exp_f32 v73, v89
    v_mfma_f32_16x16x32_bf16 v[148:151], v[152:155], v[192:195], v[148:151]
    v_cvt_pk_bf16_f32 v59, v70, v71
    v_exp_f32 v74, v90
    v_mfma_f32_32x32x16_bf16 v[128:143], v[52:55], v[192:195], v[128:143]
    v_exp_f32 v75, v91
    v_cvt_pk_bf16_f32 v60, v72, v73
    v_exp_f32 v76, v92
    v_exp_f32 v77, v93
    v_cvt_pk_bf16_f32 v61, v74, v75
    v_exp_f32 v78, v94
    v_exp_f32 v79, v95
    v_cvt_pk_bf16_f32 v62, v76, v77
    s_waitcnt lgkmcnt(0)
    v_mfma_f32_32x32x16_bf16 v[80:95], v[32:35], v[8:11], v[156:171]
    v_exp_f32 v64, v96
    v_exp_f32 v65, v97
    v_cvt_pk_bf16_f32 v63, v78, v79
    v_exp_f32 v66, v98
    v_exp_f32 v67, v99
    v_mfma_f32_32x32x16_bf16 v[80:95], v[36:39], v[12:15], v[80:95]
    v_cvt_pk_bf16_f32 v188, v64, v65
    v_exp_f32 v68, v100
    v_exp_f32 v69, v101
    v_cvt_pk_bf16_f32 v189, v66, v67
    v_mfma_f32_16x16x32_bf16 v[144:147], v[152:155], v[56:59], v[144:147]
    ds_read_b128 v[48:51], v1 offset:38912
    v_exp_f32 v70, v102
    v_mfma_f32_32x32x16_bf16 v[112:127], v[40:43], v[56:59], v[112:127]
    ds_read_b128 v[52:55], v1 offset:39936
    v_exp_f32 v71, v103
    v_cvt_pk_bf16_f32 v190, v68, v69
    v_exp_f32 v72, v104
    v_exp_f32 v73, v105
    v_mfma_f32_16x16x32_bf16 v[144:147], v[152:155], v[60:63], v[144:147]
    v_cvt_pk_bf16_f32 v191, v70, v71
    v_exp_f32 v74, v106
    v_mfma_f32_32x32x16_bf16 v[112:127], v[44:47], v[60:63], v[112:127]
    v_exp_f32 v75, v107
    v_cvt_pk_bf16_f32 v192, v72, v73
    v_exp_f32 v76, v108
    v_exp_f32 v77, v109
    v_cvt_pk_bf16_f32 v193, v74, v75
    v_exp_f32 v78, v110
    v_exp_f32 v79, v111
    v_cvt_pk_bf16_f32 v194, v76, v77
    v_mfma_f32_32x32x16_bf16 v[96:111], v[32:35], v[16:19], v[172:187]
    v_exp_f32 v64, v80
    v_exp_f32 v65, v81
    ds_read_b128 v[24:27], v1 offset:40960
    v_cvt_pk_bf16_f32 v195, v78, v79
    v_exp_f32 v66, v82
    v_exp_f32 v67, v83
    v_mfma_f32_32x32x16_bf16 v[96:111], v[36:39], v[20:23], v[96:111]
    ds_read_b128 v[28:31], v1 offset:41984
    v_cvt_pk_bf16_f32 v56, v64, v65
    v_exp_f32 v68, v84
    v_exp_f32 v69, v85
    v_cvt_pk_bf16_f32 v57, v66, v67
    v_mfma_f32_16x16x32_bf16 v[148:151], v[152:155], v[188:191], v[148:151]
    v_exp_f32 v70, v86
    v_mfma_f32_32x32x16_bf16 v[128:143], v[40:43], v[188:191], v[128:143]
    v_exp_f32 v71, v87
    v_cvt_pk_bf16_f32 v58, v68, v69
    v_exp_f32 v72, v88
    v_exp_f32 v73, v89
    v_mfma_f32_16x16x32_bf16 v[148:151], v[152:155], v[192:195], v[148:151]
    v_cvt_pk_bf16_f32 v59, v70, v71
    v_exp_f32 v74, v90
    v_mfma_f32_32x32x16_bf16 v[128:143], v[44:47], v[192:195], v[128:143]
    v_exp_f32 v75, v91
    v_cvt_pk_bf16_f32 v60, v72, v73
    v_exp_f32 v76, v92
    v_exp_f32 v77, v93
    v_cvt_pk_bf16_f32 v61, v74, v75
    v_exp_f32 v78, v94
    v_exp_f32 v79, v95
    v_cvt_pk_bf16_f32 v62, v76, v77
    s_waitcnt lgkmcnt(0)
    v_mfma_f32_32x32x16_bf16 v[80:95], v[24:27], v[8:11], v[156:171]
    v_exp_f32 v64, v96
    v_exp_f32 v65, v97
    v_cvt_pk_bf16_f32 v63, v78, v79
    v_exp_f32 v66, v98
    v_exp_f32 v67, v99
    v_mfma_f32_32x32x16_bf16 v[80:95], v[28:31], v[12:15], v[80:95]
    v_cvt_pk_bf16_f32 v188, v64, v65
    v_exp_f32 v68, v100
    v_exp_f32 v69, v101
    v_cvt_pk_bf16_f32 v189, v66, v67
    v_mfma_f32_16x16x32_bf16 v[144:147], v[152:155], v[56:59], v[144:147]
    ds_read_b128 v[40:43], v1 offset:43008
    v_exp_f32 v70, v102
    v_mfma_f32_32x32x16_bf16 v[112:127], v[48:51], v[56:59], v[112:127]
    ds_read_b128 v[44:47], v1 offset:44032
    v_exp_f32 v71, v103
    v_cvt_pk_bf16_f32 v190, v68, v69
    v_exp_f32 v72, v104
    v_exp_f32 v73, v105
    v_mfma_f32_16x16x32_bf16 v[144:147], v[152:155], v[60:63], v[144:147]
    v_cvt_pk_bf16_f32 v191, v70, v71
    v_exp_f32 v74, v106
    v_mfma_f32_32x32x16_bf16 v[112:127], v[52:55], v[60:63], v[112:127]
    v_exp_f32 v75, v107
    v_cvt_pk_bf16_f32 v192, v72, v73
    v_exp_f32 v76, v108
    v_exp_f32 v77, v109
    v_cvt_pk_bf16_f32 v193, v74, v75
    v_exp_f32 v78, v110
    v_exp_f32 v79, v111
    v_cvt_pk_bf16_f32 v194, v76, v77
    v_mfma_f32_32x32x16_bf16 v[96:111], v[24:27], v[16:19], v[172:187]
    v_exp_f32 v64, v80
    v_exp_f32 v65, v81
    ds_read_b128 v[32:35], v1 offset:45056
    v_cvt_pk_bf16_f32 v195, v78, v79
    v_exp_f32 v66, v82
    v_exp_f32 v67, v83
    v_mfma_f32_32x32x16_bf16 v[96:111], v[28:31], v[20:23], v[96:111]
    ds_read_b128 v[36:39], v1 offset:46080
    v_cvt_pk_bf16_f32 v56, v64, v65
    v_exp_f32 v68, v84
    v_exp_f32 v69, v85
    v_cvt_pk_bf16_f32 v57, v66, v67
    v_mfma_f32_16x16x32_bf16 v[148:151], v[152:155], v[188:191], v[148:151]
    v_exp_f32 v70, v86
    v_mfma_f32_32x32x16_bf16 v[128:143], v[48:51], v[188:191], v[128:143]
    v_exp_f32 v71, v87
    v_cvt_pk_bf16_f32 v58, v68, v69
    v_exp_f32 v72, v88
    v_exp_f32 v73, v89
    v_mfma_f32_16x16x32_bf16 v[148:151], v[152:155], v[192:195], v[148:151]
    v_cvt_pk_bf16_f32 v59, v70, v71
    v_exp_f32 v74, v90
    v_mfma_f32_32x32x16_bf16 v[128:143], v[52:55], v[192:195], v[128:143]
    v_exp_f32 v75, v91
    v_cvt_pk_bf16_f32 v60, v72, v73
    v_exp_f32 v76, v92
    v_exp_f32 v77, v93
    v_cvt_pk_bf16_f32 v61, v74, v75
    v_exp_f32 v78, v94
    v_exp_f32 v79, v95
    v_cvt_pk_bf16_f32 v62, v76, v77
    s_waitcnt lgkmcnt(0)
    v_mfma_f32_32x32x16_bf16 v[80:95], v[32:35], v[8:11], v[156:171]
    v_exp_f32 v64, v96
    v_exp_f32 v65, v97
    v_cvt_pk_bf16_f32 v63, v78, v79
    v_exp_f32 v66, v98
    v_exp_f32 v67, v99
    v_mfma_f32_32x32x16_bf16 v[80:95], v[36:39], v[12:15], v[80:95]
    v_cvt_pk_bf16_f32 v188, v64, v65
    v_exp_f32 v68, v100
    v_exp_f32 v69, v101
    v_cvt_pk_bf16_f32 v189, v66, v67
    v_mfma_f32_16x16x32_bf16 v[144:147], v[152:155], v[56:59], v[144:147]
    ds_read_b128 v[48:51], v1 offset:47104
    v_exp_f32 v70, v102
    v_mfma_f32_32x32x16_bf16 v[112:127], v[40:43], v[56:59], v[112:127]
    ds_read_b128 v[52:55], v1 offset:48128
    v_exp_f32 v71, v103
    v_cvt_pk_bf16_f32 v190, v68, v69
    v_exp_f32 v72, v104
    v_exp_f32 v73, v105
    v_mfma_f32_16x16x32_bf16 v[144:147], v[152:155], v[60:63], v[144:147]
    v_cvt_pk_bf16_f32 v191, v70, v71
    v_exp_f32 v74, v106
    s_waitcnt vmcnt(5)
    v_mfma_f32_32x32x16_bf16 v[112:127], v[44:47], v[60:63], v[112:127]
    s_barrier
    v_exp_f32 v75, v107
    s_add_u32 m0, s20, 16384
    v_cvt_pk_bf16_f32 v192, v72, v73
    v_exp_f32 v76, v108
    v_exp_f32 v77, v109
    buffer_load_dwordx4 v196, s[8:11], s21 offen offset:0 lds
    v_cvt_pk_bf16_f32 v193, v74, v75
    buffer_load_dwordx4 v197, s[8:11], s21 offen offset:1024 lds
    v_exp_f32 v78, v110
    buffer_load_dwordx4 v198, s[8:11], s21 offen offset:2048 lds
    v_exp_f32 v79, v111
    buffer_load_dwordx4 v199, s[8:11], s21 offen offset:3072 lds
    s_add_u32 s21, s21, s23
    v_cvt_pk_bf16_f32 v194, v76, v77
    v_mfma_f32_32x32x16_bf16 v[96:111], v[32:35], v[16:19], v[172:187]
    v_exp_f32 v64, v80
    v_exp_f32 v65, v81
    ds_read_b128 v[24:27], v1 offset:49152
    v_cvt_pk_bf16_f32 v195, v78, v79
    v_exp_f32 v66, v82
    v_exp_f32 v67, v83
    v_mfma_f32_32x32x16_bf16 v[96:111], v[36:39], v[20:23], v[96:111]
    ds_read_b128 v[28:31], v1 offset:50176
    v_cvt_pk_bf16_f32 v56, v64, v65
    v_exp_f32 v68, v84
    v_exp_f32 v69, v85
    v_cvt_pk_bf16_f32 v57, v66, v67
    v_mfma_f32_16x16x32_bf16 v[148:151], v[152:155], v[188:191], v[148:151]
    v_exp_f32 v70, v86
    v_mfma_f32_32x32x16_bf16 v[128:143], v[40:43], v[188:191], v[128:143]
    v_exp_f32 v71, v87
    v_cvt_pk_bf16_f32 v58, v68, v69
    v_exp_f32 v72, v88
    v_exp_f32 v73, v89
    v_mfma_f32_16x16x32_bf16 v[148:151], v[152:155], v[192:195], v[148:151]
    v_cvt_pk_bf16_f32 v59, v70, v71
    v_exp_f32 v74, v90
    v_mfma_f32_32x32x16_bf16 v[128:143], v[44:47], v[192:195], v[128:143]
    v_exp_f32 v75, v91
    v_cvt_pk_bf16_f32 v60, v72, v73
    v_exp_f32 v76, v92
    v_exp_f32 v77, v93
    v_cvt_pk_bf16_f32 v61, v74, v75
    v_exp_f32 v78, v94
    v_exp_f32 v79, v95
    v_cvt_pk_bf16_f32 v62, v76, v77
    s_waitcnt lgkmcnt(0)
    v_mfma_f32_32x32x16_bf16 v[80:95], v[24:27], v[8:11], v[156:171]
    v_exp_f32 v64, v96
    v_exp_f32 v65, v97
    v_cvt_pk_bf16_f32 v63, v78, v79
    v_exp_f32 v66, v98
    v_exp_f32 v67, v99
    v_mfma_f32_32x32x16_bf16 v[80:95], v[28:31], v[12:15], v[80:95]
    v_cvt_pk_bf16_f32 v188, v64, v65
    v_exp_f32 v68, v100
    v_exp_f32 v69, v101
    v_cvt_pk_bf16_f32 v189, v66, v67
    v_mfma_f32_16x16x32_bf16 v[144:147], v[152:155], v[56:59], v[144:147]
    ds_read_b128 v[40:43], v1 offset:51200
    v_exp_f32 v70, v102
    v_mfma_f32_32x32x16_bf16 v[112:127], v[48:51], v[56:59], v[112:127]
    ds_read_b128 v[44:47], v1 offset:52224
    v_exp_f32 v71, v103
    v_cvt_pk_bf16_f32 v190, v68, v69
    v_exp_f32 v72, v104
    v_exp_f32 v73, v105
    v_mfma_f32_16x16x32_bf16 v[144:147], v[152:155], v[60:63], v[144:147]
    v_cvt_pk_bf16_f32 v191, v70, v71
    v_exp_f32 v74, v106
    v_mfma_f32_32x32x16_bf16 v[112:127], v[52:55], v[60:63], v[112:127]
    v_exp_f32 v75, v107
    v_cvt_pk_bf16_f32 v192, v72, v73
    v_exp_f32 v76, v108
    v_exp_f32 v77, v109
    v_cvt_pk_bf16_f32 v193, v74, v75
    v_exp_f32 v78, v110
    v_exp_f32 v79, v111
    v_cvt_pk_bf16_f32 v194, v76, v77
    v_mfma_f32_32x32x16_bf16 v[96:111], v[24:27], v[16:19], v[172:187]
    v_exp_f32 v64, v80
    v_exp_f32 v65, v81
    ds_read_b128 v[32:35], v1 offset:53248
    v_cvt_pk_bf16_f32 v195, v78, v79
    v_exp_f32 v66, v82
    v_exp_f32 v67, v83
    v_mfma_f32_32x32x16_bf16 v[96:111], v[28:31], v[20:23], v[96:111]
    ds_read_b128 v[36:39], v1 offset:54272
    v_cvt_pk_bf16_f32 v56, v64, v65
    v_exp_f32 v68, v84
    v_exp_f32 v69, v85
    v_cvt_pk_bf16_f32 v57, v66, v67
    v_mfma_f32_16x16x32_bf16 v[148:151], v[152:155], v[188:191], v[148:151]
    v_exp_f32 v70, v86
    v_mfma_f32_32x32x16_bf16 v[128:143], v[48:51], v[188:191], v[128:143]
    v_exp_f32 v71, v87
    v_cvt_pk_bf16_f32 v58, v68, v69
    v_exp_f32 v72, v88
    v_exp_f32 v73, v89
    v_mfma_f32_16x16x32_bf16 v[148:151], v[152:155], v[192:195], v[148:151]
    v_cvt_pk_bf16_f32 v59, v70, v71
    v_exp_f32 v74, v90
    v_mfma_f32_32x32x16_bf16 v[128:143], v[52:55], v[192:195], v[128:143]
    v_exp_f32 v75, v91
    v_cvt_pk_bf16_f32 v60, v72, v73
    v_exp_f32 v76, v92
    v_exp_f32 v77, v93
    v_cvt_pk_bf16_f32 v61, v74, v75
    v_exp_f32 v78, v94
    v_exp_f32 v79, v95
    v_cvt_pk_bf16_f32 v62, v76, v77
    s_waitcnt lgkmcnt(0)
    v_mfma_f32_32x32x16_bf16 v[80:95], v[32:35], v[8:11], v[156:171]
    v_exp_f32 v64, v96
    v_exp_f32 v65, v97
    v_cvt_pk_bf16_f32 v63, v78, v79
    v_exp_f32 v66, v98
    v_exp_f32 v67, v99
    v_mfma_f32_32x32x16_bf16 v[80:95], v[36:39], v[12:15], v[80:95]
    v_cvt_pk_bf16_f32 v188, v64, v65
    v_exp_f32 v68, v100
    v_exp_f32 v69, v101
    v_cvt_pk_bf16_f32 v189, v66, v67
    v_mfma_f32_16x16x32_bf16 v[144:147], v[152:155], v[56:59], v[144:147]
    ds_read_b128 v[48:51], v1 offset:55296
    v_exp_f32 v70, v102
    v_mfma_f32_32x32x16_bf16 v[112:127], v[40:43], v[56:59], v[112:127]
    ds_read_b128 v[52:55], v1 offset:56320
    v_exp_f32 v71, v103
    v_cvt_pk_bf16_f32 v190, v68, v69
    v_exp_f32 v72, v104
    v_exp_f32 v73, v105
    v_mfma_f32_16x16x32_bf16 v[144:147], v[152:155], v[60:63], v[144:147]
    v_cvt_pk_bf16_f32 v191, v70, v71
    v_exp_f32 v74, v106
    v_mfma_f32_32x32x16_bf16 v[112:127], v[44:47], v[60:63], v[112:127]
    v_exp_f32 v75, v107
    v_cvt_pk_bf16_f32 v192, v72, v73
    v_exp_f32 v76, v108
    v_exp_f32 v77, v109
    v_cvt_pk_bf16_f32 v193, v74, v75
    v_exp_f32 v78, v110
    v_exp_f32 v79, v111
    v_cvt_pk_bf16_f32 v194, v76, v77
    v_mfma_f32_32x32x16_bf16 v[96:111], v[32:35], v[16:19], v[172:187]
    v_exp_f32 v64, v80
    v_exp_f32 v65, v81
    ds_read_b128 v[24:27], v1 offset:57344
    v_cvt_pk_bf16_f32 v195, v78, v79
    v_exp_f32 v66, v82
    v_exp_f32 v67, v83
    v_mfma_f32_32x32x16_bf16 v[96:111], v[36:39], v[20:23], v[96:111]
    ds_read_b128 v[28:31], v1 offset:58368
    v_cvt_pk_bf16_f32 v56, v64, v65
    v_exp_f32 v68, v84
    v_exp_f32 v69, v85
    v_cvt_pk_bf16_f32 v57, v66, v67
    v_mfma_f32_16x16x32_bf16 v[148:151], v[152:155], v[188:191], v[148:151]
    v_exp_f32 v70, v86
    v_mfma_f32_32x32x16_bf16 v[128:143], v[40:43], v[188:191], v[128:143]
    v_exp_f32 v71, v87
    v_cvt_pk_bf16_f32 v58, v68, v69
    v_exp_f32 v72, v88
    v_exp_f32 v73, v89
    v_mfma_f32_16x16x32_bf16 v[148:151], v[152:155], v[192:195], v[148:151]
    v_cvt_pk_bf16_f32 v59, v70, v71
    v_exp_f32 v74, v90
    v_mfma_f32_32x32x16_bf16 v[128:143], v[44:47], v[192:195], v[128:143]
    v_exp_f32 v75, v91
    v_cvt_pk_bf16_f32 v60, v72, v73
    v_exp_f32 v76, v92
    v_exp_f32 v77, v93
    v_cvt_pk_bf16_f32 v61, v74, v75
    v_exp_f32 v78, v94
    v_exp_f32 v79, v95
    v_cvt_pk_bf16_f32 v62, v76, v77
    s_waitcnt lgkmcnt(0)
    v_mfma_f32_32x32x16_bf16 v[80:95], v[24:27], v[8:11], v[156:171]
    v_exp_f32 v64, v96
    v_exp_f32 v65, v97
    v_cvt_pk_bf16_f32 v63, v78, v79
    v_exp_f32 v66, v98
    v_exp_f32 v67, v99
    v_mfma_f32_32x32x16_bf16 v[80:95], v[28:31], v[12:15], v[80:95]
    v_cvt_pk_bf16_f32 v188, v64, v65
    v_exp_f32 v68, v100
    v_exp_f32 v69, v101
    v_cvt_pk_bf16_f32 v189, v66, v67
    v_mfma_f32_16x16x32_bf16 v[144:147], v[152:155], v[56:59], v[144:147]
    ds_read_b128 v[40:43], v1 offset:59392
    v_exp_f32 v70, v102
    v_mfma_f32_32x32x16_bf16 v[112:127], v[48:51], v[56:59], v[112:127]
    ds_read_b128 v[44:47], v1 offset:60416
    v_exp_f32 v71, v103
    v_cvt_pk_bf16_f32 v190, v68, v69
    v_exp_f32 v72, v104
    v_exp_f32 v73, v105
    v_mfma_f32_16x16x32_bf16 v[144:147], v[152:155], v[60:63], v[144:147]
    v_cvt_pk_bf16_f32 v191, v70, v71
    v_exp_f32 v74, v106
    v_mfma_f32_32x32x16_bf16 v[112:127], v[52:55], v[60:63], v[112:127]
    v_exp_f32 v75, v107
    v_cvt_pk_bf16_f32 v192, v72, v73
    v_exp_f32 v76, v108
    v_exp_f32 v77, v109
    v_cvt_pk_bf16_f32 v193, v74, v75
    v_exp_f32 v78, v110
    v_exp_f32 v79, v111
    v_cvt_pk_bf16_f32 v194, v76, v77
    v_mfma_f32_32x32x16_bf16 v[96:111], v[24:27], v[16:19], v[172:187]
    v_exp_f32 v64, v80
    v_exp_f32 v65, v81
    ds_read_b128 v[32:35], v1 offset:61440
    v_cvt_pk_bf16_f32 v195, v78, v79
    v_exp_f32 v66, v82
    v_exp_f32 v67, v83
    v_mfma_f32_32x32x16_bf16 v[96:111], v[28:31], v[20:23], v[96:111]
    ds_read_b128 v[36:39], v1 offset:62464
    v_cvt_pk_bf16_f32 v56, v64, v65
    v_exp_f32 v68, v84
    v_exp_f32 v69, v85
    v_cvt_pk_bf16_f32 v57, v66, v67
    v_mfma_f32_16x16x32_bf16 v[148:151], v[152:155], v[188:191], v[148:151]
    v_exp_f32 v70, v86
    v_mfma_f32_32x32x16_bf16 v[128:143], v[48:51], v[188:191], v[128:143]
    v_exp_f32 v71, v87
    v_cvt_pk_bf16_f32 v58, v68, v69
    v_exp_f32 v72, v88
    v_exp_f32 v73, v89
    v_mfma_f32_16x16x32_bf16 v[148:151], v[152:155], v[192:195], v[148:151]
    v_cvt_pk_bf16_f32 v59, v70, v71
    v_exp_f32 v74, v90
    v_mfma_f32_32x32x16_bf16 v[128:143], v[52:55], v[192:195], v[128:143]
    v_exp_f32 v75, v91
    v_cvt_pk_bf16_f32 v60, v72, v73
    v_exp_f32 v76, v92
    v_exp_f32 v77, v93
    v_cvt_pk_bf16_f32 v61, v74, v75
    v_exp_f32 v78, v94
    v_exp_f32 v79, v95
    v_cvt_pk_bf16_f32 v62, v76, v77
    s_waitcnt lgkmcnt(0)
    v_mfma_f32_32x32x16_bf16 v[80:95], v[32:35], v[8:11], v[156:171]
    v_exp_f32 v64, v96
    v_exp_f32 v65, v97
    v_cvt_pk_bf16_f32 v63, v78, v79
    v_exp_f32 v66, v98
    v_exp_f32 v67, v99
    v_mfma_f32_32x32x16_bf16 v[80:95], v[36:39], v[12:15], v[80:95]
    v_cvt_pk_bf16_f32 v188, v64, v65
    v_exp_f32 v68, v100
    v_exp_f32 v69, v101
    v_cvt_pk_bf16_f32 v189, v66, v67
    v_mfma_f32_16x16x32_bf16 v[144:147], v[152:155], v[56:59], v[144:147]
    ds_read_b128 v[48:51], v1 offset:63488
    v_exp_f32 v70, v102
    v_mfma_f32_32x32x16_bf16 v[112:127], v[40:43], v[56:59], v[112:127]
    ds_read_b128 v[52:55], v1 offset:64512
    v_exp_f32 v71, v103
    v_cvt_pk_bf16_f32 v190, v68, v69
    v_exp_f32 v72, v104
    v_exp_f32 v73, v105
    v_mfma_f32_16x16x32_bf16 v[144:147], v[152:155], v[60:63], v[144:147]
    v_cvt_pk_bf16_f32 v191, v70, v71
    v_exp_f32 v74, v106
    s_waitcnt vmcnt(4)
    v_mfma_f32_32x32x16_bf16 v[112:127], v[44:47], v[60:63], v[112:127]
    s_barrier
    v_exp_f32 v75, v107
    s_add_u32 m0, s20, 32768
    v_cvt_pk_bf16_f32 v192, v72, v73
    v_exp_f32 v76, v108
    v_exp_f32 v77, v109
    buffer_load_dwordx4 v196, s[8:11], s21 offen offset:0 lds
    v_cvt_pk_bf16_f32 v193, v74, v75
    buffer_load_dwordx4 v197, s[8:11], s21 offen offset:1024 lds
    v_exp_f32 v78, v110
    buffer_load_dwordx4 v198, s[8:11], s21 offen offset:2048 lds
    v_exp_f32 v79, v111
    buffer_load_dwordx4 v199, s[8:11], s21 offen offset:3072 lds
    s_add_u32 s21, s21, s23
    v_cvt_pk_bf16_f32 v194, v76, v77
    v_mfma_f32_32x32x16_bf16 v[96:111], v[32:35], v[16:19], v[172:187]
    v_exp_f32 v64, v80
    v_exp_f32 v65, v81
    ds_read_b128 v[24:27], v1 offset:0
    v_cvt_pk_bf16_f32 v195, v78, v79
    v_exp_f32 v66, v82
    v_exp_f32 v67, v83
    v_mfma_f32_32x32x16_bf16 v[96:111], v[36:39], v[20:23], v[96:111]
    ds_read_b128 v[28:31], v1 offset:1024
    v_cvt_pk_bf16_f32 v56, v64, v65
    v_exp_f32 v68, v84
    v_exp_f32 v69, v85
    v_cvt_pk_bf16_f32 v57, v66, v67
    v_mfma_f32_16x16x32_bf16 v[148:151], v[152:155], v[188:191], v[148:151]
    v_exp_f32 v70, v86
    v_mfma_f32_32x32x16_bf16 v[128:143], v[40:43], v[188:191], v[128:143]
    v_exp_f32 v71, v87
    v_cvt_pk_bf16_f32 v58, v68, v69
    v_exp_f32 v72, v88
    v_exp_f32 v73, v89
    v_mfma_f32_16x16x32_bf16 v[148:151], v[152:155], v[192:195], v[148:151]
    v_cvt_pk_bf16_f32 v59, v70, v71
    v_exp_f32 v74, v90
    v_mfma_f32_32x32x16_bf16 v[128:143], v[44:47], v[192:195], v[128:143]
    v_exp_f32 v75, v91
    v_cvt_pk_bf16_f32 v60, v72, v73
    v_exp_f32 v76, v92
    v_exp_f32 v77, v93
    v_cvt_pk_bf16_f32 v61, v74, v75
    v_exp_f32 v78, v94
    v_exp_f32 v79, v95
    v_cvt_pk_bf16_f32 v62, v76, v77
    s_waitcnt lgkmcnt(0)
    v_mfma_f32_32x32x16_bf16 v[80:95], v[24:27], v[8:11], v[156:171]
    v_exp_f32 v64, v96
    v_exp_f32 v65, v97
    v_cvt_pk_bf16_f32 v63, v78, v79
    v_exp_f32 v66, v98
    v_exp_f32 v67, v99
    v_mfma_f32_32x32x16_bf16 v[80:95], v[28:31], v[12:15], v[80:95]
    v_cvt_pk_bf16_f32 v188, v64, v65
    v_exp_f32 v68, v100
    v_exp_f32 v69, v101
    v_cvt_pk_bf16_f32 v189, v66, v67
    v_mfma_f32_16x16x32_bf16 v[144:147], v[152:155], v[56:59], v[144:147]
    ds_read_b128 v[40:43], v1 offset:2048
    v_exp_f32 v70, v102
    v_mfma_f32_32x32x16_bf16 v[112:127], v[48:51], v[56:59], v[112:127]
    ds_read_b128 v[44:47], v1 offset:3072
    v_exp_f32 v71, v103
    v_cvt_pk_bf16_f32 v190, v68, v69
    v_exp_f32 v72, v104
    v_exp_f32 v73, v105
    v_mfma_f32_16x16x32_bf16 v[144:147], v[152:155], v[60:63], v[144:147]
    v_cvt_pk_bf16_f32 v191, v70, v71
    v_exp_f32 v74, v106
    v_mfma_f32_32x32x16_bf16 v[112:127], v[52:55], v[60:63], v[112:127]
    v_exp_f32 v75, v107
    v_cvt_pk_bf16_f32 v192, v72, v73
    v_exp_f32 v76, v108
    v_exp_f32 v77, v109
    s_sub_u32 s22, s22, 1
    v_cvt_pk_bf16_f32 v193, v74, v75
    s_cmp_lg_u32 s22, 0
    v_exp_f32 v78, v110
    v_exp_f32 v79, v111
    v_cvt_pk_bf16_f32 v194, v76, v77
    s_cbranch_scc1 L_parallel_sum__softmax_full_mha__glu_gated_bilinear__prompt_kernel_loop
    s_nop 0
    v_cvt_pk_bf16_f32 v195, v78, v79
    s_nop 1
    v_mfma_f32_16x16x32_bf16 v[148:151], v[152:155], v[188:191], v[148:151]
    v_mfma_f32_32x32x16_bf16 v[128:143], v[48:51], v[188:191], v[128:143]
    v_mfma_f32_16x16x32_bf16 v[148:151], v[152:155], v[192:195], v[148:151]
    v_mfma_f32_32x32x16_bf16 v[128:143], v[52:55], v[192:195], v[128:143]
    s_nop 7
    s_nop 3
    v_add_f32 v4, |v112|, |v128|
    v_add_f32 v5, |v113|, |v129|
    v_add_f32 v4, v4, v5
    v_add_f32 v5, |v114|, |v130|
    v_add_f32 v4, v4, v5
    v_add_f32 v5, |v115|, |v131|
    v_add_f32 v4, v4, v5
    v_add_f32 v5, |v116|, |v132|
    v_add_f32 v4, v4, v5
    v_add_f32 v5, |v117|, |v133|
    v_add_f32 v4, v4, v5
    v_add_f32 v5, |v118|, |v134|
    v_add_f32 v4, v4, v5
    v_add_f32 v5, |v119|, |v135|
    v_add_f32 v4, v4, v5
    v_add_f32 v5, |v120|, |v136|
    v_add_f32 v4, v4, v5
    v_add_f32 v5, |v121|, |v137|
    v_add_f32 v4, v4, v5
    v_add_f32 v5, |v122|, |v138|
    v_add_f32 v4, v4, v5
    v_add_f32 v5, |v123|, |v139|
    v_add_f32 v4, v4, v5
    v_add_f32 v5, |v124|, |v140|
    v_add_f32 v4, v4, v5
    v_add_f32 v5, |v125|, |v141|
    v_add_f32 v4, v4, v5
    v_add_f32 v5, |v126|, |v142|
    v_add_f32 v4, v4, v5
    v_add_f32 v5, |v127|, |v143|
    v_add_f32 v4, v4, v5
    v_min_f32 v5, v144, v148
    v_add_f32 v6, v144, v148
    s_mov_b32 s41, 0x1f800000
    s_mov_b32 s42, 0x5f800000
    s_mov_b32 s43, 0x7f000000
    v_cmp_le_f32 s[44:45], s41, v5
    v_cmp_ge_f32 s[46:47], s42, v6
    v_cmp_gt_f32 s[48:49], s43, v4
    v_rcp_f32 v4, v144
    v_rcp_f32 v5, v148
    s_and_b64 s[44:45], s[44:45], s[46:47]
    s_and_b64 s[44:45], s[44:45], s[48:49]
    s_cmp_eq_u64 s[44:45], -1
    s_cselect_b32 s41, 0, 1
    v_mov_b32 v7, s41
    v_mov_b32 v3, 49152
    v_lshl_add_u32 v6, s33, 2, v3
    ds_write_b32 v6, v7
    v_bfe_u32 v6, v0, 4, 1
    v_lshlrev_b32 v6, 10, v6
    v_lshrrev_b32 v7, 5, v0
    v_lshl_add_u32 v6, v7, 8, v6
    v_and_b32 v7, 15, v0
    v_lshl_add_u32 v6, v7, 4, v6
    s_xor_b32 s38, s41, 1
    s_cmp_eq_u32 s40, 0
    s_cselect_b32 s39, s41, s39
    s_cselect_b32 s38, s38, s39
    s_cmp_eq_u32 s38, 0
    s_cbranch_scc1 L_parallel_sum__softmax_full_mha__glu_gated_bilinear__prompt_kernel_nopub
    v_mul_f32 v112, v4, v112
    v_mul_f32 v113, v4, v113
    v_mul_f32 v114, v4, v114
    v_mul_f32 v115, v4, v115
    v_mul_f32 v116, v4, v116
    v_mul_f32 v117, v4, v117
    v_mul_f32 v118, v4, v118
    v_mul_f32 v119, v4, v119
    v_mul_f32 v120, v4, v120
    v_mul_f32 v121, v4, v121
    v_mul_f32 v122, v4, v122
    v_mul_f32 v123, v4, v123
    v_mul_f32 v124, v4, v124
    v_mul_f32 v125, v4, v125
    v_mul_f32 v126, v4, v126
    v_mul_f32 v127, v4, v127
    v_cvt_pk_bf16_f32 v64, v112, v113
    v_cvt_pk_bf16_f32 v65, v114, v115
    v_cvt_pk_bf16_f32 v66, v120, v121
    v_cvt_pk_bf16_f32 v67, v122, v123
    buffer_store_dwordx4 v[64:67], v6, s[16:19], s36 offen offset:0 sc0 sc1
    v_cvt_pk_bf16_f32 v68, v116, v117
    v_cvt_pk_bf16_f32 v69, v118, v119
    v_cvt_pk_bf16_f32 v70, v124, v125
    v_cvt_pk_bf16_f32 v71, v126, v127
    buffer_store_dwordx4 v[68:71], v6, s[16:19], s36 offen offset:512 sc0 sc1
    v_mul_f32 v128, v5, v128
    v_mul_f32 v129, v5, v129
    v_mul_f32 v130, v5, v130
    v_mul_f32 v131, v5, v131
    v_mul_f32 v132, v5, v132
    v_mul_f32 v133, v5, v133
    v_mul_f32 v134, v5, v134
    v_mul_f32 v135, v5, v135
    v_mul_f32 v136, v5, v136
    v_mul_f32 v137, v5, v137
    v_mul_f32 v138, v5, v138
    v_mul_f32 v139, v5, v139
    v_mul_f32 v140, v5, v140
    v_mul_f32 v141, v5, v141
    v_mul_f32 v142, v5, v142
    v_mul_f32 v143, v5, v143
    v_cvt_pk_bf16_f32 v72, v128, v129
    v_cvt_pk_bf16_f32 v73, v130, v131
    v_cvt_pk_bf16_f32 v74, v136, v137
    v_cvt_pk_bf16_f32 v75, v138, v139
    buffer_store_dwordx4 v[72:75], v6, s[16:19], s36 offen offset:2048 sc0 sc1
    v_cvt_pk_bf16_f32 v76, v132, v133
    v_cvt_pk_bf16_f32 v77, v134, v135
    v_cvt_pk_bf16_f32 v78, v140, v141
    v_cvt_pk_bf16_f32 v79, v142, v143
    buffer_store_dwordx4 v[76:79], v6, s[16:19], s36 offen offset:2560 sc0 sc1
    v_mov_b32 v4, 0
    v_mov_b32 v5, 1
    s_mov_b64 exec, 1
    s_waitcnt vmcnt(0)
    buffer_store_dword v5, v4, s[24:27], s28 offen sc0 sc1
    s_mov_b64 exec, -1
L_parallel_sum__softmax_full_mha__glu_gated_bilinear__prompt_kernel_nopub:
    s_cmp_lg_u32 s40, 0
    s_cbranch_scc1 L_parallel_sum__softmax_full_mha__glu_gated_bilinear__prompt_kernel_out2
    s_waitcnt lgkmcnt(0)
    s_barrier
    v_mov_b32 v3, 49152
    ds_read_b128 v[4:7], v3
    s_waitcnt lgkmcnt(0)
    v_or3_b32 v4, v4, v5, v6
    v_or_b32 v4, v4, v7
    s_nop 0
    v_readfirstlane_b32 s41, v4
    s_cmp_eq_u32 s41, 0
    s_cbranch_scc1 L_parallel_sum__softmax_full_mha__glu_gated_bilinear__prompt_kernel_out
    s_waitcnt vmcnt(0)
    s_barrier
    s_mov_b32 s40, 1
    s_mov_b32 s21, 0
    s_add_u32 s8, s6, s35
    s_addc_u32 s9, s7, 0
    s_mov_b32 s10, 262144
    v_mov_b32 v4, 0xff800000
    v_mov_b32 v5, 0xff800000
L_parallel_sum__softmax_full_mha__glu_gated_bilinear__prompt_kernel_mx:
    buffer_load_dwordx4 v[24:27], v1, s[8:11], s21 offen
    buffer_load_dwordx4 v[28:31], v1, s[8:11], s21 offen offset:1024
    s_add_u32 s21, s21, 4096
    s_waitcnt vmcnt(0)
    v_mfma_f32_32x32x16_bf16 v[80:95], v[24:27], v[8:11], 0
    v_mfma_f32_32x32x16_bf16 v[96:111], v[24:27], v[16:19], 0
    v_mfma_f32_32x32x16_bf16 v[80:95], v[28:31], v[12:15], v[80:95]
    v_mfma_f32_32x32x16_bf16 v[96:111], v[28:31], v[20:23], v[96:111]
    s_nop 7
    s_nop 3
    v_max3_f32 v4, v4, v80, v81
    v_max3_f32 v5, v5, v96, v97
    v_max3_f32 v4, v4, v82, v83
    v_max3_f32 v5, v5, v98, v99
    v_max3_f32 v4, v4, v84, v85
    v_max3_f32 v5, v5, v100, v101
    v_max3_f32 v4, v4, v86, v87
    v_max3_f32 v5, v5, v102, v103
    v_max3_f32 v4, v4, v88, v89
    v_max3_f32 v5, v5, v104, v105
    v_max3_f32 v4, v4, v90, v91
    v_max3_f32 v5, v5, v106, v107
    v_max3_f32 v4, v4, v92, v93
    v_max3_f32 v5, v5, v108, v109
    v_max3_f32 v4, v4, v94, v95
    v_max3_f32 v5, v5, v110, v111
    s_cmp_lt_u32 s21, 262144
    s_cbranch_scc1 L_parallel_sum__softmax_full_mha__glu_gated_bilinear__prompt_kernel_mx
    v_mov_b32 v6, v4
    v_mov_b32 v7, v5
    s_nop 1
    v_permlane32_swap_b32 v4, v6
    v_permlane32_swap_b32 v5, v7
    s_nop 1
    v_max_f32 v4, v4, v6
    v_max_f32 v5, v5, v7
    v_sub_f32 v156, 0, v4
    v_sub_f32 v172, 0, v5
    v_sub_f32 v157, 0, v4
    v_sub_f32 v173, 0, v5
    v_sub_f32 v158, 0, v4
    v_sub_f32 v174, 0, v5
    v_sub_f32 v159, 0, v4
    v_sub_f32 v175, 0, v5
    v_sub_f32 v160, 0, v4
    v_sub_f32 v176, 0, v5
    v_sub_f32 v161, 0, v4
    v_sub_f32 v177, 0, v5
    v_sub_f32 v162, 0, v4
    v_sub_f32 v178, 0, v5
    v_sub_f32 v163, 0, v4
    v_sub_f32 v179, 0, v5
    v_sub_f32 v164, 0, v4
    v_sub_f32 v180, 0, v5
    v_sub_f32 v165, 0, v4
    v_sub_f32 v181, 0, v5
    v_sub_f32 v166, 0, v4
    v_sub_f32 v182, 0, v5
    v_sub_f32 v167, 0, v4
    v_sub_f32 v183, 0, v5
    v_sub_f32 v168, 0, v4
    v_sub_f32 v184, 0, v5
    v_sub_f32 v169, 0, v4
    v_sub_f32 v185, 0, v5
    v_sub_f32 v170, 0, v4
    v_sub_f32 v186, 0, v5
    v_sub_f32 v171, 0, v4
    v_sub_f32 v187, 0, v5
    s_branch L_parallel_sum__softmax_full_mha__glu_gated_bilinear__prompt_kernel_restart
L_parallel_sum__softmax_full_mha__glu_gated_bilinear__prompt_kernel_out2:
    s_waitcnt vmcnt(0)
    s_barrier
L_parallel_sum__softmax_full_mha__glu_gated_bilinear__prompt_kernel_out:
    s_waitcnt vmcnt(0)
L_parallel_sum__softmax_full_mha__glu_gated_bilinear__prompt_kernel_end:
    s_endpgm
L_parallel_sum__softmax_full_mha__glu_gated_bilinear__prompt_kernel_role2:
    s_load_dwordx2 s[4:5], s[0:1], 0
    s_load_dwordx2 s[70:71], s[0:1], 56
    s_sub_u32 s64, s33, 4
    s_and_b32 s60, s2, 7
    s_lshr_b32 s61, s2, 3
    s_lshr_b32 s62, s60, 1
    s_lshl_b32 s62, s62, 2
    s_lshr_b32 s63, s61, 3
    s_add_u32 s62, s62, s63
    s_and_b32 s60, s60, 1
    s_lshl_b32 s60, s60, 3
    s_and_b32 s61, s61, 7
    s_add_u32 s63, s60, s61
    v_lshrrev_b32 v19, 4, v0
    v_and_b32 v20, 15, v0
    v_lshlrev_b32 v13, 4, v0
    s_mul_i32 s42, s64, 24576
    s_add_u32 s42, s42, 65536
    s_lshl_b32 s44, s64, 12
    s_sub_u32 s44, s42, s44
    s_lshl_b32 s41, s64, 16
    s_add_u32 s65, s64, 32
    s_lshl_b32 s40, s65, 17
    s_lshl_b32 s65, s62, 13
    s_add_u32 s40, s40, s65
    s_lshl_b32 s66, s63, 7
    s_add_u32 s65, s64, 0
    s_and_b32 s65, s65, 3
    s_lshl_b32 s65, s65, 11
    v_add_u32 v1, s65, v13
    s_add_u32 s65, s64, 1
    s_and_b32 s65, s65, 3
    s_lshl_b32 s65, s65, 11
    v_add_u32 v2, s65, v13
    s_add_u32 s65, s64, 2
    s_and_b32 s65, s65, 3
    s_lshl_b32 s65, s65, 11
    v_add_u32 v3, s65, v13
    s_add_u32 s65, s64, 3
    s_and_b32 s65, s65, 3
    s_lshl_b32 s65, s65, 11
    v_add_u32 v4, s65, v13
    v_bfe_u32 v22, v0, 1, 2
    v_xor_b32 v22, v22, v19
    v_lshlrev_b32 v22, 5, v22
    v_and_b32 v23, 1, v0
    v_lshl_or_b32 v22, v23, 4, v22
    v_lshrrev_b32 v23, 3, v0
    v_lshl_add_u32 v5, v23, 11, v22
    v_add_u32 v6, 15360, v5
    v_add_u32 v7, 30720, v5
    v_add_u32 v8, 46080, v5
    v_lshlrev_b32 v14, 11, v20
    v_lshl_add_u32 v14, v19, 3, v14
    v_add_u32 v15, 32768, v14
    s_lshl_b32 s67, s62, 18
    s_lshl_b32 s65, s64, 16
    s_add_u32 s67, s67, s65
    s_add_u32 s67, s67, s66
    v_lshlrev_b32 v22, 2, v19
    v_lshrrev_b32 v23, 2, v20
    v_add_u32 v22, v22, v23
    v_bfe_u32 v23, v22, 1, 2
    v_lshlrev_b32 v22, 7, v22
    v_and_b32 v21, 3, v0
    v_lshl_add_u32 v22, v21, 3, v22
    v_add_u32 v22, s42, v22
    v_lshlrev_b32 v13, 2, v21
    v_add_u32 v13, 49152, v13
    v_xor_b32 v21, 0, v23
    v_lshl_add_u32 v9, v21, 5, v22
    v_xor_b32 v21, 1, v23
    v_lshl_add_u32 v10, v21, 5, v22
    v_xor_b32 v21, 2, v23
    v_lshl_add_u32 v11, v21, 5, v22
    v_xor_b32 v21, 3, v23
    v_lshl_add_u32 v12, v21, 5, v22
    s_waitcnt lgkmcnt(0)
    s_add_u32 s8, s6, 16777216
    s_addc_u32 s9, s7, 0
    s_mov_b32 s10, 18874368
    s_mov_b32 s11, 0x20000
    s_sub_u32 s68, 7340032, s66
    s_sub_u32 s69, 2097152, s66
    s_add_u32 s12, s58, s66
    s_addc_u32 s13, s59, 0
    s_mov_b32 s14, s68
    s_mov_b32 s15, 0x20000
    s_add_u32 s16, s56, s66
    s_addc_u32 s17, s57, 0
    s_mov_b32 s18, s69
    s_mov_b32 s19, 0x20000
    s_mov_b32 s20, s4
    s_mov_b32 s21, s5
    s_mov_b32 s22, 4194304
    s_mov_b32 s23, 0x20000
    s_mov_b32 s24, s70
    s_mov_b32 s25, s71
    s_mov_b32 s26, 4194304
    s_mov_b32 s27, 0x20000
    s_add_u32 s28, s6, 41943040
    s_addc_u32 s29, s7, 0
    s_mov_b32 s30, 131072
    s_mov_b32 s31, 0x20000
    v_mov_b32 v160, 0
    v_mov_b32 v161, 0
    v_mov_b32 v162, 0
    v_mov_b32 v163, 0
    v_mov_b32 v164, 0
    v_mov_b32 v165, 0
    v_mov_b32 v166, 0
    v_mov_b32 v167, 0
    v_mov_b32 v168, 0
    v_mov_b32 v169, 0
    v_mov_b32 v170, 0
    v_mov_b32 v171, 0
    v_mov_b32 v172, 0
    v_mov_b32 v173, 0
    v_mov_b32 v174, 0
    v_mov_b32 v175, 0
    v_mov_b32 v176, 0
    v_mov_b32 v177, 0
    v_mov_b32 v178, 0
    v_mov_b32 v179, 0
    v_mov_b32 v180, 0
    v_mov_b32 v181, 0
    v_mov_b32 v182, 0
    v_mov_b32 v183, 0
    v_mov_b32 v184, 0
    v_mov_b32 v185, 0
    v_mov_b32 v186, 0
    v_mov_b32 v187, 0
    v_mov_b32 v188, 0
    v_mov_b32 v189, 0
    v_mov_b32 v190, 0
    v_mov_b32 v191, 0
    v_mov_b32 v192, 0
    v_mov_b32 v193, 0
    v_mov_b32 v194, 0
    v_mov_b32 v195, 0
    v_mov_b32 v196, 0
    v_mov_b32 v197, 0
    v_mov_b32 v198, 0
    v_mov_b32 v199, 0
    v_mov_b32 v200, 0
    v_mov_b32 v201, 0
    v_mov_b32 v202, 0
    v_mov_b32 v203, 0
    v_mov_b32 v204, 0
    v_mov_b32 v205, 0
    v_mov_b32 v206, 0
    v_mov_b32 v207, 0
    v_mov_b32 v208, 0
    v_mov_b32 v209, 0
    v_mov_b32 v210, 0
    v_mov_b32 v211, 0
    v_mov_b32 v212, 0
    v_mov_b32 v213, 0
    v_mov_b32 v214, 0
    v_mov_b32 v215, 0
    v_mov_b32 v216, 0
    v_mov_b32 v217, 0
    v_mov_b32 v218, 0
    v_mov_b32 v219, 0
    v_mov_b32 v220, 0
    v_mov_b32 v221, 0
    v_mov_b32 v222, 0
    v_mov_b32 v223, 0
    v_mov_b32 v224, 0
    v_mov_b32 v225, 0
    v_mov_b32 v226, 0
    v_mov_b32 v227, 0
    v_mov_b32 v228, 0
    v_mov_b32 v229, 0
    v_mov_b32 v230, 0
    v_mov_b32 v231, 0
    v_mov_b32 v232, 0
    v_mov_b32 v233, 0
    v_mov_b32 v234, 0
    v_mov_b32 v235, 0
    v_mov_b32 v236, 0
    v_mov_b32 v237, 0
    v_mov_b32 v238, 0
    v_mov_b32 v239, 0
    v_mov_b32 v240, 0
    v_mov_b32 v241, 0
    v_mov_b32 v242, 0
    v_mov_b32 v243, 0
    v_mov_b32 v244, 0
    v_mov_b32 v245, 0
    v_mov_b32 v246, 0
    v_mov_b32 v247, 0
    v_mov_b32 v248, 0
    v_mov_b32 v249, 0
    v_mov_b32 v250, 0
    v_mov_b32 v251, 0
    v_mov_b32 v252, 0
    v_mov_b32 v253, 0
    v_mov_b32 v254, 0
    v_mov_b32 v255, 0
    s_barrier
    buffer_load_dwordx2 v[130:131], v14, s[20:23], s67 offen offset:0
    buffer_load_dwordx2 v[134:135], v14, s[20:23], s67 offen offset:32
    buffer_load_dwordx2 v[138:139], v14, s[20:23], s67 offen offset:64
    buffer_load_dwordx2 v[142:143], v14, s[20:23], s67 offen offset:96
    buffer_load_dwordx2 v[146:147], v15, s[20:23], s67 offen offset:0
    buffer_load_dwordx2 v[150:151], v15, s[20:23], s67 offen offset:32
    buffer_load_dwordx2 v[154:155], v15, s[20:23], s67 offen offset:64
    buffer_load_dwordx2 v[158:159], v15, s[20:23], s67 offen offset:96
    s_add_u32 m0, s42, 0
    s_nop 0
    buffer_load_dwordx4 v5, s[12:15], s41 offen offset:0 lds
    buffer_load_dwordx4 v6, s[12:15], s41 offen offset:1024 lds
    buffer_load_dwordx4 v7, s[12:15], s41 offen offset:2048 lds
    buffer_load_dwordx4 v8, s[12:15], s41 offen offset:3072 lds
    s_add_u32 s41, s41, 262144
    s_add_u32 m0, s42, 4096
    s_nop 0
    buffer_load_dwordx4 v5, s[12:15], s41 offen offset:0 lds
    buffer_load_dwordx4 v6, s[12:15], s41 offen offset:1024 lds
    buffer_load_dwordx4 v7, s[12:15], s41 offen offset:2048 lds
    buffer_load_dwordx4 v8, s[12:15], s41 offen offset:3072 lds
    s_add_u32 s41, s41, 262144
    buffer_load_dwordx4 v[32:35], v1, s[8:11], s40 offen offset:0
    buffer_load_dwordx4 v[36:39], v1, s[8:11], s40 offen offset:1024
    buffer_load_dwordx4 v[40:43], v2, s[8:11], s40 offen offset:0
    buffer_load_dwordx4 v[44:47], v2, s[8:11], s40 offen offset:1024
    buffer_load_dwordx4 v[48:51], v3, s[8:11], s40 offen offset:0
    buffer_load_dwordx4 v[52:55], v3, s[8:11], s40 offen offset:1024
    buffer_load_dwordx4 v[56:59], v4, s[8:11], s40 offen offset:0
    buffer_load_dwordx4 v[60:63], v4, s[8:11], s40 offen offset:1024
    s_add_u32 s40, s40, 524288
    s_add_u32 m0, s42, 8192
    s_nop 0
    buffer_load_dwordx4 v5, s[12:15], s41 offen offset:0 lds
    buffer_load_dwordx4 v6, s[12:15], s41 offen offset:1024 lds
    buffer_load_dwordx4 v7, s[12:15], s41 offen offset:2048 lds
    buffer_load_dwordx4 v8, s[12:15], s41 offen offset:3072 lds
    s_add_u32 s41, s41, 262144
    buffer_load_dwordx4 v[64:67], v1, s[8:11], s40 offen offset:0
    buffer_load_dwordx4 v[68:71], v1, s[8:11], s40 offen offset:1024
    buffer_load_dwordx4 v[72:75], v2, s[8:11], s40 offen offset:0
    buffer_load_dwordx4 v[76:79], v2, s[8:11], s40 offen offset:1024
    buffer_load_dwordx4 v[80:83], v3, s[8:11], s40 offen offset:0
    buffer_load_dwordx4 v[84:87], v3, s[8:11], s40 offen offset:1024
    buffer_load_dwordx4 v[88:91], v4, s[8:11], s40 offen offset:0
    buffer_load_dwordx4 v[92:95], v4, s[8:11], s40 offen offset:1024
    s_add_u32 s40, s40, 524288
    s_add_u32 m0, s42, 12288
    s_nop 0
    buffer_load_dwordx4 v5, s[12:15], s41 offen offset:0 lds
    buffer_load_dwordx4 v6, s[12:15], s41 offen offset:1024 lds
    buffer_load_dwordx4 v7, s[12:15], s41 offen offset:2048 lds
    buffer_load_dwordx4 v8, s[12:15], s41 offen offset:3072 lds
    s_add_u32 s41, s41, 262144
    buffer_load_dwordx4 v[96:99], v1, s[8:11], s40 offen offset:0
    buffer_load_dwordx4 v[100:103], v1, s[8:11], s40 offen offset:1024
    buffer_load_dwordx4 v[104:107], v2, s[8:11], s40 offen offset:0
    buffer_load_dwordx4 v[108:111], v2, s[8:11], s40 offen offset:1024
    buffer_load_dwordx4 v[112:115], v3, s[8:11], s40 offen offset:0
    buffer_load_dwordx4 v[116:119], v3, s[8:11], s40 offen offset:1024
    buffer_load_dwordx4 v[120:123], v4, s[8:11], s40 offen offset:0
    buffer_load_dwordx4 v[124:127], v4, s[8:11], s40 offen offset:1024
    s_add_u32 s40, s40, 524288
    s_add_u32 m0, s42, 16384
    s_nop 0
    buffer_load_dwordx4 v5, s[12:15], s41 offen offset:0 lds
    buffer_load_dwordx4 v6, s[12:15], s41 offen offset:1024 lds
    buffer_load_dwordx4 v7, s[12:15], s41 offen offset:2048 lds
    buffer_load_dwordx4 v8, s[12:15], s41 offen offset:3072 lds
    s_add_u32 s41, s41, 262144
    v_and_b32 v14, 7, v0
    v_lshlrev_b32 v14, 7, v14
    v_bfe_u32 v15, v0, 3, 1
    s_lshl_b32 s65, s64, 5
    s_lshl_b32 s68, s62, 1
    s_add_u32 s65, s65, s68
    v_add3_u32 v14, v14, v15, s65
    v_lshlrev_b32 v14, 7, v14
    s_barrier
    s_waitcnt vmcnt(40)
    ds_read_b64_tr_b16 v[16:17], v9 offset:0
    ds_read_b64_tr_b16 v[18:19], v9 offset:2048
    ds_read_b64_tr_b16 v[20:21], v10 offset:0
    ds_read_b64_tr_b16 v[22:23], v10 offset:2048
    ds_read_b64_tr_b16 v[24:25], v11 offset:0
    ds_read_b64_tr_b16 v[26:27], v11 offset:2048
    ds_read_b64_tr_b16 v[28:29], v12 offset:0
    ds_read_b64_tr_b16 v[30:31], v12 offset:2048
    v_lshlrev_b32 v128, 16, v130
    v_and_b32 v129, 0xffff0000, v130
    v_lshlrev_b32 v130, 16, v131
    v_and_b32 v131, 0xffff0000, v131
    v_lshlrev_b32 v132, 16, v134
    v_and_b32 v133, 0xffff0000, v134
    v_lshlrev_b32 v134, 16, v135
    v_and_b32 v135, 0xffff0000, v135
    v_lshlrev_b32 v136, 16, v138
    v_and_b32 v137, 0xffff0000, v138
    v_lshlrev_b32 v138, 16, v139
    v_and_b32 v139, 0xffff0000, v139
    v_lshlrev_b32 v140, 16, v142
    v_and_b32 v141, 0xffff0000, v142
    v_lshlrev_b32 v142, 16, v143
    v_and_b32 v143, 0xffff0000, v143
    v_lshlrev_b32 v144, 16, v146
    v_and_b32 v145, 0xffff0000, v146
    v_lshlrev_b32 v146, 16, v147
    v_and_b32 v147, 0xffff0000, v147
    v_lshlrev_b32 v148, 16, v150
    v_and_b32 v149, 0xffff0000, v150
    v_lshlrev_b32 v150, 16, v151
    v_and_b32 v151, 0xffff0000, v151
    v_lshlrev_b32 v152, 16, v154
    v_and_b32 v153, 0xffff0000, v154
    v_lshlrev_b32 v154, 16, v155
    v_and_b32 v155, 0xffff0000, v155
    v_lshlrev_b32 v156, 16, v158
    v_and_b32 v157, 0xffff0000, v158
    v_lshlrev_b32 v158, 16, v159
    v_and_b32 v159, 0xffff0000, v159
    s_waitcnt vmcnt(28) lgkmcnt(6)
    v_mfma_f32_16x16x32_bf16 v[128:131], v[16:19], v[32:35], v[128:131]
    v_mfma_f32_16x16x32_bf16 v[144:147], v[16:19], v[36:39], v[144:147]
    v_mfma_f32_16x16x32_bf16 v[160:163], v[16:19], v[40:43], v[160:163]
    s_add_u32 m0, s42, 20480
    v_mfma_f32_16x16x32_bf16 v[176:179], v[16:19], v[44:47], v[176:179]
    buffer_load_dwordx4 v5, s[12:15], s41 offen offset:0 lds
    v_mfma_f32_16x16x32_bf16 v[192:195], v[16:19], v[48:51], v[192:195]
    v_mfma_f32_16x16x32_bf16 v[208:211], v[16:19], v[52:55], v[208:211]
    buffer_load_dwordx4 v6, s[12:15], s41 offen offset:1024 lds
    v_mfma_f32_16x16x32_bf16 v[224:227], v[16:19], v[56:59], v[224:227]
    v_mfma_f32_16x16x32_bf16 v[240:243], v[16:19], v[60:63], v[240:243]
    s_waitcnt lgkmcnt(4)
    v_mfma_f32_16x16x32_bf16 v[132:135], v[20:23], v[32:35], v[132:135]
    ds_read_b64_tr_b16 v[16:17], v9 offset:4096
    v_mfma_f32_16x16x32_bf16 v[148:151], v[20:23], v[36:39], v[148:151]
    ds_read_b64_tr_b16 v[18:19], v9 offset:6144
    v_mfma_f32_16x16x32_bf16 v[164:167], v[20:23], v[40:43], v[164:167]
    v_mfma_f32_16x16x32_bf16 v[180:183], v[20:23], v[44:47], v[180:183]
    buffer_load_dwordx4 v7, s[12:15], s41 offen offset:2048 lds
    v_mfma_f32_16x16x32_bf16 v[196:199], v[20:23], v[48:51], v[196:199]
    v_mfma_f32_16x16x32_bf16 v[212:215], v[20:23], v[52:55], v[212:215]
    buffer_load_dwordx4 v8, s[12:15], s41 offen offset:3072 lds
    v_mfma_f32_16x16x32_bf16 v[228:231], v[20:23], v[56:59], v[228:231]
    s_add_u32 s41, s41, 262144
    v_mfma_f32_16x16x32_bf16 v[244:247], v[20:23], v[60:63], v[244:247]
    s_waitcnt lgkmcnt(4)
    s_barrier
    v_mfma_f32_16x16x32_bf16 v[136:139], v[24:27], v[32:35], v[136:139]
    ds_read_b64_tr_b16 v[20:21], v10 offset:4096
    v_mfma_f32_16x16x32_bf16 v[152:155], v[24:27], v[36:39], v[152:155]
    ds_read_b64_tr_b16 v[22:23], v10 offset:6144
    v_mfma_f32_16x16x32_bf16 v[168:171], v[24:27], v[40:43], v[168:171]
    v_mfma_f32_16x16x32_bf16 v[184:187], v[24:27], v[44:47], v[184:187]
    v_mfma_f32_16x16x32_bf16 v[200:203], v[24:27], v[48:51], v[200:203]
    v_mfma_f32_16x16x32_bf16 v[216:219], v[24:27], v[52:55], v[216:219]
    v_mfma_f32_16x16x32_bf16 v[232:235], v[24:27], v[56:59], v[232:235]
    v_mfma_f32_16x16x32_bf16 v[248:251], v[24:27], v[60:63], v[248:251]
    s_waitcnt lgkmcnt(4)
    v_mfma_f32_16x16x32_bf16 v[140:143], v[28:31], v[32:35], v[140:143]
    buffer_load_dwordx4 v[32:35], v1, s[8:11], s40 offen offset:0
    ds_read_b64_tr_b16 v[24:25], v11 offset:4096
    v_mfma_f32_16x16x32_bf16 v[156:159], v[28:31], v[36:39], v[156:159]
    buffer_load_dwordx4 v[36:39], v1, s[8:11], s40 offen offset:1024
    ds_read_b64_tr_b16 v[26:27], v11 offset:6144
    v_mfma_f32_16x16x32_bf16 v[172:175], v[28:31], v[40:43], v[172:175]
    buffer_load_dwordx4 v[40:43], v2, s[8:11], s40 offen offset:0
    v_mfma_f32_16x16x32_bf16 v[188:191], v[28:31], v[44:47], v[188:191]
    buffer_load_dwordx4 v[44:47], v2, s[8:11], s40 offen offset:1024
    v_mfma_f32_16x16x32_bf16 v[204:207], v[28:31], v[48:51], v[204:207]
    buffer_load_dwordx4 v[48:51], v3, s[8:11], s40 offen offset:0
    v_mfma_f32_16x16x32_bf16 v[220:223], v[28:31], v[52:55], v[220:223]
    buffer_load_dwordx4 v[52:55], v3, s[8:11], s40 offen offset:1024
    v_mfma_f32_16x16x32_bf16 v[236:239], v[28:31], v[56:59], v[236:239]
    buffer_load_dwordx4 v[56:59], v4, s[8:11], s40 offen offset:0
    v_mfma_f32_16x16x32_bf16 v[252:255], v[28:31], v[60:63], v[252:255]
    buffer_load_dwordx4 v[60:63], v4, s[8:11], s40 offen offset:1024
    s_waitcnt vmcnt(24) lgkmcnt(4)
    ds_read_b64_tr_b16 v[28:29], v12 offset:4096
    ds_read_b64_tr_b16 v[30:31], v12 offset:6144
    s_add_u32 s40, s40, 524288
    v_mfma_f32_16x16x32_bf16 v[128:131], v[16:19], v[64:67], v[128:131]
    v_mfma_f32_16x16x32_bf16 v[144:147], v[16:19], v[68:71], v[144:147]
    v_mfma_f32_16x16x32_bf16 v[160:163], v[16:19], v[72:75], v[160:163]
    s_add_u32 m0, s42, 0
    v_mfma_f32_16x16x32_bf16 v[176:179], v[16:19], v[76:79], v[176:179]
    buffer_load_dwordx4 v5, s[12:15], s41 offen offset:0 lds
    v_mfma_f32_16x16x32_bf16 v[192:195], v[16:19], v[80:83], v[192:195]
    v_mfma_f32_16x16x32_bf16 v[208:211], v[16:19], v[84:87], v[208:211]
    buffer_load_dwordx4 v6, s[12:15], s41 offen offset:1024 lds
    v_mfma_f32_16x16x32_bf16 v[224:227], v[16:19], v[88:91], v[224:227]
    v_mfma_f32_16x16x32_bf16 v[240:243], v[16:19], v[92:95], v[240:243]
    s_waitcnt lgkmcnt(4)
    v_mfma_f32_16x16x32_bf16 v[132:135], v[20:23], v[64:67], v[132:135]
    ds_read_b64_tr_b16 v[16:17], v9 offset:8192
    v_mfma_f32_16x16x32_bf16 v[148:151], v[20:23], v[68:71], v[148:151]
    ds_read_b64_tr_b16 v[18:19], v9 offset:10240
    v_mfma_f32_16x16x32_bf16 v[164:167], v[20:23], v[72:75], v[164:167]
    v_mfma_f32_16x16x32_bf16 v[180:183], v[20:23], v[76:79], v[180:183]
    buffer_load_dwordx4 v7, s[12:15], s41 offen offset:2048 lds
    v_mfma_f32_16x16x32_bf16 v[196:199], v[20:23], v[80:83], v[196:199]
    v_mfma_f32_16x16x32_bf16 v[212:215], v[20:23], v[84:87], v[212:215]
    buffer_load_dwordx4 v8, s[12:15], s41 offen offset:3072 lds
    v_mfma_f32_16x16x32_bf16 v[228:231], v[20:23], v[88:91], v[228:231]
    s_add_u32 s41, s41, 262144
    v_mfma_f32_16x16x32_bf16 v[244:247], v[20:23], v[92:95], v[244:247]
    s_waitcnt lgkmcnt(4)
    v_mfma_f32_16x16x32_bf16 v[136:139], v[24:27], v[64:67], v[136:139]
    ds_read_b64_tr_b16 v[20:21], v10 offset:8192
    v_mfma_f32_16x16x32_bf16 v[152:155], v[24:27], v[68:71], v[152:155]
    ds_read_b64_tr_b16 v[22:23], v10 offset:10240
    v_mfma_f32_16x16x32_bf16 v[168:171], v[24:27], v[72:75], v[168:171]
    v_mfma_f32_16x16x32_bf16 v[184:187], v[24:27], v[76:79], v[184:187]
    v_mfma_f32_16x16x32_bf16 v[200:203], v[24:27], v[80:83], v[200:203]
    v_mfma_f32_16x16x32_bf16 v[216:219], v[24:27], v[84:87], v[216:219]
    v_mfma_f32_16x16x32_bf16 v[232:235], v[24:27], v[88:91], v[232:235]
    v_mfma_f32_16x16x32_bf16 v[248:251], v[24:27], v[92:95], v[248:251]
    s_waitcnt lgkmcnt(4)
    v_mfma_f32_16x16x32_bf16 v[140:143], v[28:31], v[64:67], v[140:143]
    buffer_load_dwordx4 v[64:67], v1, s[8:11], s40 offen offset:0
    ds_read_b64_tr_b16 v[24:25], v11 offset:8192
    v_mfma_f32_16x16x32_bf16 v[156:159], v[28:31], v[68:71], v[156:159]
    buffer_load_dwordx4 v[68:71], v1, s[8:11], s40 offen offset:1024
    ds_read_b64_tr_b16 v[26:27], v11 offset:10240
    v_mfma_f32_16x16x32_bf16 v[172:175], v[28:31], v[72:75], v[172:175]
    buffer_load_dwordx4 v[72:75], v2, s[8:11], s40 offen offset:0
    v_mfma_f32_16x16x32_bf16 v[188:191], v[28:31], v[76:79], v[188:191]
    buffer_load_dwordx4 v[76:79], v2, s[8:11], s40 offen offset:1024
    v_mfma_f32_16x16x32_bf16 v[204:207], v[28:31], v[80:83], v[204:207]
    buffer_load_dwordx4 v[80:83], v3, s[8:11], s40 offen offset:0
    v_mfma_f32_16x16x32_bf16 v[220:223], v[28:31], v[84:87], v[220:223]
    buffer_load_dwordx4 v[84:87], v3, s[8:11], s40 offen offset:1024
    s_barrier
    v_mfma_f32_16x16x32_bf16 v[236:239], v[28:31], v[88:91], v[236:239]
    buffer_load_dwordx4 v[88:91], v4, s[8:11], s40 offen offset:0
    v_mfma_f32_16x16x32_bf16 v[252:255], v[28:31], v[92:95], v[252:255]
    buffer_load_dwordx4 v[92:95], v4, s[8:11], s40 offen offset:1024
    s_waitcnt vmcnt(24) lgkmcnt(4)
    ds_read_b64_tr_b16 v[28:29], v12 offset:8192
    ds_read_b64_tr_b16 v[30:31], v12 offset:10240
    s_add_u32 s40, s40, 524288
    v_mfma_f32_16x16x32_bf16 v[128:131], v[16:19], v[96:99], v[128:131]
    v_mfma_f32_16x16x32_bf16 v[144:147], v[16:19], v[100:103], v[144:147]
    v_mfma_f32_16x16x32_bf16 v[160:163], v[16:19], v[104:107], v[160:163]
    s_add_u32 m0, s42, 4096
    v_mfma_f32_16x16x32_bf16 v[176:179], v[16:19], v[108:111], v[176:179]
    buffer_load_dwordx4 v5, s[12:15], s41 offen offset:0 lds
    v_mfma_f32_16x16x32_bf16 v[192:195], v[16:19], v[112:115], v[192:195]
    v_mfma_f32_16x16x32_bf16 v[208:211], v[16:19], v[116:119], v[208:211]
    buffer_load_dwordx4 v6, s[12:15], s41 offen offset:1024 lds
    v_mfma_f32_16x16x32_bf16 v[224:227], v[16:19], v[120:123], v[224:227]
    v_mfma_f32_16x16x32_bf16 v[240:243], v[16:19], v[124:127], v[240:243]
    s_waitcnt lgkmcnt(4)
    v_mfma_f32_16x16x32_bf16 v[132:135], v[20:23], v[96:99], v[132:135]
    ds_read_b64_tr_b16 v[16:17], v9 offset:12288
    v_mfma_f32_16x16x32_bf16 v[148:151], v[20:23], v[100:103], v[148:151]
    ds_read_b64_tr_b16 v[18:19], v9 offset:14336
    v_mfma_f32_16x16x32_bf16 v[164:167], v[20:23], v[104:107], v[164:167]
    v_mfma_f32_16x16x32_bf16 v[180:183], v[20:23], v[108:111], v[180:183]
    buffer_load_dwordx4 v7, s[12:15], s41 offen offset:2048 lds
    v_mfma_f32_16x16x32_bf16 v[196:199], v[20:23], v[112:115], v[196:199]
    v_mfma_f32_16x16x32_bf16 v[212:215], v[20:23], v[116:119], v[212:215]
    buffer_load_dwordx4 v8, s[12:15], s41 offen offset:3072 lds
    v_mfma_f32_16x16x32_bf16 v[228:231], v[20:23], v[120:123], v[228:231]
    s_add_u32 s41, s41, 262144
    v_mfma_f32_16x16x32_bf16 v[244:247], v[20:23], v[124:127], v[244:247]
    s_waitcnt lgkmcnt(4)
    v_mfma_f32_16x16x32_bf16 v[136:139], v[24:27], v[96:99], v[136:139]
    ds_read_b64_tr_b16 v[20:21], v10 offset:12288
    v_mfma_f32_16x16x32_bf16 v[152:155], v[24:27], v[100:103], v[152:155]
    ds_read_b64_tr_b16 v[22:23], v10 offset:14336
    v_mfma_f32_16x16x32_bf16 v[168:171], v[24:27], v[104:107], v[168:171]
    v_mfma_f32_16x16x32_bf16 v[184:187], v[24:27], v[108:111], v[184:187]
    v_mfma_f32_16x16x32_bf16 v[200:203], v[24:27], v[112:115], v[200:203]
    v_mfma_f32_16x16x32_bf16 v[216:219], v[24:27], v[116:119], v[216:219]
    v_mfma_f32_16x16x32_bf16 v[232:235], v[24:27], v[120:123], v[232:235]
    v_mfma_f32_16x16x32_bf16 v[248:251], v[24:27], v[124:127], v[248:251]
    s_waitcnt lgkmcnt(4)
    v_mfma_f32_16x16x32_bf16 v[140:143], v[28:31], v[96:99], v[140:143]
    buffer_load_dwordx4 v[96:99], v1, s[8:11], s40 offen offset:0
    ds_read_b64_tr_b16 v[24:25], v11 offset:12288
    v_mfma_f32_16x16x32_bf16 v[156:159], v[28:31], v[100:103], v[156:159]
    buffer_load_dwordx4 v[100:103], v1, s[8:11], s40 offen offset:1024
    ds_read_b64_tr_b16 v[26:27], v11 offset:14336
    v_mfma_f32_16x16x32_bf16 v[172:175], v[28:31], v[104:107], v[172:175]
    buffer_load_dwordx4 v[104:107], v2, s[8:11], s40 offen offset:0
    v_mfma_f32_16x16x32_bf16 v[188:191], v[28:31], v[108:111], v[188:191]
    buffer_load_dwordx4 v[108:111], v2, s[8:11], s40 offen offset:1024
    v_mfma_f32_16x16x32_bf16 v[204:207], v[28:31], v[112:115], v[204:207]
    buffer_load_dwordx4 v[112:115], v3, s[8:11], s40 offen offset:0
    v_mfma_f32_16x16x32_bf16 v[220:223], v[28:31], v[116:119], v[220:223]
    buffer_load_dwordx4 v[116:119], v3, s[8:11], s40 offen offset:1024
    v_mfma_f32_16x16x32_bf16 v[236:239], v[28:31], v[120:123], v[236:239]
    buffer_load_dwordx4 v[120:123], v4, s[8:11], s40 offen offset:0
    v_mfma_f32_16x16x32_bf16 v[252:255], v[28:31], v[124:127], v[252:255]
    buffer_load_dwordx4 v[124:127], v4, s[8:11], s40 offen offset:1024
    s_waitcnt vmcnt(24) lgkmcnt(4)
    ds_read_b64_tr_b16 v[28:29], v12 offset:12288
    ds_read_b64_tr_b16 v[30:31], v12 offset:14336
    s_add_u32 s40, s40, 524288
    v_mfma_f32_16x16x32_bf16 v[128:131], v[16:19], v[32:35], v[128:131]
    v_mfma_f32_16x16x32_bf16 v[144:147], v[16:19], v[36:39], v[144:147]
    v_mfma_f32_16x16x32_bf16 v[160:163], v[16:19], v[40:43], v[160:163]
    s_add_u32 m0, s42, 8192
    v_mfma_f32_16x16x32_bf16 v[176:179], v[16:19], v[44:47], v[176:179]
    buffer_load_dwordx4 v5, s[12:15], s41 offen offset:0 lds
    v_mfma_f32_16x16x32_bf16 v[192:195], v[16:19], v[48:51], v[192:195]
    v_mfma_f32_16x16x32_bf16 v[208:211], v[16:19], v[52:55], v[208:211]
    buffer_load_dwordx4 v6, s[12:15], s41 offen offset:1024 lds
    v_mfma_f32_16x16x32_bf16 v[224:227], v[16:19], v[56:59], v[224:227]
    v_mfma_f32_16x16x32_bf16 v[240:243], v[16:19], v[60:63], v[240:243]
    s_waitcnt lgkmcnt(4)
    v_mfma_f32_16x16x32_bf16 v[132:135], v[20:23], v[32:35], v[132:135]
    ds_read_b64_tr_b16 v[16:17], v9 offset:16384
    v_mfma_f32_16x16x32_bf16 v[148:151], v[20:23], v[36:39], v[148:151]
    ds_read_b64_tr_b16 v[18:19], v9 offset:18432
    v_mfma_f32_16x16x32_bf16 v[164:167], v[20:23], v[40:43], v[164:167]
    s_barrier
    v_mfma_f32_16x16x32_bf16 v[180:183], v[20:23], v[44:47], v[180:183]
    buffer_load_dwordx4 v7, s[12:15], s41 offen offset:2048 lds
    v_mfma_f32_16x16x32_bf16 v[196:199], v[20:23], v[48:51], v[196:199]
    v_mfma_f32_16x16x32_bf16 v[212:215], v[20:23], v[52:55], v[212:215]
    buffer_load_dwordx4 v8, s[12:15], s41 offen offset:3072 lds
    v_mfma_f32_16x16x32_bf16 v[228:231], v[20:23], v[56:59], v[228:231]
    s_add_u32 s41, s41, 262144
    v_mfma_f32_16x16x32_bf16 v[244:247], v[20:23], v[60:63], v[244:247]
    s_waitcnt lgkmcnt(4)
    v_mfma_f32_16x16x32_bf16 v[136:139], v[24:27], v[32:35], v[136:139]
    ds_read_b64_tr_b16 v[20:21], v10 offset:16384
    v_mfma_f32_16x16x32_bf16 v[152:155], v[24:27], v[36:39], v[152:155]
    ds_read_b64_tr_b16 v[22:23], v10 offset:18432
    v_mfma_f32_16x16x32_bf16 v[168:171], v[24:27], v[40:43], v[168:171]
    v_mfma_f32_16x16x32_bf16 v[184:187], v[24:27], v[44:47], v[184:187]
    v_mfma_f32_16x16x32_bf16 v[200:203], v[24:27], v[48:51], v[200:203]
    v_mfma_f32_16x16x32_bf16 v[216:219], v[24:27], v[52:55], v[216:219]
    v_mfma_f32_16x16x32_bf16 v[232:235], v[24:27], v[56:59], v[232:235]
    v_mfma_f32_16x16x32_bf16 v[248:251], v[24:27], v[60:63], v[248:251]
    s_waitcnt lgkmcnt(4)
    v_mfma_f32_16x16x32_bf16 v[140:143], v[28:31], v[32:35], v[140:143]
    buffer_load_dwordx4 v[32:35], v1, s[8:11], s40 offen offset:0
    ds_read_b64_tr_b16 v[24:25], v11 offset:16384
    v_mfma_f32_16x16x32_bf16 v[156:159], v[28:31], v[36:39], v[156:159]
    buffer_load_dwordx4 v[36:39], v1, s[8:11], s40 offen offset:1024
    ds_read_b64_tr_b16 v[26:27], v11 offset:18432
    v_mfma_f32_16x16x32_bf16 v[172:175], v[28:31], v[40:43], v[172:175]
    buffer_load_dwordx4 v[40:43], v2, s[8:11], s40 offen offset:0
    v_mfma_f32_16x16x32_bf16 v[188:191], v[28:31], v[44:47], v[188:191]
    buffer_load_dwordx4 v[44:47], v2, s[8:11], s40 offen offset:1024
    v_mfma_f32_16x16x32_bf16 v[204:207], v[28:31], v[48:51], v[204:207]
    buffer_load_dwordx4 v[48:51], v3, s[8:11], s40 offen offset:0
    v_mfma_f32_16x16x32_bf16 v[220:223], v[28:31], v[52:55], v[220:223]
    buffer_load_dwordx4 v[52:55], v3, s[8:11], s40 offen offset:1024
    v_mfma_f32_16x16x32_bf16 v[236:239], v[28:31], v[56:59], v[236:239]
    buffer_load_dwordx4 v[56:59], v4, s[8:11], s40 offen offset:0
    v_mfma_f32_16x16x32_bf16 v[252:255], v[28:31], v[60:63], v[252:255]
    buffer_load_dwordx4 v[60:63], v4, s[8:11], s40 offen offset:1024
    s_waitcnt vmcnt(24) lgkmcnt(4)
    ds_read_b64_tr_b16 v[28:29], v12 offset:16384
    ds_read_b64_tr_b16 v[30:31], v12 offset:18432
    s_add_u32 s40, s40, 524288
    v_mfma_f32_16x16x32_bf16 v[128:131], v[16:19], v[64:67], v[128:131]
    v_mfma_f32_16x16x32_bf16 v[144:147], v[16:19], v[68:71], v[144:147]
    v_mfma_f32_16x16x32_bf16 v[160:163], v[16:19], v[72:75], v[160:163]
    s_add_u32 m0, s42, 12288
    v_mfma_f32_16x16x32_bf16 v[176:179], v[16:19], v[76:79], v[176:179]
    buffer_load_dwordx4 v5, s[12:15], s41 offen offset:0 lds
    v_mfma_f32_16x16x32_bf16 v[192:195], v[16:19], v[80:83], v[192:195]
    v_mfma_f32_16x16x32_bf16 v[208:211], v[16:19], v[84:87], v[208:211]
    buffer_load_dwordx4 v6, s[12:15], s41 offen offset:1024 lds
    v_mfma_f32_16x16x32_bf16 v[224:227], v[16:19], v[88:91], v[224:227]
    v_mfma_f32_16x16x32_bf16 v[240:243], v[16:19], v[92:95], v[240:243]
    s_waitcnt lgkmcnt(4)
    v_mfma_f32_16x16x32_bf16 v[132:135], v[20:23], v[64:67], v[132:135]
    ds_read_b64_tr_b16 v[16:17], v9 offset:20480
    v_mfma_f32_16x16x32_bf16 v[148:151], v[20:23], v[68:71], v[148:151]
    ds_read_b64_tr_b16 v[18:19], v9 offset:22528
    v_mfma_f32_16x16x32_bf16 v[164:167], v[20:23], v[72:75], v[164:167]
    v_mfma_f32_16x16x32_bf16 v[180:183], v[20:23], v[76:79], v[180:183]
    buffer_load_dwordx4 v7, s[12:15], s41 offen offset:2048 lds
    v_mfma_f32_16x16x32_bf16 v[196:199], v[20:23], v[80:83], v[196:199]
    v_mfma_f32_16x16x32_bf16 v[212:215], v[20:23], v[84:87], v[212:215]
    buffer_load_dwordx4 v8, s[12:15], s41 offen offset:3072 lds
    v_mfma_f32_16x16x32_bf16 v[228:231], v[20:23], v[88:91], v[228:231]
    s_add_u32 s41, s41, 262144
    v_mfma_f32_16x16x32_bf16 v[244:247], v[20:23], v[92:95], v[244:247]
    s_waitcnt lgkmcnt(4)
    v_mfma_f32_16x16x32_bf16 v[136:139], v[24:27], v[64:67], v[136:139]
    ds_read_b64_tr_b16 v[20:21], v10 offset:20480
    v_mfma_f32_16x16x32_bf16 v[152:155], v[24:27], v[68:71], v[152:155]
    ds_read_b64_tr_b16 v[22:23], v10 offset:22528
    v_mfma_f32_16x16x32_bf16 v[168:171], v[24:27], v[72:75], v[168:171]
    v_mfma_f32_16x16x32_bf16 v[184:187], v[24:27], v[76:79], v[184:187]
    v_mfma_f32_16x16x32_bf16 v[200:203], v[24:27], v[80:83], v[200:203]
    v_mfma_f32_16x16x32_bf16 v[216:219], v[24:27], v[84:87], v[216:219]
    v_mfma_f32_16x16x32_bf16 v[232:235], v[24:27], v[88:91], v[232:235]
    v_mfma_f32_16x16x32_bf16 v[248:251], v[24:27], v[92:95], v[248:251]
    s_waitcnt lgkmcnt(4)
    v_mfma_f32_16x16x32_bf16 v[140:143], v[28:31], v[64:67], v[140:143]
    buffer_load_dwordx4 v[64:67], v1, s[8:11], s40 offen offset:0
    ds_read_b64_tr_b16 v[24:25], v11 offset:20480
    s_barrier
    v_mfma_f32_16x16x32_bf16 v[156:159], v[28:31], v[68:71], v[156:159]
    buffer_load_dwordx4 v[68:71], v1, s[8:11], s40 offen offset:1024
    ds_read_b64_tr_b16 v[26:27], v11 offset:22528
    v_mfma_f32_16x16x32_bf16 v[172:175], v[28:31], v[72:75], v[172:175]
    buffer_load_dwordx4 v[72:75], v2, s[8:11], s40 offen offset:0
    v_mfma_f32_16x16x32_bf16 v[188:191], v[28:31], v[76:79], v[188:191]
    buffer_load_dwordx4 v[76:79], v2, s[8:11], s40 offen offset:1024
    v_mfma_f32_16x16x32_bf16 v[204:207], v[28:31], v[80:83], v[204:207]
    buffer_load_dwordx4 v[80:83], v3, s[8:11], s40 offen offset:0
    v_mfma_f32_16x16x32_bf16 v[220:223], v[28:31], v[84:87], v[220:223]
    buffer_load_dwordx4 v[84:87], v3, s[8:11], s40 offen offset:1024
    v_mfma_f32_16x16x32_bf16 v[236:239], v[28:31], v[88:91], v[236:239]
    buffer_load_dwordx4 v[88:91], v4, s[8:11], s40 offen offset:0
    v_mfma_f32_16x16x32_bf16 v[252:255], v[28:31], v[92:95], v[252:255]
    buffer_load_dwordx4 v[92:95], v4, s[8:11], s40 offen offset:1024
    s_waitcnt vmcnt(24) lgkmcnt(4)
    ds_read_b64_tr_b16 v[28:29], v12 offset:20480
    ds_read_b64_tr_b16 v[30:31], v12 offset:22528
    s_add_u32 s40, s40, 524288
    v_mfma_f32_16x16x32_bf16 v[128:131], v[16:19], v[96:99], v[128:131]
    v_mfma_f32_16x16x32_bf16 v[144:147], v[16:19], v[100:103], v[144:147]
    v_mfma_f32_16x16x32_bf16 v[160:163], v[16:19], v[104:107], v[160:163]
    s_add_u32 m0, s42, 16384
    v_mfma_f32_16x16x32_bf16 v[176:179], v[16:19], v[108:111], v[176:179]
    buffer_load_dwordx4 v5, s[12:15], s41 offen offset:0 lds
    v_mfma_f32_16x16x32_bf16 v[192:195], v[16:19], v[112:115], v[192:195]
    v_mfma_f32_16x16x32_bf16 v[208:211], v[16:19], v[116:119], v[208:211]
    buffer_load_dwordx4 v6, s[12:15], s41 offen offset:1024 lds
    v_mfma_f32_16x16x32_bf16 v[224:227], v[16:19], v[120:123], v[224:227]
    v_mfma_f32_16x16x32_bf16 v[240:243], v[16:19], v[124:127], v[240:243]
    s_waitcnt lgkmcnt(4)
    v_mfma_f32_16x16x32_bf16 v[132:135], v[20:23], v[96:99], v[132:135]
    ds_read_b64_tr_b16 v[16:17], v9 offset:0
    v_mfma_f32_16x16x32_bf16 v[148:151], v[20:23], v[100:103], v[148:151]
    ds_read_b64_tr_b16 v[18:19], v9 offset:2048
    v_mfma_f32_16x16x32_bf16 v[164:167], v[20:23], v[104:107], v[164:167]
    v_mfma_f32_16x16x32_bf16 v[180:183], v[20:23], v[108:111], v[180:183]
    buffer_load_dwordx4 v7, s[12:15], s41 offen offset:2048 lds
    v_mfma_f32_16x16x32_bf16 v[196:199], v[20:23], v[112:115], v[196:199]
    v_mfma_f32_16x16x32_bf16 v[212:215], v[20:23], v[116:119], v[212:215]
    buffer_load_dwordx4 v8, s[12:15], s41 offen offset:3072 lds
    v_mfma_f32_16x16x32_bf16 v[228:231], v[20:23], v[120:123], v[228:231]
    s_add_u32 s41, s41, 262144
    v_mfma_f32_16x16x32_bf16 v[244:247], v[20:23], v[124:127], v[244:247]
    s_waitcnt lgkmcnt(4)
    v_mfma_f32_16x16x32_bf16 v[136:139], v[24:27], v[96:99], v[136:139]
    ds_read_b64_tr_b16 v[20:21], v10 offset:0
    v_mfma_f32_16x16x32_bf16 v[152:155], v[24:27], v[100:103], v[152:155]
    ds_read_b64_tr_b16 v[22:23], v10 offset:2048
    v_mfma_f32_16x16x32_bf16 v[168:171], v[24:27], v[104:107], v[168:171]
    v_mfma_f32_16x16x32_bf16 v[184:187], v[24:27], v[108:111], v[184:187]
    v_mfma_f32_16x16x32_bf16 v[200:203], v[24:27], v[112:115], v[200:203]
    v_mfma_f32_16x16x32_bf16 v[216:219], v[24:27], v[116:119], v[216:219]
    v_mfma_f32_16x16x32_bf16 v[232:235], v[24:27], v[120:123], v[232:235]
    v_mfma_f32_16x16x32_bf16 v[248:251], v[24:27], v[124:127], v[248:251]
    s_waitcnt lgkmcnt(4)
    v_mfma_f32_16x16x32_bf16 v[140:143], v[28:31], v[96:99], v[140:143]
    buffer_load_dwordx4 v[96:99], v1, s[8:11], s40 offen offset:0
    ds_read_b64_tr_b16 v[24:25], v11 offset:0
    v_mfma_f32_16x16x32_bf16 v[156:159], v[28:31], v[100:103], v[156:159]
    buffer_load_dwordx4 v[100:103], v1, s[8:11], s40 offen offset:1024
    ds_read_b64_tr_b16 v[26:27], v11 offset:2048
    v_mfma_f32_16x16x32_bf16 v[172:175], v[28:31], v[104:107], v[172:175]
    buffer_load_dwordx4 v[104:107], v2, s[8:11], s40 offen offset:0
    v_mfma_f32_16x16x32_bf16 v[188:191], v[28:31], v[108:111], v[188:191]
    buffer_load_dwordx4 v[108:111], v2, s[8:11], s40 offen offset:1024
    v_mfma_f32_16x16x32_bf16 v[204:207], v[28:31], v[112:115], v[204:207]
    buffer_load_dwordx4 v[112:115], v3, s[8:11], s40 offen offset:0
    v_mfma_f32_16x16x32_bf16 v[220:223], v[28:31], v[116:119], v[220:223]
    buffer_load_dwordx4 v[116:119], v3, s[8:11], s40 offen offset:1024
    v_mfma_f32_16x16x32_bf16 v[236:239], v[28:31], v[120:123], v[236:239]
    buffer_load_dwordx4 v[120:123], v4, s[8:11], s40 offen offset:0
    v_mfma_f32_16x16x32_bf16 v[252:255], v[28:31], v[124:127], v[252:255]
    buffer_load_dwordx4 v[124:127], v4, s[8:11], s40 offen offset:1024
    s_waitcnt vmcnt(24) lgkmcnt(4)
    ds_read_b64_tr_b16 v[28:29], v12 offset:0
    ds_read_b64_tr_b16 v[30:31], v12 offset:2048
    s_add_u32 s40, s40, 524288
    v_mfma_f32_16x16x32_bf16 v[128:131], v[16:19], v[32:35], v[128:131]
    v_mfma_f32_16x16x32_bf16 v[144:147], v[16:19], v[36:39], v[144:147]
    v_mfma_f32_16x16x32_bf16 v[160:163], v[16:19], v[40:43], v[160:163]
    s_add_u32 m0, s42, 20480
    v_mfma_f32_16x16x32_bf16 v[176:179], v[16:19], v[44:47], v[176:179]
    buffer_load_dwordx4 v5, s[12:15], s41 offen offset:0 lds
    v_mfma_f32_16x16x32_bf16 v[192:195], v[16:19], v[48:51], v[192:195]
    v_mfma_f32_16x16x32_bf16 v[208:211], v[16:19], v[52:55], v[208:211]
    buffer_load_dwordx4 v6, s[12:15], s41 offen offset:1024 lds
    v_mfma_f32_16x16x32_bf16 v[224:227], v[16:19], v[56:59], v[224:227]
    s_barrier
    v_mfma_f32_16x16x32_bf16 v[240:243], v[16:19], v[60:63], v[240:243]
    s_waitcnt lgkmcnt(4)
    v_mfma_f32_16x16x32_bf16 v[132:135], v[20:23], v[32:35], v[132:135]
    ds_read_b64_tr_b16 v[16:17], v9 offset:4096
    v_mfma_f32_16x16x32_bf16 v[148:151], v[20:23], v[36:39], v[148:151]
    ds_read_b64_tr_b16 v[18:19], v9 offset:6144
    v_mfma_f32_16x16x32_bf16 v[164:167], v[20:23], v[40:43], v[164:167]
    v_mfma_f32_16x16x32_bf16 v[180:183], v[20:23], v[44:47], v[180:183]
    buffer_load_dwordx4 v7, s[12:15], s41 offen offset:2048 lds
    v_mfma_f32_16x16x32_bf16 v[196:199], v[20:23], v[48:51], v[196:199]
    v_mfma_f32_16x16x32_bf16 v[212:215], v[20:23], v[52:55], v[212:215]
    buffer_load_dwordx4 v8, s[12:15], s41 offen offset:3072 lds
    v_mfma_f32_16x16x32_bf16 v[228:231], v[20:23], v[56:59], v[228:231]
    s_add_u32 s41, s41, 262144
    v_mfma_f32_16x16x32_bf16 v[244:247], v[20:23], v[60:63], v[244:247]
    s_waitcnt lgkmcnt(4)
    v_mfma_f32_16x16x32_bf16 v[136:139], v[24:27], v[32:35], v[136:139]
    ds_read_b64_tr_b16 v[20:21], v10 offset:4096
    v_mfma_f32_16x16x32_bf16 v[152:155], v[24:27], v[36:39], v[152:155]
    ds_read_b64_tr_b16 v[22:23], v10 offset:6144
    v_mfma_f32_16x16x32_bf16 v[168:171], v[24:27], v[40:43], v[168:171]
    v_mfma_f32_16x16x32_bf16 v[184:187], v[24:27], v[44:47], v[184:187]
    v_mfma_f32_16x16x32_bf16 v[200:203], v[24:27], v[48:51], v[200:203]
    v_mfma_f32_16x16x32_bf16 v[216:219], v[24:27], v[52:55], v[216:219]
    v_mfma_f32_16x16x32_bf16 v[232:235], v[24:27], v[56:59], v[232:235]
    v_mfma_f32_16x16x32_bf16 v[248:251], v[24:27], v[60:63], v[248:251]
    s_waitcnt lgkmcnt(4)
    v_mfma_f32_16x16x32_bf16 v[140:143], v[28:31], v[32:35], v[140:143]
    buffer_load_dwordx4 v[32:35], v1, s[8:11], s40 offen offset:0
    ds_read_b64_tr_b16 v[24:25], v11 offset:4096
    v_mfma_f32_16x16x32_bf16 v[156:159], v[28:31], v[36:39], v[156:159]
    buffer_load_dwordx4 v[36:39], v1, s[8:11], s40 offen offset:1024
    ds_read_b64_tr_b16 v[26:27], v11 offset:6144
    v_mfma_f32_16x16x32_bf16 v[172:175], v[28:31], v[40:43], v[172:175]
    buffer_load_dwordx4 v[40:43], v2, s[8:11], s40 offen offset:0
    v_mfma_f32_16x16x32_bf16 v[188:191], v[28:31], v[44:47], v[188:191]
    buffer_load_dwordx4 v[44:47], v2, s[8:11], s40 offen offset:1024
    v_mfma_f32_16x16x32_bf16 v[204:207], v[28:31], v[48:51], v[204:207]
    buffer_load_dwordx4 v[48:51], v3, s[8:11], s40 offen offset:0
    v_mfma_f32_16x16x32_bf16 v[220:223], v[28:31], v[52:55], v[220:223]
    buffer_load_dwordx4 v[52:55], v3, s[8:11], s40 offen offset:1024
    v_mfma_f32_16x16x32_bf16 v[236:239], v[28:31], v[56:59], v[236:239]
    buffer_load_dwordx4 v[56:59], v4, s[8:11], s40 offen offset:0
    v_mfma_f32_16x16x32_bf16 v[252:255], v[28:31], v[60:63], v[252:255]
    buffer_load_dwordx4 v[60:63], v4, s[8:11], s40 offen offset:1024
    s_waitcnt vmcnt(24) lgkmcnt(4)
    ds_read_b64_tr_b16 v[28:29], v12 offset:4096
    ds_read_b64_tr_b16 v[30:31], v12 offset:6144
    s_add_u32 s40, s40, 524288
    v_mfma_f32_16x16x32_bf16 v[128:131], v[16:19], v[64:67], v[128:131]
    v_mfma_f32_16x16x32_bf16 v[144:147], v[16:19], v[68:71], v[144:147]
    v_mfma_f32_16x16x32_bf16 v[160:163], v[16:19], v[72:75], v[160:163]
    s_add_u32 m0, s42, 0
    v_mfma_f32_16x16x32_bf16 v[176:179], v[16:19], v[76:79], v[176:179]
    buffer_load_dwordx4 v5, s[12:15], s41 offen offset:0 lds
    v_mfma_f32_16x16x32_bf16 v[192:195], v[16:19], v[80:83], v[192:195]
    v_mfma_f32_16x16x32_bf16 v[208:211], v[16:19], v[84:87], v[208:211]
    buffer_load_dwordx4 v6, s[12:15], s41 offen offset:1024 lds
    v_mfma_f32_16x16x32_bf16 v[224:227], v[16:19], v[88:91], v[224:227]
    v_mfma_f32_16x16x32_bf16 v[240:243], v[16:19], v[92:95], v[240:243]
    s_waitcnt lgkmcnt(4)
    v_mfma_f32_16x16x32_bf16 v[132:135], v[20:23], v[64:67], v[132:135]
    ds_read_b64_tr_b16 v[16:17], v9 offset:8192
    v_mfma_f32_16x16x32_bf16 v[148:151], v[20:23], v[68:71], v[148:151]
    ds_read_b64_tr_b16 v[18:19], v9 offset:10240
    v_mfma_f32_16x16x32_bf16 v[164:167], v[20:23], v[72:75], v[164:167]
    v_mfma_f32_16x16x32_bf16 v[180:183], v[20:23], v[76:79], v[180:183]
    buffer_load_dwordx4 v7, s[12:15], s41 offen offset:2048 lds
    v_mfma_f32_16x16x32_bf16 v[196:199], v[20:23], v[80:83], v[196:199]
    v_mfma_f32_16x16x32_bf16 v[212:215], v[20:23], v[84:87], v[212:215]
    buffer_load_dwordx4 v8, s[12:15], s41 offen offset:3072 lds
    v_mfma_f32_16x16x32_bf16 v[228:231], v[20:23], v[88:91], v[228:231]
    s_add_u32 s41, s41, 262144
    v_mfma_f32_16x16x32_bf16 v[244:247], v[20:23], v[92:95], v[244:247]
    s_waitcnt lgkmcnt(4)
    v_mfma_f32_16x16x32_bf16 v[136:139], v[24:27], v[64:67], v[136:139]
    ds_read_b64_tr_b16 v[20:21], v10 offset:8192
    v_mfma_f32_16x16x32_bf16 v[152:155], v[24:27], v[68:71], v[152:155]
    ds_read_b64_tr_b16 v[22:23], v10 offset:10240
    v_mfma_f32_16x16x32_bf16 v[168:171], v[24:27], v[72:75], v[168:171]
    v_mfma_f32_16x16x32_bf16 v[184:187], v[24:27], v[76:79], v[184:187]
    v_mfma_f32_16x16x32_bf16 v[200:203], v[24:27], v[80:83], v[200:203]
    s_barrier
    v_mfma_f32_16x16x32_bf16 v[216:219], v[24:27], v[84:87], v[216:219]
    v_mfma_f32_16x16x32_bf16 v[232:235], v[24:27], v[88:91], v[232:235]
    v_mfma_f32_16x16x32_bf16 v[248:251], v[24:27], v[92:95], v[248:251]
    s_waitcnt lgkmcnt(4)
    v_mfma_f32_16x16x32_bf16 v[140:143], v[28:31], v[64:67], v[140:143]
    buffer_load_dwordx4 v[64:67], v1, s[8:11], s40 offen offset:0
    ds_read_b64_tr_b16 v[24:25], v11 offset:8192
    v_mfma_f32_16x16x32_bf16 v[156:159], v[28:31], v[68:71], v[156:159]
    buffer_load_dwordx4 v[68:71], v1, s[8:11], s40 offen offset:1024
    ds_read_b64_tr_b16 v[26:27], v11 offset:10240
    v_mfma_f32_16x16x32_bf16 v[172:175], v[28:31], v[72:75], v[172:175]
    buffer_load_dwordx4 v[72:75], v2, s[8:11], s40 offen offset:0
    v_mfma_f32_16x16x32_bf16 v[188:191], v[28:31], v[76:79], v[188:191]
    buffer_load_dwordx4 v[76:79], v2, s[8:11], s40 offen offset:1024
    v_mfma_f32_16x16x32_bf16 v[204:207], v[28:31], v[80:83], v[204:207]
    buffer_load_dwordx4 v[80:83], v3, s[8:11], s40 offen offset:0
    v_mfma_f32_16x16x32_bf16 v[220:223], v[28:31], v[84:87], v[220:223]
    buffer_load_dwordx4 v[84:87], v3, s[8:11], s40 offen offset:1024
    v_mfma_f32_16x16x32_bf16 v[236:239], v[28:31], v[88:91], v[236:239]
    buffer_load_dwordx4 v[88:91], v4, s[8:11], s40 offen offset:0
    v_mfma_f32_16x16x32_bf16 v[252:255], v[28:31], v[92:95], v[252:255]
    buffer_load_dwordx4 v[92:95], v4, s[8:11], s40 offen offset:1024
    s_waitcnt vmcnt(24) lgkmcnt(4)
    ds_read_b64_tr_b16 v[28:29], v12 offset:8192
    ds_read_b64_tr_b16 v[30:31], v12 offset:10240
    s_add_u32 s40, s40, 524288
    v_mfma_f32_16x16x32_bf16 v[128:131], v[16:19], v[96:99], v[128:131]
    v_mfma_f32_16x16x32_bf16 v[144:147], v[16:19], v[100:103], v[144:147]
    v_mfma_f32_16x16x32_bf16 v[160:163], v[16:19], v[104:107], v[160:163]
    s_add_u32 m0, s42, 4096
    v_mfma_f32_16x16x32_bf16 v[176:179], v[16:19], v[108:111], v[176:179]
    buffer_load_dwordx4 v5, s[12:15], s41 offen offset:0 lds
    v_mfma_f32_16x16x32_bf16 v[192:195], v[16:19], v[112:115], v[192:195]
    v_mfma_f32_16x16x32_bf16 v[208:211], v[16:19], v[116:119], v[208:211]
    buffer_load_dwordx4 v6, s[12:15], s41 offen offset:1024 lds
    v_mfma_f32_16x16x32_bf16 v[224:227], v[16:19], v[120:123], v[224:227]
    v_mfma_f32_16x16x32_bf16 v[240:243], v[16:19], v[124:127], v[240:243]
    s_waitcnt lgkmcnt(4)
    v_mfma_f32_16x16x32_bf16 v[132:135], v[20:23], v[96:99], v[132:135]
    ds_read_b64_tr_b16 v[16:17], v9 offset:12288
    v_mfma_f32_16x16x32_bf16 v[148:151], v[20:23], v[100:103], v[148:151]
    ds_read_b64_tr_b16 v[18:19], v9 offset:14336
    v_mfma_f32_16x16x32_bf16 v[164:167], v[20:23], v[104:107], v[164:167]
    v_mfma_f32_16x16x32_bf16 v[180:183], v[20:23], v[108:111], v[180:183]
    buffer_load_dwordx4 v7, s[12:15], s41 offen offset:2048 lds
    v_mfma_f32_16x16x32_bf16 v[196:199], v[20:23], v[112:115], v[196:199]
    v_mfma_f32_16x16x32_bf16 v[212:215], v[20:23], v[116:119], v[212:215]
    buffer_load_dwordx4 v8, s[12:15], s41 offen offset:3072 lds
    v_mfma_f32_16x16x32_bf16 v[228:231], v[20:23], v[120:123], v[228:231]
    s_add_u32 s41, s41, 262144
    v_mfma_f32_16x16x32_bf16 v[244:247], v[20:23], v[124:127], v[244:247]
    s_waitcnt lgkmcnt(4)
    v_mfma_f32_16x16x32_bf16 v[136:139], v[24:27], v[96:99], v[136:139]
    ds_read_b64_tr_b16 v[20:21], v10 offset:12288
    v_mfma_f32_16x16x32_bf16 v[152:155], v[24:27], v[100:103], v[152:155]
    ds_read_b64_tr_b16 v[22:23], v10 offset:14336
    v_mfma_f32_16x16x32_bf16 v[168:171], v[24:27], v[104:107], v[168:171]
    v_mfma_f32_16x16x32_bf16 v[184:187], v[24:27], v[108:111], v[184:187]
    v_mfma_f32_16x16x32_bf16 v[200:203], v[24:27], v[112:115], v[200:203]
    v_mfma_f32_16x16x32_bf16 v[216:219], v[24:27], v[116:119], v[216:219]
    v_mfma_f32_16x16x32_bf16 v[232:235], v[24:27], v[120:123], v[232:235]
    v_mfma_f32_16x16x32_bf16 v[248:251], v[24:27], v[124:127], v[248:251]
    s_waitcnt lgkmcnt(4)
    v_mfma_f32_16x16x32_bf16 v[140:143], v[28:31], v[96:99], v[140:143]
    buffer_load_dwordx4 v[96:99], v1, s[8:11], s40 offen offset:0
    ds_read_b64_tr_b16 v[24:25], v11 offset:12288
    v_mfma_f32_16x16x32_bf16 v[156:159], v[28:31], v[100:103], v[156:159]
    buffer_load_dwordx4 v[100:103], v1, s[8:11], s40 offen offset:1024
    ds_read_b64_tr_b16 v[26:27], v11 offset:14336
    v_mfma_f32_16x16x32_bf16 v[172:175], v[28:31], v[104:107], v[172:175]
    buffer_load_dwordx4 v[104:107], v2, s[8:11], s40 offen offset:0
    v_mfma_f32_16x16x32_bf16 v[188:191], v[28:31], v[108:111], v[188:191]
    buffer_load_dwordx4 v[108:111], v2, s[8:11], s40 offen offset:1024
    v_mfma_f32_16x16x32_bf16 v[204:207], v[28:31], v[112:115], v[204:207]
    buffer_load_dwordx4 v[112:115], v3, s[8:11], s40 offen offset:0
    v_mfma_f32_16x16x32_bf16 v[220:223], v[28:31], v[116:119], v[220:223]
    buffer_load_dwordx4 v[116:119], v3, s[8:11], s40 offen offset:1024
    v_mfma_f32_16x16x32_bf16 v[236:239], v[28:31], v[120:123], v[236:239]
    buffer_load_dwordx4 v[120:123], v4, s[8:11], s40 offen offset:0
    v_mfma_f32_16x16x32_bf16 v[252:255], v[28:31], v[124:127], v[252:255]
    buffer_load_dwordx4 v[124:127], v4, s[8:11], s40 offen offset:1024
    s_waitcnt vmcnt(24) lgkmcnt(4)
    ds_read_b64_tr_b16 v[28:29], v12 offset:12288
    ds_read_b64_tr_b16 v[30:31], v12 offset:14336
    s_add_u32 s40, s40, 524288
    v_mfma_f32_16x16x32_bf16 v[128:131], v[16:19], v[32:35], v[128:131]
    v_mfma_f32_16x16x32_bf16 v[144:147], v[16:19], v[36:39], v[144:147]
    s_barrier
    v_mfma_f32_16x16x32_bf16 v[160:163], v[16:19], v[40:43], v[160:163]
    s_add_u32 m0, s42, 8192
    v_mfma_f32_16x16x32_bf16 v[176:179], v[16:19], v[44:47], v[176:179]
    buffer_load_dwordx4 v5, s[12:15], s41 offen offset:0 lds
    v_mfma_f32_16x16x32_bf16 v[192:195], v[16:19], v[48:51], v[192:195]
    v_mfma_f32_16x16x32_bf16 v[208:211], v[16:19], v[52:55], v[208:211]
    buffer_load_dwordx4 v6, s[12:15], s41 offen offset:1024 lds
    v_mfma_f32_16x16x32_bf16 v[224:227], v[16:19], v[56:59], v[224:227]
    v_mfma_f32_16x16x32_bf16 v[240:243], v[16:19], v[60:63], v[240:243]
    s_waitcnt lgkmcnt(4)
    v_mfma_f32_16x16x32_bf16 v[132:135], v[20:23], v[32:35], v[132:135]
    ds_read_b64_tr_b16 v[16:17], v9 offset:16384
    v_mfma_f32_16x16x32_bf16 v[148:151], v[20:23], v[36:39], v[148:151]
    ds_read_b64_tr_b16 v[18:19], v9 offset:18432
    v_mfma_f32_16x16x32_bf16 v[164:167], v[20:23], v[40:43], v[164:167]
    v_mfma_f32_16x16x32_bf16 v[180:183], v[20:23], v[44:47], v[180:183]
    buffer_load_dwordx4 v7, s[12:15], s41 offen offset:2048 lds
    v_mfma_f32_16x16x32_bf16 v[196:199], v[20:23], v[48:51], v[196:199]
    v_mfma_f32_16x16x32_bf16 v[212:215], v[20:23], v[52:55], v[212:215]
    buffer_load_dwordx4 v8, s[12:15], s41 offen offset:3072 lds
    v_mfma_f32_16x16x32_bf16 v[228:231], v[20:23], v[56:59], v[228:231]
    s_add_u32 s41, s41, 262144
    v_mfma_f32_16x16x32_bf16 v[244:247], v[20:23], v[60:63], v[244:247]
    s_waitcnt lgkmcnt(4)
    v_mfma_f32_16x16x32_bf16 v[136:139], v[24:27], v[32:35], v[136:139]
    ds_read_b64_tr_b16 v[20:21], v10 offset:16384
    v_mfma_f32_16x16x32_bf16 v[152:155], v[24:27], v[36:39], v[152:155]
    ds_read_b64_tr_b16 v[22:23], v10 offset:18432
    v_mfma_f32_16x16x32_bf16 v[168:171], v[24:27], v[40:43], v[168:171]
    v_mfma_f32_16x16x32_bf16 v[184:187], v[24:27], v[44:47], v[184:187]
    v_mfma_f32_16x16x32_bf16 v[200:203], v[24:27], v[48:51], v[200:203]
    v_mfma_f32_16x16x32_bf16 v[216:219], v[24:27], v[52:55], v[216:219]
    v_mfma_f32_16x16x32_bf16 v[232:235], v[24:27], v[56:59], v[232:235]
    v_mfma_f32_16x16x32_bf16 v[248:251], v[24:27], v[60:63], v[248:251]
    s_waitcnt lgkmcnt(4)
    v_mfma_f32_16x16x32_bf16 v[140:143], v[28:31], v[32:35], v[140:143]
    buffer_load_dwordx4 v[32:35], v1, s[8:11], s40 offen offset:0
    ds_read_b64_tr_b16 v[24:25], v11 offset:16384
    v_mfma_f32_16x16x32_bf16 v[156:159], v[28:31], v[36:39], v[156:159]
    buffer_load_dwordx4 v[36:39], v1, s[8:11], s40 offen offset:1024
    ds_read_b64_tr_b16 v[26:27], v11 offset:18432
    v_mfma_f32_16x16x32_bf16 v[172:175], v[28:31], v[40:43], v[172:175]
    buffer_load_dwordx4 v[40:43], v2, s[8:11], s40 offen offset:0
    v_mfma_f32_16x16x32_bf16 v[188:191], v[28:31], v[44:47], v[188:191]
    buffer_load_dwordx4 v[44:47], v2, s[8:11], s40 offen offset:1024
    v_mfma_f32_16x16x32_bf16 v[204:207], v[28:31], v[48:51], v[204:207]
    buffer_load_dwordx4 v[48:51], v3, s[8:11], s40 offen offset:0
    v_mfma_f32_16x16x32_bf16 v[220:223], v[28:31], v[52:55], v[220:223]
    buffer_load_dwordx4 v[52:55], v3, s[8:11], s40 offen offset:1024
    v_mfma_f32_16x16x32_bf16 v[236:239], v[28:31], v[56:59], v[236:239]
    buffer_load_dwordx4 v[56:59], v4, s[8:11], s40 offen offset:0
    v_mfma_f32_16x16x32_bf16 v[252:255], v[28:31], v[60:63], v[252:255]
    buffer_load_dwordx4 v[60:63], v4, s[8:11], s40 offen offset:1024
    s_waitcnt vmcnt(24) lgkmcnt(4)
    ds_read_b64_tr_b16 v[28:29], v12 offset:16384
    ds_read_b64_tr_b16 v[30:31], v12 offset:18432
    s_add_u32 s40, s40, 524288
    v_mfma_f32_16x16x32_bf16 v[128:131], v[16:19], v[64:67], v[128:131]
    v_mfma_f32_16x16x32_bf16 v[144:147], v[16:19], v[68:71], v[144:147]
    v_mfma_f32_16x16x32_bf16 v[160:163], v[16:19], v[72:75], v[160:163]
    s_add_u32 m0, s42, 12288
    v_mfma_f32_16x16x32_bf16 v[176:179], v[16:19], v[76:79], v[176:179]
    buffer_load_dwordx4 v5, s[12:15], s41 offen offset:0 lds
    v_mfma_f32_16x16x32_bf16 v[192:195], v[16:19], v[80:83], v[192:195]
    v_mfma_f32_16x16x32_bf16 v[208:211], v[16:19], v[84:87], v[208:211]
    buffer_load_dwordx4 v6, s[12:15], s41 offen offset:1024 lds
    v_mfma_f32_16x16x32_bf16 v[224:227], v[16:19], v[88:91], v[224:227]
    v_mfma_f32_16x16x32_bf16 v[240:243], v[16:19], v[92:95], v[240:243]
    s_waitcnt lgkmcnt(4)
    v_mfma_f32_16x16x32_bf16 v[132:135], v[20:23], v[64:67], v[132:135]
    ds_read_b64_tr_b16 v[16:17], v9 offset:20480
    v_mfma_f32_16x16x32_bf16 v[148:151], v[20:23], v[68:71], v[148:151]
    ds_read_b64_tr_b16 v[18:19], v9 offset:22528
    v_mfma_f32_16x16x32_bf16 v[164:167], v[20:23], v[72:75], v[164:167]
    v_mfma_f32_16x16x32_bf16 v[180:183], v[20:23], v[76:79], v[180:183]
    buffer_load_dwordx4 v7, s[12:15], s41 offen offset:2048 lds
    v_mfma_f32_16x16x32_bf16 v[196:199], v[20:23], v[80:83], v[196:199]
    v_mfma_f32_16x16x32_bf16 v[212:215], v[20:23], v[84:87], v[212:215]
    buffer_load_dwordx4 v8, s[12:15], s41 offen offset:3072 lds
    v_mfma_f32_16x16x32_bf16 v[228:231], v[20:23], v[88:91], v[228:231]
    s_add_u32 s41, s41, 262144
    v_mfma_f32_16x16x32_bf16 v[244:247], v[20:23], v[92:95], v[244:247]
    s_waitcnt lgkmcnt(4)
    s_barrier
    v_mfma_f32_16x16x32_bf16 v[136:139], v[24:27], v[64:67], v[136:139]
    ds_read_b64_tr_b16 v[20:21], v10 offset:20480
    v_mfma_f32_16x16x32_bf16 v[152:155], v[24:27], v[68:71], v[152:155]
    ds_read_b64_tr_b16 v[22:23], v10 offset:22528
    v_mfma_f32_16x16x32_bf16 v[168:171], v[24:27], v[72:75], v[168:171]
    v_mfma_f32_16x16x32_bf16 v[184:187], v[24:27], v[76:79], v[184:187]
    v_mfma_f32_16x16x32_bf16 v[200:203], v[24:27], v[80:83], v[200:203]
    v_mfma_f32_16x16x32_bf16 v[216:219], v[24:27], v[84:87], v[216:219]
    v_mfma_f32_16x16x32_bf16 v[232:235], v[24:27], v[88:91], v[232:235]
    v_mfma_f32_16x16x32_bf16 v[248:251], v[24:27], v[92:95], v[248:251]
    s_waitcnt lgkmcnt(4)
    v_mfma_f32_16x16x32_bf16 v[140:143], v[28:31], v[64:67], v[140:143]
    buffer_load_dwordx4 v[64:67], v1, s[8:11], s40 offen offset:0
    ds_read_b64_tr_b16 v[24:25], v11 offset:20480
    v_mfma_f32_16x16x32_bf16 v[156:159], v[28:31], v[68:71], v[156:159]
    buffer_load_dwordx4 v[68:71], v1, s[8:11], s40 offen offset:1024
    ds_read_b64_tr_b16 v[26:27], v11 offset:22528
    v_mfma_f32_16x16x32_bf16 v[172:175], v[28:31], v[72:75], v[172:175]
    buffer_load_dwordx4 v[72:75], v2, s[8:11], s40 offen offset:0
    v_mfma_f32_16x16x32_bf16 v[188:191], v[28:31], v[76:79], v[188:191]
    buffer_load_dwordx4 v[76:79], v2, s[8:11], s40 offen offset:1024
    v_mfma_f32_16x16x32_bf16 v[204:207], v[28:31], v[80:83], v[204:207]
    buffer_load_dwordx4 v[80:83], v3, s[8:11], s40 offen offset:0
    v_mfma_f32_16x16x32_bf16 v[220:223], v[28:31], v[84:87], v[220:223]
    buffer_load_dwordx4 v[84:87], v3, s[8:11], s40 offen offset:1024
    v_mfma_f32_16x16x32_bf16 v[236:239], v[28:31], v[88:91], v[236:239]
    buffer_load_dwordx4 v[88:91], v4, s[8:11], s40 offen offset:0
    v_mfma_f32_16x16x32_bf16 v[252:255], v[28:31], v[92:95], v[252:255]
    buffer_load_dwordx4 v[92:95], v4, s[8:11], s40 offen offset:1024
    s_waitcnt vmcnt(24) lgkmcnt(4)
    ds_read_b64_tr_b16 v[28:29], v12 offset:20480
    ds_read_b64_tr_b16 v[30:31], v12 offset:22528
    s_add_u32 s40, s40, 524288
    v_mfma_f32_16x16x32_bf16 v[128:131], v[16:19], v[96:99], v[128:131]
    v_mfma_f32_16x16x32_bf16 v[144:147], v[16:19], v[100:103], v[144:147]
    v_mfma_f32_16x16x32_bf16 v[160:163], v[16:19], v[104:107], v[160:163]
    s_add_u32 m0, s42, 16384
    v_mfma_f32_16x16x32_bf16 v[176:179], v[16:19], v[108:111], v[176:179]
    buffer_load_dwordx4 v5, s[12:15], s41 offen offset:0 lds
    v_mfma_f32_16x16x32_bf16 v[192:195], v[16:19], v[112:115], v[192:195]
    v_mfma_f32_16x16x32_bf16 v[208:211], v[16:19], v[116:119], v[208:211]
    buffer_load_dwordx4 v6, s[12:15], s41 offen offset:1024 lds
    v_mfma_f32_16x16x32_bf16 v[224:227], v[16:19], v[120:123], v[224:227]
    v_mfma_f32_16x16x32_bf16 v[240:243], v[16:19], v[124:127], v[240:243]
    s_waitcnt lgkmcnt(4)
    v_mfma_f32_16x16x32_bf16 v[132:135], v[20:23], v[96:99], v[132:135]
    ds_read_b64_tr_b16 v[16:17], v9 offset:0
    v_mfma_f32_16x16x32_bf16 v[148:151], v[20:23], v[100:103], v[148:151]
    ds_read_b64_tr_b16 v[18:19], v9 offset:2048
    v_mfma_f32_16x16x32_bf16 v[164:167], v[20:23], v[104:107], v[164:167]
    v_mfma_f32_16x16x32_bf16 v[180:183], v[20:23], v[108:111], v[180:183]
    buffer_load_dwordx4 v7, s[12:15], s41 offen offset:2048 lds
    v_mfma_f32_16x16x32_bf16 v[196:199], v[20:23], v[112:115], v[196:199]
    v_mfma_f32_16x16x32_bf16 v[212:215], v[20:23], v[116:119], v[212:215]
    buffer_load_dwordx4 v8, s[12:15], s41 offen offset:3072 lds
    v_mfma_f32_16x16x32_bf16 v[228:231], v[20:23], v[120:123], v[228:231]
    s_add_u32 s41, s41, 262144
    v_mfma_f32_16x16x32_bf16 v[244:247], v[20:23], v[124:127], v[244:247]
    s_waitcnt lgkmcnt(4)
    v_mfma_f32_16x16x32_bf16 v[136:139], v[24:27], v[96:99], v[136:139]
    ds_read_b64_tr_b16 v[20:21], v10 offset:0
    v_mfma_f32_16x16x32_bf16 v[152:155], v[24:27], v[100:103], v[152:155]
    ds_read_b64_tr_b16 v[22:23], v10 offset:2048
    v_mfma_f32_16x16x32_bf16 v[168:171], v[24:27], v[104:107], v[168:171]
    v_mfma_f32_16x16x32_bf16 v[184:187], v[24:27], v[108:111], v[184:187]
    v_mfma_f32_16x16x32_bf16 v[200:203], v[24:27], v[112:115], v[200:203]
    v_mfma_f32_16x16x32_bf16 v[216:219], v[24:27], v[116:119], v[216:219]
    v_mfma_f32_16x16x32_bf16 v[232:235], v[24:27], v[120:123], v[232:235]
    v_mfma_f32_16x16x32_bf16 v[248:251], v[24:27], v[124:127], v[248:251]
    s_waitcnt lgkmcnt(4)
    v_mfma_f32_16x16x32_bf16 v[140:143], v[28:31], v[96:99], v[140:143]
    buffer_load_dwordx4 v[96:99], v1, s[8:11], s40 offen offset:0
    ds_read_b64_tr_b16 v[24:25], v11 offset:0
    v_mfma_f32_16x16x32_bf16 v[156:159], v[28:31], v[100:103], v[156:159]
    buffer_load_dwordx4 v[100:103], v1, s[8:11], s40 offen offset:1024
    ds_read_b64_tr_b16 v[26:27], v11 offset:2048
    v_mfma_f32_16x16x32_bf16 v[172:175], v[28:31], v[104:107], v[172:175]
    buffer_load_dwordx4 v[104:107], v2, s[8:11], s40 offen offset:0
    v_mfma_f32_16x16x32_bf16 v[188:191], v[28:31], v[108:111], v[188:191]
    buffer_load_dwordx4 v[108:111], v2, s[8:11], s40 offen offset:1024
    v_mfma_f32_16x16x32_bf16 v[204:207], v[28:31], v[112:115], v[204:207]
    buffer_load_dwordx4 v[112:115], v3, s[8:11], s40 offen offset:0
    v_mfma_f32_16x16x32_bf16 v[220:223], v[28:31], v[116:119], v[220:223]
    buffer_load_dwordx4 v[116:119], v3, s[8:11], s40 offen offset:1024
    s_barrier
    v_mfma_f32_16x16x32_bf16 v[236:239], v[28:31], v[120:123], v[236:239]
    buffer_load_dwordx4 v[120:123], v4, s[8:11], s40 offen offset:0
    v_mfma_f32_16x16x32_bf16 v[252:255], v[28:31], v[124:127], v[252:255]
    buffer_load_dwordx4 v[124:127], v4, s[8:11], s40 offen offset:1024
    s_waitcnt vmcnt(24) lgkmcnt(4)
    ds_read_b64_tr_b16 v[28:29], v12 offset:0
    ds_read_b64_tr_b16 v[30:31], v12 offset:2048
    s_add_u32 s40, s40, 524288
    v_mfma_f32_16x16x32_bf16 v[128:131], v[16:19], v[32:35], v[128:131]
    v_mfma_f32_16x16x32_bf16 v[144:147], v[16:19], v[36:39], v[144:147]
    v_mfma_f32_16x16x32_bf16 v[160:163], v[16:19], v[40:43], v[160:163]
    s_add_u32 m0, s42, 20480
    v_mfma_f32_16x16x32_bf16 v[176:179], v[16:19], v[44:47], v[176:179]
    buffer_load_dwordx4 v5, s[12:15], s41 offen offset:0 lds
    v_mfma_f32_16x16x32_bf16 v[192:195], v[16:19], v[48:51], v[192:195]
    v_mfma_f32_16x16x32_bf16 v[208:211], v[16:19], v[52:55], v[208:211]
    buffer_load_dwordx4 v6, s[12:15], s41 offen offset:1024 lds
    v_mfma_f32_16x16x32_bf16 v[224:227], v[16:19], v[56:59], v[224:227]
    v_mfma_f32_16x16x32_bf16 v[240:243], v[16:19], v[60:63], v[240:243]
    s_waitcnt lgkmcnt(4)
    v_mfma_f32_16x16x32_bf16 v[132:135], v[20:23], v[32:35], v[132:135]
    ds_read_b64_tr_b16 v[16:17], v9 offset:4096
    v_mfma_f32_16x16x32_bf16 v[148:151], v[20:23], v[36:39], v[148:151]
    ds_read_b64_tr_b16 v[18:19], v9 offset:6144
    v_mfma_f32_16x16x32_bf16 v[164:167], v[20:23], v[40:43], v[164:167]
    v_mfma_f32_16x16x32_bf16 v[180:183], v[20:23], v[44:47], v[180:183]
    buffer_load_dwordx4 v7, s[12:15], s41 offen offset:2048 lds
    v_mfma_f32_16x16x32_bf16 v[196:199], v[20:23], v[48:51], v[196:199]
    v_mfma_f32_16x16x32_bf16 v[212:215], v[20:23], v[52:55], v[212:215]
    buffer_load_dwordx4 v8, s[12:15], s41 offen offset:3072 lds
    v_mfma_f32_16x16x32_bf16 v[228:231], v[20:23], v[56:59], v[228:231]
    s_add_u32 s41, s41, 262144
    v_mfma_f32_16x16x32_bf16 v[244:247], v[20:23], v[60:63], v[244:247]
    s_waitcnt lgkmcnt(4)
    v_mfma_f32_16x16x32_bf16 v[136:139], v[24:27], v[32:35], v[136:139]
    ds_read_b64_tr_b16 v[20:21], v10 offset:4096
    v_mfma_f32_16x16x32_bf16 v[152:155], v[24:27], v[36:39], v[152:155]
    ds_read_b64_tr_b16 v[22:23], v10 offset:6144
    v_mfma_f32_16x16x32_bf16 v[168:171], v[24:27], v[40:43], v[168:171]
    v_mfma_f32_16x16x32_bf16 v[184:187], v[24:27], v[44:47], v[184:187]
    v_mfma_f32_16x16x32_bf16 v[200:203], v[24:27], v[48:51], v[200:203]
    v_mfma_f32_16x16x32_bf16 v[216:219], v[24:27], v[52:55], v[216:219]
    v_mfma_f32_16x16x32_bf16 v[232:235], v[24:27], v[56:59], v[232:235]
    v_mfma_f32_16x16x32_bf16 v[248:251], v[24:27], v[60:63], v[248:251]
    s_waitcnt lgkmcnt(4)
    v_mfma_f32_16x16x32_bf16 v[140:143], v[28:31], v[32:35], v[140:143]
    buffer_load_dwordx4 v[32:35], v1, s[8:11], s40 offen offset:0
    ds_read_b64_tr_b16 v[24:25], v11 offset:4096
    v_mfma_f32_16x16x32_bf16 v[156:159], v[28:31], v[36:39], v[156:159]
    buffer_load_dwordx4 v[36:39], v1, s[8:11], s40 offen offset:1024
    ds_read_b64_tr_b16 v[26:27], v11 offset:6144
    v_mfma_f32_16x16x32_bf16 v[172:175], v[28:31], v[40:43], v[172:175]
    buffer_load_dwordx4 v[40:43], v2, s[8:11], s40 offen offset:0
    v_mfma_f32_16x16x32_bf16 v[188:191], v[28:31], v[44:47], v[188:191]
    buffer_load_dwordx4 v[44:47], v2, s[8:11], s40 offen offset:1024
    v_mfma_f32_16x16x32_bf16 v[204:207], v[28:31], v[48:51], v[204:207]
    buffer_load_dwordx4 v[48:51], v3, s[8:11], s40 offen offset:0
    v_mfma_f32_16x16x32_bf16 v[220:223], v[28:31], v[52:55], v[220:223]
    buffer_load_dwordx4 v[52:55], v3, s[8:11], s40 offen offset:1024
    v_mfma_f32_16x16x32_bf16 v[236:239], v[28:31], v[56:59], v[236:239]
    buffer_load_dwordx4 v[56:59], v4, s[8:11], s40 offen offset:0
    v_mfma_f32_16x16x32_bf16 v[252:255], v[28:31], v[60:63], v[252:255]
    buffer_load_dwordx4 v[60:63], v4, s[8:11], s40 offen offset:1024
    s_waitcnt vmcnt(24) lgkmcnt(4)
    ds_read_b64_tr_b16 v[28:29], v12 offset:4096
    ds_read_b64_tr_b16 v[30:31], v12 offset:6144
    s_add_u32 s40, s40, 524288
    v_mfma_f32_16x16x32_bf16 v[128:131], v[16:19], v[64:67], v[128:131]
    v_mfma_f32_16x16x32_bf16 v[144:147], v[16:19], v[68:71], v[144:147]
    v_mfma_f32_16x16x32_bf16 v[160:163], v[16:19], v[72:75], v[160:163]
    s_add_u32 m0, s42, 0
    v_mfma_f32_16x16x32_bf16 v[176:179], v[16:19], v[76:79], v[176:179]
    buffer_load_dwordx4 v5, s[12:15], s41 offen offset:0 lds
    v_mfma_f32_16x16x32_bf16 v[192:195], v[16:19], v[80:83], v[192:195]
    v_mfma_f32_16x16x32_bf16 v[208:211], v[16:19], v[84:87], v[208:211]
    buffer_load_dwordx4 v6, s[12:15], s41 offen offset:1024 lds
    v_mfma_f32_16x16x32_bf16 v[224:227], v[16:19], v[88:91], v[224:227]
    v_mfma_f32_16x16x32_bf16 v[240:243], v[16:19], v[92:95], v[240:243]
    s_waitcnt lgkmcnt(4)
    v_mfma_f32_16x16x32_bf16 v[132:135], v[20:23], v[64:67], v[132:135]
    ds_read_b64_tr_b16 v[16:17], v9 offset:8192
    v_mfma_f32_16x16x32_bf16 v[148:151], v[20:23], v[68:71], v[148:151]
    ds_read_b64_tr_b16 v[18:19], v9 offset:10240
    v_mfma_f32_16x16x32_bf16 v[164:167], v[20:23], v[72:75], v[164:167]
    s_barrier
    v_mfma_f32_16x16x32_bf16 v[180:183], v[20:23], v[76:79], v[180:183]
    buffer_load_dwordx4 v7, s[12:15], s41 offen offset:2048 lds
    v_mfma_f32_16x16x32_bf16 v[196:199], v[20:23], v[80:83], v[196:199]
    v_mfma_f32_16x16x32_bf16 v[212:215], v[20:23], v[84:87], v[212:215]
    buffer_load_dwordx4 v8, s[12:15], s41 offen offset:3072 lds
    v_mfma_f32_16x16x32_bf16 v[228:231], v[20:23], v[88:91], v[228:231]
    s_add_u32 s41, s41, 262144
    v_mfma_f32_16x16x32_bf16 v[244:247], v[20:23], v[92:95], v[244:247]
    s_waitcnt lgkmcnt(4)
    v_mfma_f32_16x16x32_bf16 v[136:139], v[24:27], v[64:67], v[136:139]
    ds_read_b64_tr_b16 v[20:21], v10 offset:8192
    v_mfma_f32_16x16x32_bf16 v[152:155], v[24:27], v[68:71], v[152:155]
    ds_read_b64_tr_b16 v[22:23], v10 offset:10240
    v_mfma_f32_16x16x32_bf16 v[168:171], v[24:27], v[72:75], v[168:171]
    v_mfma_f32_16x16x32_bf16 v[184:187], v[24:27], v[76:79], v[184:187]
    v_mfma_f32_16x16x32_bf16 v[200:203], v[24:27], v[80:83], v[200:203]
    v_mfma_f32_16x16x32_bf16 v[216:219], v[24:27], v[84:87], v[216:219]
    v_mfma_f32_16x16x32_bf16 v[232:235], v[24:27], v[88:91], v[232:235]
    v_mfma_f32_16x16x32_bf16 v[248:251], v[24:27], v[92:95], v[248:251]
    s_waitcnt lgkmcnt(4)
    v_mfma_f32_16x16x32_bf16 v[140:143], v[28:31], v[64:67], v[140:143]
    buffer_load_dwordx4 v[64:67], v1, s[8:11], s40 offen offset:0
    ds_read_b64_tr_b16 v[24:25], v11 offset:8192
    v_mfma_f32_16x16x32_bf16 v[156:159], v[28:31], v[68:71], v[156:159]
    buffer_load_dwordx4 v[68:71], v1, s[8:11], s40 offen offset:1024
    ds_read_b64_tr_b16 v[26:27], v11 offset:10240
    v_mfma_f32_16x16x32_bf16 v[172:175], v[28:31], v[72:75], v[172:175]
    buffer_load_dwordx4 v[72:75], v2, s[8:11], s40 offen offset:0
    v_mfma_f32_16x16x32_bf16 v[188:191], v[28:31], v[76:79], v[188:191]
    buffer_load_dwordx4 v[76:79], v2, s[8:11], s40 offen offset:1024
    v_mfma_f32_16x16x32_bf16 v[204:207], v[28:31], v[80:83], v[204:207]
    buffer_load_dwordx4 v[80:83], v3, s[8:11], s40 offen offset:0
    v_mfma_f32_16x16x32_bf16 v[220:223], v[28:31], v[84:87], v[220:223]
    buffer_load_dwordx4 v[84:87], v3, s[8:11], s40 offen offset:1024
    v_mfma_f32_16x16x32_bf16 v[236:239], v[28:31], v[88:91], v[236:239]
    buffer_load_dwordx4 v[88:91], v4, s[8:11], s40 offen offset:0
    v_mfma_f32_16x16x32_bf16 v[252:255], v[28:31], v[92:95], v[252:255]
    buffer_load_dwordx4 v[92:95], v4, s[8:11], s40 offen offset:1024
    s_waitcnt vmcnt(24) lgkmcnt(4)
    ds_read_b64_tr_b16 v[28:29], v12 offset:8192
    ds_read_b64_tr_b16 v[30:31], v12 offset:10240
    s_add_u32 s40, s40, 524288
    v_mfma_f32_16x16x32_bf16 v[128:131], v[16:19], v[96:99], v[128:131]
    v_mfma_f32_16x16x32_bf16 v[144:147], v[16:19], v[100:103], v[144:147]
    v_mfma_f32_16x16x32_bf16 v[160:163], v[16:19], v[104:107], v[160:163]
    s_add_u32 m0, s42, 4096
    v_mfma_f32_16x16x32_bf16 v[176:179], v[16:19], v[108:111], v[176:179]
    buffer_load_dwordx4 v5, s[12:15], s41 offen offset:0 lds
    v_mfma_f32_16x16x32_bf16 v[192:195], v[16:19], v[112:115], v[192:195]
    v_mfma_f32_16x16x32_bf16 v[208:211], v[16:19], v[116:119], v[208:211]
    buffer_load_dwordx4 v6, s[12:15], s41 offen offset:1024 lds
    v_mfma_f32_16x16x32_bf16 v[224:227], v[16:19], v[120:123], v[224:227]
    v_mfma_f32_16x16x32_bf16 v[240:243], v[16:19], v[124:127], v[240:243]
    s_waitcnt lgkmcnt(4)
    v_mfma_f32_16x16x32_bf16 v[132:135], v[20:23], v[96:99], v[132:135]
    ds_read_b64_tr_b16 v[16:17], v9 offset:12288
    v_mfma_f32_16x16x32_bf16 v[148:151], v[20:23], v[100:103], v[148:151]
    ds_read_b64_tr_b16 v[18:19], v9 offset:14336
    v_mfma_f32_16x16x32_bf16 v[164:167], v[20:23], v[104:107], v[164:167]
    v_mfma_f32_16x16x32_bf16 v[180:183], v[20:23], v[108:111], v[180:183]
    buffer_load_dwordx4 v7, s[12:15], s41 offen offset:2048 lds
    v_mfma_f32_16x16x32_bf16 v[196:199], v[20:23], v[112:115], v[196:199]
    v_mfma_f32_16x16x32_bf16 v[212:215], v[20:23], v[116:119], v[212:215]
    buffer_load_dwordx4 v8, s[12:15], s41 offen offset:3072 lds
    v_mfma_f32_16x16x32_bf16 v[228:231], v[20:23], v[120:123], v[228:231]
    s_add_u32 s41, s41, 262144
    v_mfma_f32_16x16x32_bf16 v[244:247], v[20:23], v[124:127], v[244:247]
    s_waitcnt lgkmcnt(4)
    v_mfma_f32_16x16x32_bf16 v[136:139], v[24:27], v[96:99], v[136:139]
    ds_read_b64_tr_b16 v[20:21], v10 offset:12288
    v_mfma_f32_16x16x32_bf16 v[152:155], v[24:27], v[100:103], v[152:155]
    ds_read_b64_tr_b16 v[22:23], v10 offset:14336
    v_mfma_f32_16x16x32_bf16 v[168:171], v[24:27], v[104:107], v[168:171]
    v_mfma_f32_16x16x32_bf16 v[184:187], v[24:27], v[108:111], v[184:187]
    v_mfma_f32_16x16x32_bf16 v[200:203], v[24:27], v[112:115], v[200:203]
    v_mfma_f32_16x16x32_bf16 v[216:219], v[24:27], v[116:119], v[216:219]
    v_mfma_f32_16x16x32_bf16 v[232:235], v[24:27], v[120:123], v[232:235]
    v_mfma_f32_16x16x32_bf16 v[248:251], v[24:27], v[124:127], v[248:251]
    s_waitcnt lgkmcnt(4)
    v_mfma_f32_16x16x32_bf16 v[140:143], v[28:31], v[96:99], v[140:143]
    buffer_load_dwordx4 v[96:99], v1, s[8:11], s40 offen offset:0
    ds_read_b64_tr_b16 v[24:25], v11 offset:12288
    s_barrier
    v_mfma_f32_16x16x32_bf16 v[156:159], v[28:31], v[100:103], v[156:159]
    buffer_load_dwordx4 v[100:103], v1, s[8:11], s40 offen offset:1024
    ds_read_b64_tr_b16 v[26:27], v11 offset:14336
    v_mfma_f32_16x16x32_bf16 v[172:175], v[28:31], v[104:107], v[172:175]
    buffer_load_dwordx4 v[104:107], v2, s[8:11], s40 offen offset:0
    v_mfma_f32_16x16x32_bf16 v[188:191], v[28:31], v[108:111], v[188:191]
    buffer_load_dwordx4 v[108:111], v2, s[8:11], s40 offen offset:1024
    v_mfma_f32_16x16x32_bf16 v[204:207], v[28:31], v[112:115], v[204:207]
    buffer_load_dwordx4 v[112:115], v3, s[8:11], s40 offen offset:0
    v_mfma_f32_16x16x32_bf16 v[220:223], v[28:31], v[116:119], v[220:223]
    buffer_load_dwordx4 v[116:119], v3, s[8:11], s40 offen offset:1024
    v_mfma_f32_16x16x32_bf16 v[236:239], v[28:31], v[120:123], v[236:239]
    buffer_load_dwordx4 v[120:123], v4, s[8:11], s40 offen offset:0
    v_mfma_f32_16x16x32_bf16 v[252:255], v[28:31], v[124:127], v[252:255]
    buffer_load_dwordx4 v[124:127], v4, s[8:11], s40 offen offset:1024
    s_waitcnt vmcnt(24) lgkmcnt(4)
    ds_read_b64_tr_b16 v[28:29], v12 offset:12288
    ds_read_b64_tr_b16 v[30:31], v12 offset:14336
    s_add_u32 s40, s40, 524288
    v_mfma_f32_16x16x32_bf16 v[128:131], v[16:19], v[32:35], v[128:131]
    v_mfma_f32_16x16x32_bf16 v[144:147], v[16:19], v[36:39], v[144:147]
    v_mfma_f32_16x16x32_bf16 v[160:163], v[16:19], v[40:43], v[160:163]
    s_add_u32 m0, s42, 8192
    v_mfma_f32_16x16x32_bf16 v[176:179], v[16:19], v[44:47], v[176:179]
    buffer_load_dwordx4 v5, s[12:15], s41 offen offset:0 lds
    v_mfma_f32_16x16x32_bf16 v[192:195], v[16:19], v[48:51], v[192:195]
    v_mfma_f32_16x16x32_bf16 v[208:211], v[16:19], v[52:55], v[208:211]
    buffer_load_dwordx4 v6, s[12:15], s41 offen offset:1024 lds
    v_mfma_f32_16x16x32_bf16 v[224:227], v[16:19], v[56:59], v[224:227]
    v_mfma_f32_16x16x32_bf16 v[240:243], v[16:19], v[60:63], v[240:243]
    s_waitcnt lgkmcnt(4)
    v_mfma_f32_16x16x32_bf16 v[132:135], v[20:23], v[32:35], v[132:135]
    ds_read_b64_tr_b16 v[16:17], v9 offset:16384
    v_mfma_f32_16x16x32_bf16 v[148:151], v[20:23], v[36:39], v[148:151]
    ds_read_b64_tr_b16 v[18:19], v9 offset:18432
    v_mfma_f32_16x16x32_bf16 v[164:167], v[20:23], v[40:43], v[164:167]
    v_mfma_f32_16x16x32_bf16 v[180:183], v[20:23], v[44:47], v[180:183]
    buffer_load_dwordx4 v7, s[12:15], s41 offen offset:2048 lds
    v_mfma_f32_16x16x32_bf16 v[196:199], v[20:23], v[48:51], v[196:199]
    v_mfma_f32_16x16x32_bf16 v[212:215], v[20:23], v[52:55], v[212:215]
    buffer_load_dwordx4 v8, s[12:15], s41 offen offset:3072 lds
    v_mfma_f32_16x16x32_bf16 v[228:231], v[20:23], v[56:59], v[228:231]
    s_add_u32 s41, s41, 262144
    v_mfma_f32_16x16x32_bf16 v[244:247], v[20:23], v[60:63], v[244:247]
    s_waitcnt lgkmcnt(4)
    v_mfma_f32_16x16x32_bf16 v[136:139], v[24:27], v[32:35], v[136:139]
    ds_read_b64_tr_b16 v[20:21], v10 offset:16384
    v_mfma_f32_16x16x32_bf16 v[152:155], v[24:27], v[36:39], v[152:155]
    ds_read_b64_tr_b16 v[22:23], v10 offset:18432
    v_mfma_f32_16x16x32_bf16 v[168:171], v[24:27], v[40:43], v[168:171]
    v_mfma_f32_16x16x32_bf16 v[184:187], v[24:27], v[44:47], v[184:187]
    v_mfma_f32_16x16x32_bf16 v[200:203], v[24:27], v[48:51], v[200:203]
    v_mfma_f32_16x16x32_bf16 v[216:219], v[24:27], v[52:55], v[216:219]
    v_mfma_f32_16x16x32_bf16 v[232:235], v[24:27], v[56:59], v[232:235]
    v_mfma_f32_16x16x32_bf16 v[248:251], v[24:27], v[60:63], v[248:251]
    s_waitcnt lgkmcnt(4)
    v_mfma_f32_16x16x32_bf16 v[140:143], v[28:31], v[32:35], v[140:143]
    buffer_load_dwordx4 v[32:35], v1, s[8:11], s40 offen offset:0
    ds_read_b64_tr_b16 v[24:25], v11 offset:16384
    v_mfma_f32_16x16x32_bf16 v[156:159], v[28:31], v[36:39], v[156:159]
    buffer_load_dwordx4 v[36:39], v1, s[8:11], s40 offen offset:1024
    ds_read_b64_tr_b16 v[26:27], v11 offset:18432
    v_mfma_f32_16x16x32_bf16 v[172:175], v[28:31], v[40:43], v[172:175]
    buffer_load_dwordx4 v[40:43], v2, s[8:11], s40 offen offset:0
    v_mfma_f32_16x16x32_bf16 v[188:191], v[28:31], v[44:47], v[188:191]
    buffer_load_dwordx4 v[44:47], v2, s[8:11], s40 offen offset:1024
    v_mfma_f32_16x16x32_bf16 v[204:207], v[28:31], v[48:51], v[204:207]
    buffer_load_dwordx4 v[48:51], v3, s[8:11], s40 offen offset:0
    v_mfma_f32_16x16x32_bf16 v[220:223], v[28:31], v[52:55], v[220:223]
    buffer_load_dwordx4 v[52:55], v3, s[8:11], s40 offen offset:1024
    v_mfma_f32_16x16x32_bf16 v[236:239], v[28:31], v[56:59], v[236:239]
    buffer_load_dwordx4 v[56:59], v4, s[8:11], s40 offen offset:0
    v_mfma_f32_16x16x32_bf16 v[252:255], v[28:31], v[60:63], v[252:255]
    buffer_load_dwordx4 v[60:63], v4, s[8:11], s40 offen offset:1024
    s_waitcnt vmcnt(24) lgkmcnt(4)
    ds_read_b64_tr_b16 v[28:29], v12 offset:16384
    ds_read_b64_tr_b16 v[30:31], v12 offset:18432
    s_add_u32 s40, s40, 524288
    v_mfma_f32_16x16x32_bf16 v[128:131], v[16:19], v[64:67], v[128:131]
    v_mfma_f32_16x16x32_bf16 v[144:147], v[16:19], v[68:71], v[144:147]
    v_mfma_f32_16x16x32_bf16 v[160:163], v[16:19], v[72:75], v[160:163]
    s_add_u32 m0, s42, 12288
    v_mfma_f32_16x16x32_bf16 v[176:179], v[16:19], v[76:79], v[176:179]
    buffer_load_dwordx4 v5, s[12:15], s41 offen offset:0 lds
    v_mfma_f32_16x16x32_bf16 v[192:195], v[16:19], v[80:83], v[192:195]
    v_mfma_f32_16x16x32_bf16 v[208:211], v[16:19], v[84:87], v[208:211]
    buffer_load_dwordx4 v6, s[12:15], s41 offen offset:1024 lds
    v_mfma_f32_16x16x32_bf16 v[224:227], v[16:19], v[88:91], v[224:227]
    s_barrier
    v_mfma_f32_16x16x32_bf16 v[240:243], v[16:19], v[92:95], v[240:243]
    s_waitcnt lgkmcnt(4)
    v_mfma_f32_16x16x32_bf16 v[132:135], v[20:23], v[64:67], v[132:135]
    ds_read_b64_tr_b16 v[16:17], v9 offset:20480
    v_mfma_f32_16x16x32_bf16 v[148:151], v[20:23], v[68:71], v[148:151]
    ds_read_b64_tr_b16 v[18:19], v9 offset:22528
    v_mfma_f32_16x16x32_bf16 v[164:167], v[20:23], v[72:75], v[164:167]
    v_mfma_f32_16x16x32_bf16 v[180:183], v[20:23], v[76:79], v[180:183]
    buffer_load_dwordx4 v7, s[12:15], s41 offen offset:2048 lds
    v_mfma_f32_16x16x32_bf16 v[196:199], v[20:23], v[80:83], v[196:199]
    v_mfma_f32_16x16x32_bf16 v[212:215], v[20:23], v[84:87], v[212:215]
    buffer_load_dwordx4 v8, s[12:15], s41 offen offset:3072 lds
    v_mfma_f32_16x16x32_bf16 v[228:231], v[20:23], v[88:91], v[228:231]
    s_add_u32 s41, s41, 262144
    v_mfma_f32_16x16x32_bf16 v[244:247], v[20:23], v[92:95], v[244:247]
    s_waitcnt lgkmcnt(4)
    v_mfma_f32_16x16x32_bf16 v[136:139], v[24:27], v[64:67], v[136:139]
    ds_read_b64_tr_b16 v[20:21], v10 offset:20480
    v_mfma_f32_16x16x32_bf16 v[152:155], v[24:27], v[68:71], v[152:155]
    ds_read_b64_tr_b16 v[22:23], v10 offset:22528
    v_mfma_f32_16x16x32_bf16 v[168:171], v[24:27], v[72:75], v[168:171]
    v_mfma_f32_16x16x32_bf16 v[184:187], v[24:27], v[76:79], v[184:187]
    v_mfma_f32_16x16x32_bf16 v[200:203], v[24:27], v[80:83], v[200:203]
    v_mfma_f32_16x16x32_bf16 v[216:219], v[24:27], v[84:87], v[216:219]
    v_mfma_f32_16x16x32_bf16 v[232:235], v[24:27], v[88:91], v[232:235]
    v_mfma_f32_16x16x32_bf16 v[248:251], v[24:27], v[92:95], v[248:251]
    s_waitcnt lgkmcnt(4)
    v_mfma_f32_16x16x32_bf16 v[140:143], v[28:31], v[64:67], v[140:143]
    buffer_load_dwordx4 v[64:67], v1, s[8:11], s40 offen offset:0
    ds_read_b64_tr_b16 v[24:25], v11 offset:20480
    v_mfma_f32_16x16x32_bf16 v[156:159], v[28:31], v[68:71], v[156:159]
    buffer_load_dwordx4 v[68:71], v1, s[8:11], s40 offen offset:1024
    ds_read_b64_tr_b16 v[26:27], v11 offset:22528
    v_mfma_f32_16x16x32_bf16 v[172:175], v[28:31], v[72:75], v[172:175]
    buffer_load_dwordx4 v[72:75], v2, s[8:11], s40 offen offset:0
    v_mfma_f32_16x16x32_bf16 v[188:191], v[28:31], v[76:79], v[188:191]
    buffer_load_dwordx4 v[76:79], v2, s[8:11], s40 offen offset:1024
    v_mfma_f32_16x16x32_bf16 v[204:207], v[28:31], v[80:83], v[204:207]
    buffer_load_dwordx4 v[80:83], v3, s[8:11], s40 offen offset:0
    v_mfma_f32_16x16x32_bf16 v[220:223], v[28:31], v[84:87], v[220:223]
    buffer_load_dwordx4 v[84:87], v3, s[8:11], s40 offen offset:1024
    v_mfma_f32_16x16x32_bf16 v[236:239], v[28:31], v[88:91], v[236:239]
    buffer_load_dwordx4 v[88:91], v4, s[8:11], s40 offen offset:0
    v_mfma_f32_16x16x32_bf16 v[252:255], v[28:31], v[92:95], v[252:255]
    buffer_load_dwordx4 v[92:95], v4, s[8:11], s40 offen offset:1024
    s_waitcnt vmcnt(24) lgkmcnt(4)
    ds_read_b64_tr_b16 v[28:29], v12 offset:20480
    ds_read_b64_tr_b16 v[30:31], v12 offset:22528
    s_add_u32 s40, s40, 524288
    v_mfma_f32_16x16x32_bf16 v[128:131], v[16:19], v[96:99], v[128:131]
    v_mfma_f32_16x16x32_bf16 v[144:147], v[16:19], v[100:103], v[144:147]
    v_mfma_f32_16x16x32_bf16 v[160:163], v[16:19], v[104:107], v[160:163]
    s_add_u32 m0, s42, 16384
    v_mfma_f32_16x16x32_bf16 v[176:179], v[16:19], v[108:111], v[176:179]
    buffer_load_dwordx4 v5, s[12:15], s41 offen offset:0 lds
    v_mfma_f32_16x16x32_bf16 v[192:195], v[16:19], v[112:115], v[192:195]
    v_mfma_f32_16x16x32_bf16 v[208:211], v[16:19], v[116:119], v[208:211]
    buffer_load_dwordx4 v6, s[12:15], s41 offen offset:1024 lds
    v_mfma_f32_16x16x32_bf16 v[224:227], v[16:19], v[120:123], v[224:227]
    v_mfma_f32_16x16x32_bf16 v[240:243], v[16:19], v[124:127], v[240:243]
    s_waitcnt lgkmcnt(4)
    v_mfma_f32_16x16x32_bf16 v[132:135], v[20:23], v[96:99], v[132:135]
    ds_read_b64_tr_b16 v[16:17], v9 offset:0
    v_mfma_f32_16x16x32_bf16 v[148:151], v[20:23], v[100:103], v[148:151]
    ds_read_b64_tr_b16 v[18:19], v9 offset:2048
    v_mfma_f32_16x16x32_bf16 v[164:167], v[20:23], v[104:107], v[164:167]
    v_mfma_f32_16x16x32_bf16 v[180:183], v[20:23], v[108:111], v[180:183]
    buffer_load_dwordx4 v7, s[12:15], s41 offen offset:2048 lds
    v_mfma_f32_16x16x32_bf16 v[196:199], v[20:23], v[112:115], v[196:199]
    v_mfma_f32_16x16x32_bf16 v[212:215], v[20:23], v[116:119], v[212:215]
    buffer_load_dwordx4 v8, s[12:15], s41 offen offset:3072 lds
    v_mfma_f32_16x16x32_bf16 v[228:231], v[20:23], v[120:123], v[228:231]
    s_add_u32 s41, s41, 262144
    v_mfma_f32_16x16x32_bf16 v[244:247], v[20:23], v[124:127], v[244:247]
    s_waitcnt lgkmcnt(4)
    v_mfma_f32_16x16x32_bf16 v[136:139], v[24:27], v[96:99], v[136:139]
    ds_read_b64_tr_b16 v[20:21], v10 offset:0
    v_mfma_f32_16x16x32_bf16 v[152:155], v[24:27], v[100:103], v[152:155]
    ds_read_b64_tr_b16 v[22:23], v10 offset:2048
    v_mfma_f32_16x16x32_bf16 v[168:171], v[24:27], v[104:107], v[168:171]
    v_mfma_f32_16x16x32_bf16 v[184:187], v[24:27], v[108:111], v[184:187]
    v_mfma_f32_16x16x32_bf16 v[200:203], v[24:27], v[112:115], v[200:203]
    s_barrier
    v_mfma_f32_16x16x32_bf16 v[216:219], v[24:27], v[116:119], v[216:219]
    v_mfma_f32_16x16x32_bf16 v[232:235], v[24:27], v[120:123], v[232:235]
    v_mfma_f32_16x16x32_bf16 v[248:251], v[24:27], v[124:127], v[248:251]
    s_waitcnt lgkmcnt(4)
    v_mfma_f32_16x16x32_bf16 v[140:143], v[28:31], v[96:99], v[140:143]
    buffer_load_dwordx4 v[96:99], v1, s[8:11], s40 offen offset:0
    ds_read_b64_tr_b16 v[24:25], v11 offset:0
    v_mfma_f32_16x16x32_bf16 v[156:159], v[28:31], v[100:103], v[156:159]
    buffer_load_dwordx4 v[100:103], v1, s[8:11], s40 offen offset:1024
    ds_read_b64_tr_b16 v[26:27], v11 offset:2048
    v_mfma_f32_16x16x32_bf16 v[172:175], v[28:31], v[104:107], v[172:175]
    buffer_load_dwordx4 v[104:107], v2, s[8:11], s40 offen offset:0
    v_mfma_f32_16x16x32_bf16 v[188:191], v[28:31], v[108:111], v[188:191]
    buffer_load_dwordx4 v[108:111], v2, s[8:11], s40 offen offset:1024
    v_mfma_f32_16x16x32_bf16 v[204:207], v[28:31], v[112:115], v[204:207]
    buffer_load_dwordx4 v[112:115], v3, s[8:11], s40 offen offset:0
    v_mfma_f32_16x16x32_bf16 v[220:223], v[28:31], v[116:119], v[220:223]
    buffer_load_dwordx4 v[116:119], v3, s[8:11], s40 offen offset:1024
    v_mfma_f32_16x16x32_bf16 v[236:239], v[28:31], v[120:123], v[236:239]
    buffer_load_dwordx4 v[120:123], v4, s[8:11], s40 offen offset:0
    v_mfma_f32_16x16x32_bf16 v[252:255], v[28:31], v[124:127], v[252:255]
    buffer_load_dwordx4 v[124:127], v4, s[8:11], s40 offen offset:1024
    s_waitcnt vmcnt(24) lgkmcnt(4)
    ds_read_b64_tr_b16 v[28:29], v12 offset:0
    ds_read_b64_tr_b16 v[30:31], v12 offset:2048
    s_add_u32 s40, s40, 524288
    v_mfma_f32_16x16x32_bf16 v[128:131], v[16:19], v[32:35], v[128:131]
    v_mfma_f32_16x16x32_bf16 v[144:147], v[16:19], v[36:39], v[144:147]
    v_mfma_f32_16x16x32_bf16 v[160:163], v[16:19], v[40:43], v[160:163]
    s_add_u32 m0, s42, 20480
    v_mfma_f32_16x16x32_bf16 v[176:179], v[16:19], v[44:47], v[176:179]
    buffer_load_dwordx4 v5, s[12:15], s41 offen offset:0 lds
    v_mfma_f32_16x16x32_bf16 v[192:195], v[16:19], v[48:51], v[192:195]
    v_mfma_f32_16x16x32_bf16 v[208:211], v[16:19], v[52:55], v[208:211]
    buffer_load_dwordx4 v6, s[12:15], s41 offen offset:1024 lds
    v_mfma_f32_16x16x32_bf16 v[224:227], v[16:19], v[56:59], v[224:227]
    v_mfma_f32_16x16x32_bf16 v[240:243], v[16:19], v[60:63], v[240:243]
    s_waitcnt lgkmcnt(4)
    v_mfma_f32_16x16x32_bf16 v[132:135], v[20:23], v[32:35], v[132:135]
    ds_read_b64_tr_b16 v[16:17], v9 offset:4096
    v_mfma_f32_16x16x32_bf16 v[148:151], v[20:23], v[36:39], v[148:151]
    ds_read_b64_tr_b16 v[18:19], v9 offset:6144
    v_mfma_f32_16x16x32_bf16 v[164:167], v[20:23], v[40:43], v[164:167]
    v_mfma_f32_16x16x32_bf16 v[180:183], v[20:23], v[44:47], v[180:183]
    buffer_load_dwordx4 v7, s[12:15], s41 offen offset:2048 lds
    v_mfma_f32_16x16x32_bf16 v[196:199], v[20:23], v[48:51], v[196:199]
    v_mfma_f32_16x16x32_bf16 v[212:215], v[20:23], v[52:55], v[212:215]
    buffer_load_dwordx4 v8, s[12:15], s41 offen offset:3072 lds
    v_mfma_f32_16x16x32_bf16 v[228:231], v[20:23], v[56:59], v[228:231]
    s_add_u32 s41, s41, 262144
    v_mfma_f32_16x16x32_bf16 v[244:247], v[20:23], v[60:63], v[244:247]
    s_waitcnt lgkmcnt(4)
    v_mfma_f32_16x16x32_bf16 v[136:139], v[24:27], v[32:35], v[136:139]
    ds_read_b64_tr_b16 v[20:21], v10 offset:4096
    v_mfma_f32_16x16x32_bf16 v[152:155], v[24:27], v[36:39], v[152:155]
    ds_read_b64_tr_b16 v[22:23], v10 offset:6144
    v_mfma_f32_16x16x32_bf16 v[168:171], v[24:27], v[40:43], v[168:171]
    v_mfma_f32_16x16x32_bf16 v[184:187], v[24:27], v[44:47], v[184:187]
    v_mfma_f32_16x16x32_bf16 v[200:203], v[24:27], v[48:51], v[200:203]
    v_mfma_f32_16x16x32_bf16 v[216:219], v[24:27], v[52:55], v[216:219]
    v_mfma_f32_16x16x32_bf16 v[232:235], v[24:27], v[56:59], v[232:235]
    v_mfma_f32_16x16x32_bf16 v[248:251], v[24:27], v[60:63], v[248:251]
    s_waitcnt lgkmcnt(4)
    v_mfma_f32_16x16x32_bf16 v[140:143], v[28:31], v[32:35], v[140:143]
    buffer_load_dwordx4 v[32:35], v1, s[8:11], s40 offen offset:0
    ds_read_b64_tr_b16 v[24:25], v11 offset:4096
    v_mfma_f32_16x16x32_bf16 v[156:159], v[28:31], v[36:39], v[156:159]
    buffer_load_dwordx4 v[36:39], v1, s[8:11], s40 offen offset:1024
    ds_read_b64_tr_b16 v[26:27], v11 offset:6144
    v_mfma_f32_16x16x32_bf16 v[172:175], v[28:31], v[40:43], v[172:175]
    buffer_load_dwordx4 v[40:43], v2, s[8:11], s40 offen offset:0
    v_mfma_f32_16x16x32_bf16 v[188:191], v[28:31], v[44:47], v[188:191]
    buffer_load_dwordx4 v[44:47], v2, s[8:11], s40 offen offset:1024
    v_mfma_f32_16x16x32_bf16 v[204:207], v[28:31], v[48:51], v[204:207]
    buffer_load_dwordx4 v[48:51], v3, s[8:11], s40 offen offset:0
    v_mfma_f32_16x16x32_bf16 v[220:223], v[28:31], v[52:55], v[220:223]
    buffer_load_dwordx4 v[52:55], v3, s[8:11], s40 offen offset:1024
    v_mfma_f32_16x16x32_bf16 v[236:239], v[28:31], v[56:59], v[236:239]
    buffer_load_dwordx4 v[56:59], v4, s[8:11], s40 offen offset:0
    v_mfma_f32_16x16x32_bf16 v[252:255], v[28:31], v[60:63], v[252:255]
    buffer_load_dwordx4 v[60:63], v4, s[8:11], s40 offen offset:1024
    s_waitcnt vmcnt(24) lgkmcnt(4)
    ds_read_b64_tr_b16 v[28:29], v12 offset:4096
    ds_read_b64_tr_b16 v[30:31], v12 offset:6144
    s_add_u32 s40, s40, 524288
    v_mfma_f32_16x16x32_bf16 v[128:131], v[16:19], v[64:67], v[128:131]
    v_mfma_f32_16x16x32_bf16 v[144:147], v[16:19], v[68:71], v[144:147]
    s_barrier
    v_mfma_f32_16x16x32_bf16 v[160:163], v[16:19], v[72:75], v[160:163]
    s_add_u32 m0, s42, 0
    v_mfma_f32_16x16x32_bf16 v[176:179], v[16:19], v[76:79], v[176:179]
    buffer_load_dwordx4 v5, s[12:15], s41 offen offset:0 lds
    v_mfma_f32_16x16x32_bf16 v[192:195], v[16:19], v[80:83], v[192:195]
    v_mfma_f32_16x16x32_bf16 v[208:211], v[16:19], v[84:87], v[208:211]
    buffer_load_dwordx4 v6, s[12:15], s41 offen offset:1024 lds
    v_mfma_f32_16x16x32_bf16 v[224:227], v[16:19], v[88:91], v[224:227]
    v_mfma_f32_16x16x32_bf16 v[240:243], v[16:19], v[92:95], v[240:243]
    s_waitcnt lgkmcnt(4)
    v_mfma_f32_16x16x32_bf16 v[132:135], v[20:23], v[64:67], v[132:135]
    ds_read_b64_tr_b16 v[16:17], v9 offset:8192
    v_mfma_f32_16x16x32_bf16 v[148:151], v[20:23], v[68:71], v[148:151]
    ds_read_b64_tr_b16 v[18:19], v9 offset:10240
    v_mfma_f32_16x16x32_bf16 v[164:167], v[20:23], v[72:75], v[164:167]
    v_mfma_f32_16x16x32_bf16 v[180:183], v[20:23], v[76:79], v[180:183]
    buffer_load_dwordx4 v7, s[12:15], s41 offen offset:2048 lds
    v_mfma_f32_16x16x32_bf16 v[196:199], v[20:23], v[80:83], v[196:199]
    v_mfma_f32_16x16x32_bf16 v[212:215], v[20:23], v[84:87], v[212:215]
    buffer_load_dwordx4 v8, s[12:15], s41 offen offset:3072 lds
    v_mfma_f32_16x16x32_bf16 v[228:231], v[20:23], v[88:91], v[228:231]
    s_add_u32 s41, s41, 262144
    v_mfma_f32_16x16x32_bf16 v[244:247], v[20:23], v[92:95], v[244:247]
    s_waitcnt lgkmcnt(4)
    v_mfma_f32_16x16x32_bf16 v[136:139], v[24:27], v[64:67], v[136:139]
    ds_read_b64_tr_b16 v[20:21], v10 offset:8192
    v_mfma_f32_16x16x32_bf16 v[152:155], v[24:27], v[68:71], v[152:155]
    ds_read_b64_tr_b16 v[22:23], v10 offset:10240
    v_mfma_f32_16x16x32_bf16 v[168:171], v[24:27], v[72:75], v[168:171]
    v_mfma_f32_16x16x32_bf16 v[184:187], v[24:27], v[76:79], v[184:187]
    v_mfma_f32_16x16x32_bf16 v[200:203], v[24:27], v[80:83], v[200:203]
    v_mfma_f32_16x16x32_bf16 v[216:219], v[24:27], v[84:87], v[216:219]
    v_mfma_f32_16x16x32_bf16 v[232:235], v[24:27], v[88:91], v[232:235]
    v_mfma_f32_16x16x32_bf16 v[248:251], v[24:27], v[92:95], v[248:251]
    s_waitcnt lgkmcnt(4)
    v_mfma_f32_16x16x32_bf16 v[140:143], v[28:31], v[64:67], v[140:143]
    buffer_load_dwordx4 v[64:67], v1, s[8:11], s40 offen offset:0
    ds_read_b64_tr_b16 v[24:25], v11 offset:8192
    v_mfma_f32_16x16x32_bf16 v[156:159], v[28:31], v[68:71], v[156:159]
    buffer_load_dwordx4 v[68:71], v1, s[8:11], s40 offen offset:1024
    ds_read_b64_tr_b16 v[26:27], v11 offset:10240
    v_mfma_f32_16x16x32_bf16 v[172:175], v[28:31], v[72:75], v[172:175]
    buffer_load_dwordx4 v[72:75], v2, s[8:11], s40 offen offset:0
    v_mfma_f32_16x16x32_bf16 v[188:191], v[28:31], v[76:79], v[188:191]
    buffer_load_dwordx4 v[76:79], v2, s[8:11], s40 offen offset:1024
    v_mfma_f32_16x16x32_bf16 v[204:207], v[28:31], v[80:83], v[204:207]
    buffer_load_dwordx4 v[80:83], v3, s[8:11], s40 offen offset:0
    v_mfma_f32_16x16x32_bf16 v[220:223], v[28:31], v[84:87], v[220:223]
    buffer_load_dwordx4 v[84:87], v3, s[8:11], s40 offen offset:1024
    v_mfma_f32_16x16x32_bf16 v[236:239], v[28:31], v[88:91], v[236:239]
    buffer_load_dwordx4 v[88:91], v4, s[8:11], s40 offen offset:0
    v_mfma_f32_16x16x32_bf16 v[252:255], v[28:31], v[92:95], v[252:255]
    buffer_load_dwordx4 v[92:95], v4, s[8:11], s40 offen offset:1024
    s_waitcnt vmcnt(24) lgkmcnt(4)
    ds_read_b64_tr_b16 v[28:29], v12 offset:8192
    ds_read_b64_tr_b16 v[30:31], v12 offset:10240
    s_add_u32 s40, s40, 524288
    v_mfma_f32_16x16x32_bf16 v[128:131], v[16:19], v[96:99], v[128:131]
    v_mfma_f32_16x16x32_bf16 v[144:147], v[16:19], v[100:103], v[144:147]
    v_mfma_f32_16x16x32_bf16 v[160:163], v[16:19], v[104:107], v[160:163]
    s_add_u32 m0, s42, 4096
    v_mfma_f32_16x16x32_bf16 v[176:179], v[16:19], v[108:111], v[176:179]
    buffer_load_dwordx4 v5, s[12:15], s41 offen offset:0 lds
    v_mfma_f32_16x16x32_bf16 v[192:195], v[16:19], v[112:115], v[192:195]
    v_mfma_f32_16x16x32_bf16 v[208:211], v[16:19], v[116:119], v[208:211]
    buffer_load_dwordx4 v6, s[12:15], s41 offen offset:1024 lds
    v_mfma_f32_16x16x32_bf16 v[224:227], v[16:19], v[120:123], v[224:227]
    v_mfma_f32_16x16x32_bf16 v[240:243], v[16:19], v[124:127], v[240:243]
    s_waitcnt lgkmcnt(4)
    v_mfma_f32_16x16x32_bf16 v[132:135], v[20:23], v[96:99], v[132:135]
    ds_read_b64_tr_b16 v[16:17], v9 offset:12288
    v_mfma_f32_16x16x32_bf16 v[148:151], v[20:23], v[100:103], v[148:151]
    ds_read_b64_tr_b16 v[18:19], v9 offset:14336
    v_mfma_f32_16x16x32_bf16 v[164:167], v[20:23], v[104:107], v[164:167]
    v_mfma_f32_16x16x32_bf16 v[180:183], v[20:23], v[108:111], v[180:183]
    buffer_load_dwordx4 v7, s[12:15], s41 offen offset:2048 lds
    v_mfma_f32_16x16x32_bf16 v[196:199], v[20:23], v[112:115], v[196:199]
    v_mfma_f32_16x16x32_bf16 v[212:215], v[20:23], v[116:119], v[212:215]
    buffer_load_dwordx4 v8, s[12:15], s41 offen offset:3072 lds
    v_mfma_f32_16x16x32_bf16 v[228:231], v[20:23], v[120:123], v[228:231]
    s_add_u32 s41, s41, 262144
    v_mfma_f32_16x16x32_bf16 v[244:247], v[20:23], v[124:127], v[244:247]
    s_waitcnt lgkmcnt(4)
    s_barrier
    v_mfma_f32_16x16x32_bf16 v[136:139], v[24:27], v[96:99], v[136:139]
    ds_read_b64_tr_b16 v[20:21], v10 offset:12288
    v_mfma_f32_16x16x32_bf16 v[152:155], v[24:27], v[100:103], v[152:155]
    ds_read_b64_tr_b16 v[22:23], v10 offset:14336
    v_mfma_f32_16x16x32_bf16 v[168:171], v[24:27], v[104:107], v[168:171]
    v_mfma_f32_16x16x32_bf16 v[184:187], v[24:27], v[108:111], v[184:187]
    v_mfma_f32_16x16x32_bf16 v[200:203], v[24:27], v[112:115], v[200:203]
    v_mfma_f32_16x16x32_bf16 v[216:219], v[24:27], v[116:119], v[216:219]
    v_mfma_f32_16x16x32_bf16 v[232:235], v[24:27], v[120:123], v[232:235]
    v_mfma_f32_16x16x32_bf16 v[248:251], v[24:27], v[124:127], v[248:251]
    s_waitcnt lgkmcnt(4)
    v_mfma_f32_16x16x32_bf16 v[140:143], v[28:31], v[96:99], v[140:143]
    buffer_load_dwordx4 v[96:99], v1, s[8:11], s40 offen offset:0
    ds_read_b64_tr_b16 v[24:25], v11 offset:12288
    v_mfma_f32_16x16x32_bf16 v[156:159], v[28:31], v[100:103], v[156:159]
    buffer_load_dwordx4 v[100:103], v1, s[8:11], s40 offen offset:1024
    ds_read_b64_tr_b16 v[26:27], v11 offset:14336
    v_mfma_f32_16x16x32_bf16 v[172:175], v[28:31], v[104:107], v[172:175]
    buffer_load_dwordx4 v[104:107], v2, s[8:11], s40 offen offset:0
    v_mfma_f32_16x16x32_bf16 v[188:191], v[28:31], v[108:111], v[188:191]
    buffer_load_dwordx4 v[108:111], v2, s[8:11], s40 offen offset:1024
    v_mfma_f32_16x16x32_bf16 v[204:207], v[28:31], v[112:115], v[204:207]
    buffer_load_dwordx4 v[112:115], v3, s[8:11], s40 offen offset:0
    v_mfma_f32_16x16x32_bf16 v[220:223], v[28:31], v[116:119], v[220:223]
    buffer_load_dwordx4 v[116:119], v3, s[8:11], s40 offen offset:1024
    v_mfma_f32_16x16x32_bf16 v[236:239], v[28:31], v[120:123], v[236:239]
    buffer_load_dwordx4 v[120:123], v4, s[8:11], s40 offen offset:0
    v_mfma_f32_16x16x32_bf16 v[252:255], v[28:31], v[124:127], v[252:255]
    buffer_load_dwordx4 v[124:127], v4, s[8:11], s40 offen offset:1024
    s_waitcnt vmcnt(24) lgkmcnt(4)
    ds_read_b64_tr_b16 v[28:29], v12 offset:12288
    ds_read_b64_tr_b16 v[30:31], v12 offset:14336
    s_add_u32 s40, s40, 524288
    v_mfma_f32_16x16x32_bf16 v[128:131], v[16:19], v[32:35], v[128:131]
    v_mfma_f32_16x16x32_bf16 v[144:147], v[16:19], v[36:39], v[144:147]
    v_mfma_f32_16x16x32_bf16 v[160:163], v[16:19], v[40:43], v[160:163]
    s_add_u32 m0, s42, 8192
    v_mfma_f32_16x16x32_bf16 v[176:179], v[16:19], v[44:47], v[176:179]
    buffer_load_dwordx4 v5, s[12:15], s41 offen offset:0 lds
    v_mfma_f32_16x16x32_bf16 v[192:195], v[16:19], v[48:51], v[192:195]
    v_mfma_f32_16x16x32_bf16 v[208:211], v[16:19], v[52:55], v[208:211]
    buffer_load_dwordx4 v6, s[12:15], s41 offen offset:1024 lds
    v_mfma_f32_16x16x32_bf16 v[224:227], v[16:19], v[56:59], v[224:227]
    v_mfma_f32_16x16x32_bf16 v[240:243], v[16:19], v[60:63], v[240:243]
    s_waitcnt lgkmcnt(4)
    v_mfma_f32_16x16x32_bf16 v[132:135], v[20:23], v[32:35], v[132:135]
    ds_read_b64_tr_b16 v[16:17], v9 offset:16384
    v_mfma_f32_16x16x32_bf16 v[148:151], v[20:23], v[36:39], v[148:151]
    ds_read_b64_tr_b16 v[18:19], v9 offset:18432
    v_mfma_f32_16x16x32_bf16 v[164:167], v[20:23], v[40:43], v[164:167]
    v_mfma_f32_16x16x32_bf16 v[180:183], v[20:23], v[44:47], v[180:183]
    buffer_load_dwordx4 v7, s[12:15], s41 offen offset:2048 lds
    v_mfma_f32_16x16x32_bf16 v[196:199], v[20:23], v[48:51], v[196:199]
    v_mfma_f32_16x16x32_bf16 v[212:215], v[20:23], v[52:55], v[212:215]
    buffer_load_dwordx4 v8, s[12:15], s41 offen offset:3072 lds
    v_mfma_f32_16x16x32_bf16 v[228:231], v[20:23], v[56:59], v[228:231]
    s_add_u32 s41, s41, 262144
    v_mfma_f32_16x16x32_bf16 v[244:247], v[20:23], v[60:63], v[244:247]
    s_waitcnt lgkmcnt(4)
    v_mfma_f32_16x16x32_bf16 v[136:139], v[24:27], v[32:35], v[136:139]
    ds_read_b64_tr_b16 v[20:21], v10 offset:16384
    v_mfma_f32_16x16x32_bf16 v[152:155], v[24:27], v[36:39], v[152:155]
    ds_read_b64_tr_b16 v[22:23], v10 offset:18432
    v_mfma_f32_16x16x32_bf16 v[168:171], v[24:27], v[40:43], v[168:171]
    v_mfma_f32_16x16x32_bf16 v[184:187], v[24:27], v[44:47], v[184:187]
    v_mfma_f32_16x16x32_bf16 v[200:203], v[24:27], v[48:51], v[200:203]
    v_mfma_f32_16x16x32_bf16 v[216:219], v[24:27], v[52:55], v[216:219]
    v_mfma_f32_16x16x32_bf16 v[232:235], v[24:27], v[56:59], v[232:235]
    v_mfma_f32_16x16x32_bf16 v[248:251], v[24:27], v[60:63], v[248:251]
    s_waitcnt lgkmcnt(4)
    v_mfma_f32_16x16x32_bf16 v[140:143], v[28:31], v[32:35], v[140:143]
    buffer_load_dwordx4 v[32:35], v1, s[8:11], s40 offen offset:0
    ds_read_b64_tr_b16 v[24:25], v11 offset:16384
    v_mfma_f32_16x16x32_bf16 v[156:159], v[28:31], v[36:39], v[156:159]
    buffer_load_dwordx4 v[36:39], v1, s[8:11], s40 offen offset:1024
    ds_read_b64_tr_b16 v[26:27], v11 offset:18432
    v_mfma_f32_16x16x32_bf16 v[172:175], v[28:31], v[40:43], v[172:175]
    buffer_load_dwordx4 v[40:43], v2, s[8:11], s40 offen offset:0
    v_mfma_f32_16x16x32_bf16 v[188:191], v[28:31], v[44:47], v[188:191]
    buffer_load_dwordx4 v[44:47], v2, s[8:11], s40 offen offset:1024
    v_mfma_f32_16x16x32_bf16 v[204:207], v[28:31], v[48:51], v[204:207]
    buffer_load_dwordx4 v[48:51], v3, s[8:11], s40 offen offset:0
    v_mfma_f32_16x16x32_bf16 v[220:223], v[28:31], v[52:55], v[220:223]
    buffer_load_dwordx4 v[52:55], v3, s[8:11], s40 offen offset:1024
    v_mfma_f32_16x16x32_bf16 v[236:239], v[28:31], v[56:59], v[236:239]
    buffer_load_dwordx4 v[56:59], v4, s[8:11], s40 offen offset:0
    v_mfma_f32_16x16x32_bf16 v[252:255], v[28:31], v[60:63], v[252:255]
    buffer_load_dwordx4 v[60:63], v4, s[8:11], s40 offen offset:1024
    s_waitcnt vmcnt(24) lgkmcnt(4)
    ds_read_b64_tr_b16 v[28:29], v12 offset:16384
    ds_read_b64_tr_b16 v[30:31], v12 offset:18432
    s_add_u32 s40, s40, 524288
    v_mfma_f32_16x16x32_bf16 v[128:131], v[16:19], v[64:67], v[128:131]
    v_mfma_f32_16x16x32_bf16 v[144:147], v[16:19], v[68:71], v[144:147]
    v_mfma_f32_16x16x32_bf16 v[160:163], v[16:19], v[72:75], v[160:163]
    s_add_u32 m0, s42, 12288
    v_mfma_f32_16x16x32_bf16 v[176:179], v[16:19], v[76:79], v[176:179]
    buffer_load_dwordx4 v5, s[12:15], s41 offen offset:0 lds
    v_mfma_f32_16x16x32_bf16 v[192:195], v[16:19], v[80:83], v[192:195]
    v_mfma_f32_16x16x32_bf16 v[208:211], v[16:19], v[84:87], v[208:211]
    buffer_load_dwordx4 v6, s[12:15], s41 offen offset:1024 lds
    v_mfma_f32_16x16x32_bf16 v[224:227], v[16:19], v[88:91], v[224:227]
    v_mfma_f32_16x16x32_bf16 v[240:243], v[16:19], v[92:95], v[240:243]
    s_waitcnt lgkmcnt(4)
    v_mfma_f32_16x16x32_bf16 v[132:135], v[20:23], v[64:67], v[132:135]
    ds_read_b64_tr_b16 v[16:17], v9 offset:20480
    v_mfma_f32_16x16x32_bf16 v[148:151], v[20:23], v[68:71], v[148:151]
    ds_read_b64_tr_b16 v[18:19], v9 offset:22528
    v_mfma_f32_16x16x32_bf16 v[164:167], v[20:23], v[72:75], v[164:167]
    v_mfma_f32_16x16x32_bf16 v[180:183], v[20:23], v[76:79], v[180:183]
    buffer_load_dwordx4 v7, s[12:15], s41 offen offset:2048 lds
    v_mfma_f32_16x16x32_bf16 v[196:199], v[20:23], v[80:83], v[196:199]
    v_mfma_f32_16x16x32_bf16 v[212:215], v[20:23], v[84:87], v[212:215]
    buffer_load_dwordx4 v8, s[12:15], s41 offen offset:3072 lds
    v_mfma_f32_16x16x32_bf16 v[228:231], v[20:23], v[88:91], v[228:231]
    s_lshl_b32 s41, s64, 16
    v_mfma_f32_16x16x32_bf16 v[244:247], v[20:23], v[92:95], v[244:247]
    s_waitcnt lgkmcnt(4)
    v_mfma_f32_16x16x32_bf16 v[136:139], v[24:27], v[64:67], v[136:139]
    ds_read_b64_tr_b16 v[20:21], v10 offset:20480
    v_mfma_f32_16x16x32_bf16 v[152:155], v[24:27], v[68:71], v[152:155]
    ds_read_b64_tr_b16 v[22:23], v10 offset:22528
    v_mfma_f32_16x16x32_bf16 v[168:171], v[24:27], v[72:75], v[168:171]
    v_mfma_f32_16x16x32_bf16 v[184:187], v[24:27], v[76:79], v[184:187]
    v_mfma_f32_16x16x32_bf16 v[200:203], v[24:27], v[80:83], v[200:203]
    v_mfma_f32_16x16x32_bf16 v[216:219], v[24:27], v[84:87], v[216:219]
    v_mfma_f32_16x16x32_bf16 v[232:235], v[24:27], v[88:91], v[232:235]
    v_mfma_f32_16x16x32_bf16 v[248:251], v[24:27], v[92:95], v[248:251]
    s_waitcnt lgkmcnt(4)
    v_mfma_f32_16x16x32_bf16 v[140:143], v[28:31], v[64:67], v[140:143]
    buffer_load_dwordx4 v[64:67], v1, s[8:11], s40 offen offset:0
    ds_read_b64_tr_b16 v[24:25], v11 offset:20480
    v_mfma_f32_16x16x32_bf16 v[156:159], v[28:31], v[68:71], v[156:159]
    buffer_load_dwordx4 v[68:71], v1, s[8:11], s40 offen offset:1024
    ds_read_b64_tr_b16 v[26:27], v11 offset:22528
    v_mfma_f32_16x16x32_bf16 v[172:175], v[28:31], v[72:75], v[172:175]
    buffer_load_dwordx4 v[72:75], v2, s[8:11], s40 offen offset:0
    v_mfma_f32_16x16x32_bf16 v[188:191], v[28:31], v[76:79], v[188:191]
    buffer_load_dwordx4 v[76:79], v2, s[8:11], s40 offen offset:1024
    v_mfma_f32_16x16x32_bf16 v[204:207], v[28:31], v[80:83], v[204:207]
    buffer_load_dwordx4 v[80:83], v3, s[8:11], s40 offen offset:0
    v_mfma_f32_16x16x32_bf16 v[220:223], v[28:31], v[84:87], v[220:223]
    buffer_load_dwordx4 v[84:87], v3, s[8:11], s40 offen offset:1024
    v_mfma_f32_16x16x32_bf16 v[236:239], v[28:31], v[88:91], v[236:239]
    buffer_load_dwordx4 v[88:91], v4, s[8:11], s40 offen offset:0
    v_mfma_f32_16x16x32_bf16 v[252:255], v[28:31], v[92:95], v[252:255]
    buffer_load_dwordx4 v[92:95], v4, s[8:11], s40 offen offset:1024
    s_waitcnt vmcnt(24) lgkmcnt(4)
    ds_read_b64_tr_b16 v[28:29], v12 offset:20480
    ds_read_b64_tr_b16 v[30:31], v12 offset:22528
    s_add_u32 s40, s40, 524288
    v_mfma_f32_16x16x32_bf16 v[128:131], v[16:19], v[96:99], v[128:131]
    v_mfma_f32_16x16x32_bf16 v[144:147], v[16:19], v[100:103], v[144:147]
    v_mfma_f32_16x16x32_bf16 v[160:163], v[16:19], v[104:107], v[160:163]
    s_add_u32 m0, s42, 16384
    v_mfma_f32_16x16x32_bf16 v[176:179], v[16:19], v[108:111], v[176:179]
    buffer_load_dwordx4 v5, s[16:19], s41 offen offset:0 lds
    v_mfma_f32_16x16x32_bf16 v[192:195], v[16:19], v[112:115], v[192:195]
    v_mfma_f32_16x16x32_bf16 v[208:211], v[16:19], v[116:119], v[208:211]
    buffer_load_dwordx4 v6, s[16:19], s41 offen offset:1024 lds
    v_mfma_f32_16x16x32_bf16 v[224:227], v[16:19], v[120:123], v[224:227]
    v_mfma_f32_16x16x32_bf16 v[240:243], v[16:19], v[124:127], v[240:243]
    s_waitcnt lgkmcnt(4)
    v_mfma_f32_16x16x32_bf16 v[132:135], v[20:23], v[96:99], v[132:135]
    ds_read_b64_tr_b16 v[16:17], v9 offset:0
    v_mfma_f32_16x16x32_bf16 v[148:151], v[20:23], v[100:103], v[148:151]
    ds_read_b64_tr_b16 v[18:19], v9 offset:2048
    v_mfma_f32_16x16x32_bf16 v[164:167], v[20:23], v[104:107], v[164:167]
    v_mfma_f32_16x16x32_bf16 v[180:183], v[20:23], v[108:111], v[180:183]
    buffer_load_dwordx4 v7, s[16:19], s41 offen offset:2048 lds
    v_mfma_f32_16x16x32_bf16 v[196:199], v[20:23], v[112:115], v[196:199]
    v_mfma_f32_16x16x32_bf16 v[212:215], v[20:23], v[116:119], v[212:215]
    buffer_load_dwordx4 v8, s[16:19], s41 offen offset:3072 lds
    v_mfma_f32_16x16x32_bf16 v[228:231], v[20:23], v[120:123], v[228:231]
    s_add_u32 s41, s41, 262144
    v_mfma_f32_16x16x32_bf16 v[244:247], v[20:23], v[124:127], v[244:247]
    s_waitcnt lgkmcnt(4)
    v_mfma_f32_16x16x32_bf16 v[136:139], v[24:27], v[96:99], v[136:139]
    ds_read_b64_tr_b16 v[20:21], v10 offset:0
    v_mfma_f32_16x16x32_bf16 v[152:155], v[24:27], v[100:103], v[152:155]
    ds_read_b64_tr_b16 v[22:23], v10 offset:2048
    v_mfma_f32_16x16x32_bf16 v[168:171], v[24:27], v[104:107], v[168:171]
    v_mfma_f32_16x16x32_bf16 v[184:187], v[24:27], v[108:111], v[184:187]
    v_mfma_f32_16x16x32_bf16 v[200:203], v[24:27], v[112:115], v[200:203]
    v_mfma_f32_16x16x32_bf16 v[216:219], v[24:27], v[116:119], v[216:219]
    v_mfma_f32_16x16x32_bf16 v[232:235], v[24:27], v[120:123], v[232:235]
    v_mfma_f32_16x16x32_bf16 v[248:251], v[24:27], v[124:127], v[248:251]
    s_waitcnt lgkmcnt(4)
    v_mfma_f32_16x16x32_bf16 v[140:143], v[28:31], v[96:99], v[140:143]
    buffer_load_dwordx4 v[96:99], v1, s[8:11], s40 offen offset:0
    ds_read_b64_tr_b16 v[24:25], v11 offset:0
    v_mfma_f32_16x16x32_bf16 v[156:159], v[28:31], v[100:103], v[156:159]
    buffer_load_dwordx4 v[100:103], v1, s[8:11], s40 offen offset:1024
    ds_read_b64_tr_b16 v[26:27], v11 offset:2048
    v_mfma_f32_16x16x32_bf16 v[172:175], v[28:31], v[104:107], v[172:175]
    buffer_load_dwordx4 v[104:107], v2, s[8:11], s40 offen offset:0
    v_mfma_f32_16x16x32_bf16 v[188:191], v[28:31], v[108:111], v[188:191]
    buffer_load_dwordx4 v[108:111], v2, s[8:11], s40 offen offset:1024
    v_mfma_f32_16x16x32_bf16 v[204:207], v[28:31], v[112:115], v[204:207]
    buffer_load_dwordx4 v[112:115], v3, s[8:11], s40 offen offset:0
    v_mfma_f32_16x16x32_bf16 v[220:223], v[28:31], v[116:119], v[220:223]
    buffer_load_dwordx4 v[116:119], v3, s[8:11], s40 offen offset:1024
    v_mfma_f32_16x16x32_bf16 v[236:239], v[28:31], v[120:123], v[236:239]
    buffer_load_dwordx4 v[120:123], v4, s[8:11], s40 offen offset:0
    v_mfma_f32_16x16x32_bf16 v[252:255], v[28:31], v[124:127], v[252:255]
    buffer_load_dwordx4 v[124:127], v4, s[8:11], s40 offen offset:1024
    s_waitcnt vmcnt(24) lgkmcnt(4)
    ds_read_b64_tr_b16 v[28:29], v12 offset:0
    ds_read_b64_tr_b16 v[30:31], v12 offset:2048
    s_add_u32 s40, s40, 524288
    v_mfma_f32_16x16x32_bf16 v[128:131], v[16:19], v[32:35], v[128:131]
    buffer_load_dword v15, v14, s[28:31], 0 offen sc0 sc1
    v_mfma_f32_16x16x32_bf16 v[144:147], v[16:19], v[36:39], v[144:147]
    v_mfma_f32_16x16x32_bf16 v[160:163], v[16:19], v[40:43], v[160:163]
    s_add_u32 m0, s42, 20480
    v_mfma_f32_16x16x32_bf16 v[176:179], v[16:19], v[44:47], v[176:179]
    buffer_load_dwordx4 v5, s[16:19], s41 offen offset:0 lds
    v_mfma_f32_16x16x32_bf16 v[192:195], v[16:19], v[48:51], v[192:195]
    v_mfma_f32_16x16x32_bf16 v[208:211], v[16:19], v[52:55], v[208:211]
    buffer_load_dwordx4 v6, s[16:19], s41 offen offset:1024 lds
    v_mfma_f32_16x16x32_bf16 v[224:227], v[16:19], v[56:59], v[224:227]
    v_mfma_f32_16x16x32_bf16 v[240:243], v[16:19], v[60:63], v[240:243]
    s_waitcnt lgkmcnt(4)
    v_mfma_f32_16x16x32_bf16 v[132:135], v[20:23], v[32:35], v[132:135]
    ds_read_b64_tr_b16 v[16:17], v9 offset:4096
    v_mfma_f32_16x16x32_bf16 v[148:151], v[20:23], v[36:39], v[148:151]
    ds_read_b64_tr_b16 v[18:19], v9 offset:6144
    v_mfma_f32_16x16x32_bf16 v[164:167], v[20:23], v[40:43], v[164:167]
    v_mfma_f32_16x16x32_bf16 v[180:183], v[20:23], v[44:47], v[180:183]
    buffer_load_dwordx4 v7, s[16:19], s41 offen offset:2048 lds
    v_mfma_f32_16x16x32_bf16 v[196:199], v[20:23], v[48:51], v[196:199]
    v_mfma_f32_16x16x32_bf16 v[212:215], v[20:23], v[52:55], v[212:215]
    buffer_load_dwordx4 v8, s[16:19], s41 offen offset:3072 lds
    v_mfma_f32_16x16x32_bf16 v[228:231], v[20:23], v[56:59], v[228:231]
    s_add_u32 s41, s41, 262144
    v_mfma_f32_16x16x32_bf16 v[244:247], v[20:23], v[60:63], v[244:247]
    s_waitcnt lgkmcnt(4)
    v_mfma_f32_16x16x32_bf16 v[136:139], v[24:27], v[32:35], v[136:139]
    ds_read_b64_tr_b16 v[20:21], v10 offset:4096
    v_mfma_f32_16x16x32_bf16 v[152:155], v[24:27], v[36:39], v[152:155]
    ds_read_b64_tr_b16 v[22:23], v10 offset:6144
    v_mfma_f32_16x16x32_bf16 v[168:171], v[24:27], v[40:43], v[168:171]
    v_mfma_f32_16x16x32_bf16 v[184:187], v[24:27], v[44:47], v[184:187]
    v_mfma_f32_16x16x32_bf16 v[200:203], v[24:27], v[48:51], v[200:203]
    v_mfma_f32_16x16x32_bf16 v[216:219], v[24:27], v[52:55], v[216:219]
    v_mfma_f32_16x16x32_bf16 v[232:235], v[24:27], v[56:59], v[232:235]
    v_mfma_f32_16x16x32_bf16 v[248:251], v[24:27], v[60:63], v[248:251]
    s_waitcnt lgkmcnt(4)
    v_mfma_f32_16x16x32_bf16 v[140:143], v[28:31], v[32:35], v[140:143]
    buffer_load_dwordx4 v[32:35], v1, s[8:11], s40 offen offset:0
    ds_read_b64_tr_b16 v[24:25], v11 offset:4096
    v_mfma_f32_16x16x32_bf16 v[156:159], v[28:31], v[36:39], v[156:159]
    buffer_load_dwordx4 v[36:39], v1, s[8:11], s40 offen offset:1024
    ds_read_b64_tr_b16 v[26:27], v11 offset:6144
    v_mfma_f32_16x16x32_bf16 v[172:175], v[28:31], v[40:43], v[172:175]
    buffer_load_dwordx4 v[40:43], v2, s[8:11], s40 offen offset:0
    v_mfma_f32_16x16x32_bf16 v[188:191], v[28:31], v[44:47], v[188:191]
    buffer_load_dwordx4 v[44:47], v2, s[8:11], s40 offen offset:1024
    v_mfma_f32_16x16x32_bf16 v[204:207], v[28:31], v[48:51], v[204:207]
    buffer_load_dwordx4 v[48:51], v3, s[8:11], s40 offen offset:0
    v_mfma_f32_16x16x32_bf16 v[220:223], v[28:31], v[52:55], v[220:223]
    buffer_load_dwordx4 v[52:55], v3, s[8:11], s40 offen offset:1024
    v_mfma_f32_16x16x32_bf16 v[236:239], v[28:31], v[56:59], v[236:239]
    buffer_load_dwordx4 v[56:59], v4, s[8:11], s40 offen offset:0
    v_mfma_f32_16x16x32_bf16 v[252:255], v[28:31], v[60:63], v[252:255]
    buffer_load_dwordx4 v[60:63], v4, s[8:11], s40 offen offset:1024
    s_waitcnt vmcnt(25) lgkmcnt(4)
    ds_read_b64_tr_b16 v[28:29], v12 offset:4096
    ds_read_b64_tr_b16 v[30:31], v12 offset:6144
    s_sub_u32 s40, s40, 18350080
    v_mfma_f32_16x16x32_bf16 v[128:131], v[16:19], v[64:67], v[128:131]
    v_mfma_f32_16x16x32_bf16 v[144:147], v[16:19], v[68:71], v[144:147]
    v_mfma_f32_16x16x32_bf16 v[160:163], v[16:19], v[72:75], v[160:163]
    s_add_u32 m0, s42, 0
    v_mfma_f32_16x16x32_bf16 v[176:179], v[16:19], v[76:79], v[176:179]
    buffer_load_dwordx4 v5, s[16:19], s41 offen offset:0 lds
    v_mfma_f32_16x16x32_bf16 v[192:195], v[16:19], v[80:83], v[192:195]
    v_mfma_f32_16x16x32_bf16 v[208:211], v[16:19], v[84:87], v[208:211]
    buffer_load_dwordx4 v6, s[16:19], s41 offen offset:1024 lds
    v_mfma_f32_16x16x32_bf16 v[224:227], v[16:19], v[88:91], v[224:227]
    v_mfma_f32_16x16x32_bf16 v[240:243], v[16:19], v[92:95], v[240:243]
    s_waitcnt lgkmcnt(4)
    v_mfma_f32_16x16x32_bf16 v[132:135], v[20:23], v[64:67], v[132:135]
    ds_read_b64_tr_b16 v[16:17], v9 offset:8192
    v_mfma_f32_16x16x32_bf16 v[148:151], v[20:23], v[68:71], v[148:151]
    ds_read_b64_tr_b16 v[18:19], v9 offset:10240
    v_mfma_f32_16x16x32_bf16 v[164:167], v[20:23], v[72:75], v[164:167]
    v_mfma_f32_16x16x32_bf16 v[180:183], v[20:23], v[76:79], v[180:183]
    buffer_load_dwordx4 v7, s[16:19], s41 offen offset:2048 lds
    v_mfma_f32_16x16x32_bf16 v[196:199], v[20:23], v[80:83], v[196:199]
    v_mfma_f32_16x16x32_bf16 v[212:215], v[20:23], v[84:87], v[212:215]
    buffer_load_dwordx4 v8, s[16:19], s41 offen offset:3072 lds
    v_mfma_f32_16x16x32_bf16 v[228:231], v[20:23], v[88:91], v[228:231]
    s_add_u32 s41, s41, 262144
    v_mfma_f32_16x16x32_bf16 v[244:247], v[20:23], v[92:95], v[244:247]
    s_waitcnt lgkmcnt(4)
    v_mfma_f32_16x16x32_bf16 v[136:139], v[24:27], v[64:67], v[136:139]
    ds_read_b64_tr_b16 v[20:21], v10 offset:8192
    v_mfma_f32_16x16x32_bf16 v[152:155], v[24:27], v[68:71], v[152:155]
    ds_read_b64_tr_b16 v[22:23], v10 offset:10240
    v_mfma_f32_16x16x32_bf16 v[168:171], v[24:27], v[72:75], v[168:171]
    v_mfma_f32_16x16x32_bf16 v[184:187], v[24:27], v[76:79], v[184:187]
    v_mfma_f32_16x16x32_bf16 v[200:203], v[24:27], v[80:83], v[200:203]
    v_mfma_f32_16x16x32_bf16 v[216:219], v[24:27], v[84:87], v[216:219]
    v_mfma_f32_16x16x32_bf16 v[232:235], v[24:27], v[88:91], v[232:235]
    v_mfma_f32_16x16x32_bf16 v[248:251], v[24:27], v[92:95], v[248:251]
    s_waitcnt lgkmcnt(4)
    s_barrier
    ds_read_b32 v13, v13
    s_waitcnt lgkmcnt(0)
    v_cmp_ne_u32 vcc, 0, v13
    s_cbranch_vccz L_mg_nofb
    s_mov_b32 s65, 19
L_mg_fb:
    s_barrier
    s_sub_u32 s65, s65, 1
    s_cmp_lg_u32 s65, 0
    s_cbranch_scc1 L_mg_fb
L_mg_nofb:
    s_mov_b32 s65, 0x40000
    s_waitcnt vmcnt(16)
L_mg_spin:
    v_cmp_ne_u32 vcc, 1, v15
    s_sub_u32 s65, s65, 1
    s_cbranch_vccz L_mg_go
    s_cbranch_scc1 L_mg_go
    buffer_load_dword v15, v14, s[28:31], 0 offen sc0 sc1
    s_waitcnt vmcnt(0)
    s_branch L_mg_spin
L_mg_go:
    s_waitcnt lgkmcnt(4)
    v_mfma_f32_16x16x32_bf16 v[140:143], v[28:31], v[64:67], v[140:143]
    buffer_load_dwordx4 v[64:67], v1, s[8:11], s40 offen offset:0 sc0 sc1
    ds_read_b64_tr_b16 v[24:25], v11 offset:8192
    v_mfma_f32_16x16x32_bf16 v[156:159], v[28:31], v[68:71], v[156:159]
    buffer_load_dwordx4 v[68:71], v1, s[8:11], s40 offen offset:1024 sc0 sc1
    ds_read_b64_tr_b16 v[26:27], v11 offset:10240
    v_mfma_f32_16x16x32_bf16 v[172:175], v[28:31], v[72:75], v[172:175]
    buffer_load_dwordx4 v[72:75], v2, s[8:11], s40 offen offset:0 sc0 sc1
    v_mfma_f32_16x16x32_bf16 v[188:191], v[28:31], v[76:79], v[188:191]
    buffer_load_dwordx4 v[76:79], v2, s[8:11], s40 offen offset:1024 sc0 sc1
    v_mfma_f32_16x16x32_bf16 v[204:207], v[28:31], v[80:83], v[204:207]
    buffer_load_dwordx4 v[80:83], v3, s[8:11], s40 offen offset:0 sc0 sc1
    v_mfma_f32_16x16x32_bf16 v[220:223], v[28:31], v[84:87], v[220:223]
    buffer_load_dwordx4 v[84:87], v3, s[8:11], s40 offen offset:1024 sc0 sc1
    v_mfma_f32_16x16x32_bf16 v[236:239], v[28:31], v[88:91], v[236:239]
    buffer_load_dwordx4 v[88:91], v4, s[8:11], s40 offen offset:0 sc0 sc1
    v_mfma_f32_16x16x32_bf16 v[252:255], v[28:31], v[92:95], v[252:255]
    buffer_load_dwordx4 v[92:95], v4, s[8:11], s40 offen offset:1024 sc0 sc1
    s_waitcnt vmcnt(24) lgkmcnt(4)
    ds_read_b64_tr_b16 v[28:29], v12 offset:8192
    ds_read_b64_tr_b16 v[30:31], v12 offset:10240
    s_add_u32 s40, s40, 524288
    v_mfma_f32_16x16x32_bf16 v[128:131], v[16:19], v[96:99], v[128:131]
    v_mfma_f32_16x16x32_bf16 v[144:147], v[16:19], v[100:103], v[144:147]
    v_mfma_f32_16x16x32_bf16 v[160:163], v[16:19], v[104:107], v[160:163]
    s_add_u32 m0, s42, 4096
    v_mfma_f32_16x16x32_bf16 v[176:179], v[16:19], v[108:111], v[176:179]
    buffer_load_dwordx4 v5, s[16:19], s41 offen offset:0 lds
    v_mfma_f32_16x16x32_bf16 v[192:195], v[16:19], v[112:115], v[192:195]
    v_mfma_f32_16x16x32_bf16 v[208:211], v[16:19], v[116:119], v[208:211]
    buffer_load_dwordx4 v6, s[16:19], s41 offen offset:1024 lds
    v_mfma_f32_16x16x32_bf16 v[224:227], v[16:19], v[120:123], v[224:227]
    v_mfma_f32_16x16x32_bf16 v[240:243], v[16:19], v[124:127], v[240:243]
    s_waitcnt lgkmcnt(4)
    v_mfma_f32_16x16x32_bf16 v[132:135], v[20:23], v[96:99], v[132:135]
    ds_read_b64_tr_b16 v[16:17], v9 offset:12288
    v_mfma_f32_16x16x32_bf16 v[148:151], v[20:23], v[100:103], v[148:151]
    ds_read_b64_tr_b16 v[18:19], v9 offset:14336
    v_mfma_f32_16x16x32_bf16 v[164:167], v[20:23], v[104:107], v[164:167]
    v_mfma_f32_16x16x32_bf16 v[180:183], v[20:23], v[108:111], v[180:183]
    buffer_load_dwordx4 v7, s[16:19], s41 offen offset:2048 lds
    v_mfma_f32_16x16x32_bf16 v[196:199], v[20:23], v[112:115], v[196:199]
    v_mfma_f32_16x16x32_bf16 v[212:215], v[20:23], v[116:119], v[212:215]
    buffer_load_dwordx4 v8, s[16:19], s41 offen offset:3072 lds
    v_mfma_f32_16x16x32_bf16 v[228:231], v[20:23], v[120:123], v[228:231]
    s_add_u32 s41, s41, 262144
    v_mfma_f32_16x16x32_bf16 v[244:247], v[20:23], v[124:127], v[244:247]
    s_waitcnt lgkmcnt(4)
    v_mfma_f32_16x16x32_bf16 v[136:139], v[24:27], v[96:99], v[136:139]
    ds_read_b64_tr_b16 v[20:21], v10 offset:12288
    v_mfma_f32_16x16x32_bf16 v[152:155], v[24:27], v[100:103], v[152:155]
    ds_read_b64_tr_b16 v[22:23], v10 offset:14336
    v_mfma_f32_16x16x32_bf16 v[168:171], v[24:27], v[104:107], v[168:171]
    v_mfma_f32_16x16x32_bf16 v[184:187], v[24:27], v[108:111], v[184:187]
    v_mfma_f32_16x16x32_bf16 v[200:203], v[24:27], v[112:115], v[200:203]
    v_mfma_f32_16x16x32_bf16 v[216:219], v[24:27], v[116:119], v[216:219]
    v_mfma_f32_16x16x32_bf16 v[232:235], v[24:27], v[120:123], v[232:235]
    v_mfma_f32_16x16x32_bf16 v[248:251], v[24:27], v[124:127], v[248:251]
    s_waitcnt lgkmcnt(4)
    v_mfma_f32_16x16x32_bf16 v[140:143], v[28:31], v[96:99], v[140:143]
    buffer_load_dwordx4 v[96:99], v1, s[8:11], s40 offen offset:0 sc0 sc1
    ds_read_b64_tr_b16 v[24:25], v11 offset:12288
    v_mfma_f32_16x16x32_bf16 v[156:159], v[28:31], v[100:103], v[156:159]
    buffer_load_dwordx4 v[100:103], v1, s[8:11], s40 offen offset:1024 sc0 sc1
    ds_read_b64_tr_b16 v[26:27], v11 offset:14336
    v_mfma_f32_16x16x32_bf16 v[172:175], v[28:31], v[104:107], v[172:175]
    buffer_load_dwordx4 v[104:107], v2, s[8:11], s40 offen offset:0 sc0 sc1
    v_mfma_f32_16x16x32_bf16 v[188:191], v[28:31], v[108:111], v[188:191]
    buffer_load_dwordx4 v[108:111], v2, s[8:11], s40 offen offset:1024 sc0 sc1
    v_mfma_f32_16x16x32_bf16 v[204:207], v[28:31], v[112:115], v[204:207]
    buffer_load_dwordx4 v[112:115], v3, s[8:11], s40 offen offset:0 sc0 sc1
    v_mfma_f32_16x16x32_bf16 v[220:223], v[28:31], v[116:119], v[220:223]
    buffer_load_dwordx4 v[116:119], v3, s[8:11], s40 offen offset:1024 sc0 sc1
    v_mfma_f32_16x16x32_bf16 v[236:239], v[28:31], v[120:123], v[236:239]
    buffer_load_dwordx4 v[120:123], v4, s[8:11], s40 offen offset:0 sc0 sc1
    v_mfma_f32_16x16x32_bf16 v[252:255], v[28:31], v[124:127], v[252:255]
    buffer_load_dwordx4 v[124:127], v4, s[8:11], s40 offen offset:1024 sc0 sc1
    s_waitcnt vmcnt(24) lgkmcnt(4)
    ds_read_b64_tr_b16 v[28:29], v12 offset:12288
    ds_read_b64_tr_b16 v[30:31], v12 offset:14336
    s_add_u32 s40, s40, 524288
    v_mfma_f32_16x16x32_bf16 v[128:131], v[16:19], v[32:35], v[128:131]
    v_mfma_f32_16x16x32_bf16 v[144:147], v[16:19], v[36:39], v[144:147]
    v_mfma_f32_16x16x32_bf16 v[160:163], v[16:19], v[40:43], v[160:163]
    s_add_u32 m0, s42, 8192
    v_mfma_f32_16x16x32_bf16 v[176:179], v[16:19], v[44:47], v[176:179]
    buffer_load_dwordx4 v5, s[16:19], s41 offen offset:0 lds
    v_mfma_f32_16x16x32_bf16 v[192:195], v[16:19], v[48:51], v[192:195]
    v_mfma_f32_16x16x32_bf16 v[208:211], v[16:19], v[52:55], v[208:211]
    buffer_load_dwordx4 v6, s[16:19], s41 offen offset:1024 lds
    v_mfma_f32_16x16x32_bf16 v[224:227], v[16:19], v[56:59], v[224:227]
    v_mfma_f32_16x16x32_bf16 v[240:243], v[16:19], v[60:63], v[240:243]
    s_waitcnt lgkmcnt(4)
    v_mfma_f32_16x16x32_bf16 v[132:135], v[20:23], v[32:35], v[132:135]
    ds_read_b64_tr_b16 v[16:17], v9 offset:16384
    v_mfma_f32_16x16x32_bf16 v[148:151], v[20:23], v[36:39], v[148:151]
    ds_read_b64_tr_b16 v[18:19], v9 offset:18432
    v_mfma_f32_16x16x32_bf16 v[164:167], v[20:23], v[40:43], v[164:167]
    v_mfma_f32_16x16x32_bf16 v[180:183], v[20:23], v[44:47], v[180:183]
    buffer_load_dwordx4 v7, s[16:19], s41 offen offset:2048 lds
    v_mfma_f32_16x16x32_bf16 v[196:199], v[20:23], v[48:51], v[196:199]
    v_mfma_f32_16x16x32_bf16 v[212:215], v[20:23], v[52:55], v[212:215]
    buffer_load_dwordx4 v8, s[16:19], s41 offen offset:3072 lds
    v_mfma_f32_16x16x32_bf16 v[228:231], v[20:23], v[56:59], v[228:231]
    s_add_u32 s41, s41, 262144
    v_mfma_f32_16x16x32_bf16 v[244:247], v[20:23], v[60:63], v[244:247]
    s_waitcnt lgkmcnt(4)
    v_mfma_f32_16x16x32_bf16 v[136:139], v[24:27], v[32:35], v[136:139]
    ds_read_b64_tr_b16 v[20:21], v10 offset:16384
    v_mfma_f32_16x16x32_bf16 v[152:155], v[24:27], v[36:39], v[152:155]
    ds_read_b64_tr_b16 v[22:23], v10 offset:18432
    v_mfma_f32_16x16x32_bf16 v[168:171], v[24:27], v[40:43], v[168:171]
    v_mfma_f32_16x16x32_bf16 v[184:187], v[24:27], v[44:47], v[184:187]
    v_mfma_f32_16x16x32_bf16 v[200:203], v[24:27], v[48:51], v[200:203]
    v_mfma_f32_16x16x32_bf16 v[216:219], v[24:27], v[52:55], v[216:219]
    v_mfma_f32_16x16x32_bf16 v[232:235], v[24:27], v[56:59], v[232:235]
    v_mfma_f32_16x16x32_bf16 v[248:251], v[24:27], v[60:63], v[248:251]
    s_waitcnt lgkmcnt(4)
    v_mfma_f32_16x16x32_bf16 v[140:143], v[28:31], v[32:35], v[140:143]
    buffer_load_dwordx4 v[32:35], v1, s[8:11], s40 offen offset:0 sc0 sc1
    ds_read_b64_tr_b16 v[24:25], v11 offset:16384
    v_mfma_f32_16x16x32_bf16 v[156:159], v[28:31], v[36:39], v[156:159]
    buffer_load_dwordx4 v[36:39], v1, s[8:11], s40 offen offset:1024 sc0 sc1
    ds_read_b64_tr_b16 v[26:27], v11 offset:18432
    v_mfma_f32_16x16x32_bf16 v[172:175], v[28:31], v[40:43], v[172:175]
    buffer_load_dwordx4 v[40:43], v2, s[8:11], s40 offen offset:0 sc0 sc1
    v_mfma_f32_16x16x32_bf16 v[188:191], v[28:31], v[44:47], v[188:191]
    buffer_load_dwordx4 v[44:47], v2, s[8:11], s40 offen offset:1024 sc0 sc1
    v_mfma_f32_16x16x32_bf16 v[204:207], v[28:31], v[48:51], v[204:207]
    buffer_load_dwordx4 v[48:51], v3, s[8:11], s40 offen offset:0 sc0 sc1
    v_mfma_f32_16x16x32_bf16 v[220:223], v[28:31], v[52:55], v[220:223]
    buffer_load_dwordx4 v[52:55], v3, s[8:11], s40 offen offset:1024 sc0 sc1
    v_mfma_f32_16x16x32_bf16 v[236:239], v[28:31], v[56:59], v[236:239]
    buffer_load_dwordx4 v[56:59], v4, s[8:11], s40 offen offset:0 sc0 sc1
    v_mfma_f32_16x16x32_bf16 v[252:255], v[28:31], v[60:63], v[252:255]
    buffer_load_dwordx4 v[60:63], v4, s[8:11], s40 offen offset:1024 sc0 sc1
    s_waitcnt vmcnt(24) lgkmcnt(4)
    ds_read_b64_tr_b16 v[28:29], v12 offset:16384
    ds_read_b64_tr_b16 v[30:31], v12 offset:18432
    s_add_u32 s40, s40, 524288
    v_mfma_f32_16x16x32_bf16 v[128:131], v[16:19], v[64:67], v[128:131]
    v_mfma_f32_16x16x32_bf16 v[144:147], v[16:19], v[68:71], v[144:147]
    v_mfma_f32_16x16x32_bf16 v[160:163], v[16:19], v[72:75], v[160:163]
    v_mfma_f32_16x16x32_bf16 v[176:179], v[16:19], v[76:79], v[176:179]
    v_mfma_f32_16x16x32_bf16 v[192:195], v[16:19], v[80:83], v[192:195]
    v_mfma_f32_16x16x32_bf16 v[208:211], v[16:19], v[84:87], v[208:211]
    v_mfma_f32_16x16x32_bf16 v[224:227], v[16:19], v[88:91], v[224:227]
    v_mfma_f32_16x16x32_bf16 v[240:243], v[16:19], v[92:95], v[240:243]
    s_waitcnt lgkmcnt(4)
    v_mfma_f32_16x16x32_bf16 v[132:135], v[20:23], v[64:67], v[132:135]
    ds_read_b64_tr_b16 v[16:17], v9 offset:20480
    v_mfma_f32_16x16x32_bf16 v[148:151], v[20:23], v[68:71], v[148:151]
    ds_read_b64_tr_b16 v[18:19], v9 offset:22528
    v_mfma_f32_16x16x32_bf16 v[164:167], v[20:23], v[72:75], v[164:167]
    v_mfma_f32_16x16x32_bf16 v[180:183], v[20:23], v[76:79], v[180:183]
    v_mfma_f32_16x16x32_bf16 v[196:199], v[20:23], v[80:83], v[196:199]
    v_mfma_f32_16x16x32_bf16 v[212:215], v[20:23], v[84:87], v[212:215]
    v_mfma_f32_16x16x32_bf16 v[228:231], v[20:23], v[88:91], v[228:231]
    v_mfma_f32_16x16x32_bf16 v[244:247], v[20:23], v[92:95], v[244:247]
    s_waitcnt lgkmcnt(4)
    v_mfma_f32_16x16x32_bf16 v[136:139], v[24:27], v[64:67], v[136:139]
    ds_read_b64_tr_b16 v[20:21], v10 offset:20480
    v_mfma_f32_16x16x32_bf16 v[152:155], v[24:27], v[68:71], v[152:155]
    ds_read_b64_tr_b16 v[22:23], v10 offset:22528
    v_mfma_f32_16x16x32_bf16 v[168:171], v[24:27], v[72:75], v[168:171]
    v_mfma_f32_16x16x32_bf16 v[184:187], v[24:27], v[76:79], v[184:187]
    v_mfma_f32_16x16x32_bf16 v[200:203], v[24:27], v[80:83], v[200:203]
    v_mfma_f32_16x16x32_bf16 v[216:219], v[24:27], v[84:87], v[216:219]
    v_mfma_f32_16x16x32_bf16 v[232:235], v[24:27], v[88:91], v[232:235]
    v_mfma_f32_16x16x32_bf16 v[248:251], v[24:27], v[92:95], v[248:251]
    s_waitcnt lgkmcnt(4)
    v_mfma_f32_16x16x32_bf16 v[140:143], v[28:31], v[64:67], v[140:143]
    buffer_load_dwordx4 v[64:67], v1, s[8:11], s40 offen offset:0 sc0 sc1
    ds_read_b64_tr_b16 v[24:25], v11 offset:20480
    v_mfma_f32_16x16x32_bf16 v[156:159], v[28:31], v[68:71], v[156:159]
    buffer_load_dwordx4 v[68:71], v1, s[8:11], s40 offen offset:1024 sc0 sc1
    ds_read_b64_tr_b16 v[26:27], v11 offset:22528
    v_mfma_f32_16x16x32_bf16 v[172:175], v[28:31], v[72:75], v[172:175]
    buffer_load_dwordx4 v[72:75], v2, s[8:11], s40 offen offset:0 sc0 sc1
    v_mfma_f32_16x16x32_bf16 v[188:191], v[28:31], v[76:79], v[188:191]
    buffer_load_dwordx4 v[76:79], v2, s[8:11], s40 offen offset:1024 sc0 sc1
    v_mfma_f32_16x16x32_bf16 v[204:207], v[28:31], v[80:83], v[204:207]
    buffer_load_dwordx4 v[80:83], v3, s[8:11], s40 offen offset:0 sc0 sc1
    v_mfma_f32_16x16x32_bf16 v[220:223], v[28:31], v[84:87], v[220:223]
    buffer_load_dwordx4 v[84:87], v3, s[8:11], s40 offen offset:1024 sc0 sc1
    v_mfma_f32_16x16x32_bf16 v[236:239], v[28:31], v[88:91], v[236:239]
    buffer_load_dwordx4 v[88:91], v4, s[8:11], s40 offen offset:0 sc0 sc1
    v_mfma_f32_16x16x32_bf16 v[252:255], v[28:31], v[92:95], v[252:255]
    buffer_load_dwordx4 v[92:95], v4, s[8:11], s40 offen offset:1024 sc0 sc1
    s_waitcnt vmcnt(20) lgkmcnt(4)
    ds_read_b64_tr_b16 v[28:29], v12 offset:20480
    ds_read_b64_tr_b16 v[30:31], v12 offset:22528
    s_add_u32 s40, s40, 524288
    v_mfma_f32_16x16x32_bf16 v[128:131], v[16:19], v[96:99], v[128:131]
    v_mfma_f32_16x16x32_bf16 v[144:147], v[16:19], v[100:103], v[144:147]
    v_mfma_f32_16x16x32_bf16 v[160:163], v[16:19], v[104:107], v[160:163]
    v_mfma_f32_16x16x32_bf16 v[176:179], v[16:19], v[108:111], v[176:179]
    v_mfma_f32_16x16x32_bf16 v[192:195], v[16:19], v[112:115], v[192:195]
    v_mfma_f32_16x16x32_bf16 v[208:211], v[16:19], v[116:119], v[208:211]
    v_mfma_f32_16x16x32_bf16 v[224:227], v[16:19], v[120:123], v[224:227]
    v_mfma_f32_16x16x32_bf16 v[240:243], v[16:19], v[124:127], v[240:243]
    s_waitcnt lgkmcnt(4)
    v_mfma_f32_16x16x32_bf16 v[132:135], v[20:23], v[96:99], v[132:135]
    ds_read_b64_tr_b16 v[16:17], v9 offset:0
    v_mfma_f32_16x16x32_bf16 v[148:151], v[20:23], v[100:103], v[148:151]
    ds_read_b64_tr_b16 v[18:19], v9 offset:2048
    v_mfma_f32_16x16x32_bf16 v[164:167], v[20:23], v[104:107], v[164:167]
    v_mfma_f32_16x16x32_bf16 v[180:183], v[20:23], v[108:111], v[180:183]
    v_mfma_f32_16x16x32_bf16 v[196:199], v[20:23], v[112:115], v[196:199]
    v_mfma_f32_16x16x32_bf16 v[212:215], v[20:23], v[116:119], v[212:215]
    v_mfma_f32_16x16x32_bf16 v[228:231], v[20:23], v[120:123], v[228:231]
    v_mfma_f32_16x16x32_bf16 v[244:247], v[20:23], v[124:127], v[244:247]
    s_waitcnt lgkmcnt(4)
    v_mfma_f32_16x16x32_bf16 v[136:139], v[24:27], v[96:99], v[136:139]
    ds_read_b64_tr_b16 v[20:21], v10 offset:0
    v_mfma_f32_16x16x32_bf16 v[152:155], v[24:27], v[100:103], v[152:155]
    ds_read_b64_tr_b16 v[22:23], v10 offset:2048
    v_mfma_f32_16x16x32_bf16 v[168:171], v[24:27], v[104:107], v[168:171]
    v_mfma_f32_16x16x32_bf16 v[184:187], v[24:27], v[108:111], v[184:187]
    v_mfma_f32_16x16x32_bf16 v[200:203], v[24:27], v[112:115], v[200:203]
    v_mfma_f32_16x16x32_bf16 v[216:219], v[24:27], v[116:119], v[216:219]
    v_mfma_f32_16x16x32_bf16 v[232:235], v[24:27], v[120:123], v[232:235]
    v_mfma_f32_16x16x32_bf16 v[248:251], v[24:27], v[124:127], v[248:251]
    s_waitcnt lgkmcnt(4)
    v_mfma_f32_16x16x32_bf16 v[140:143], v[28:31], v[96:99], v[140:143]
    buffer_load_dwordx4 v[96:99], v1, s[8:11], s40 offen offset:0 sc0 sc1
    ds_read_b64_tr_b16 v[24:25], v11 offset:0
    v_mfma_f32_16x16x32_bf16 v[156:159], v[28:31], v[100:103], v[156:159]
    buffer_load_dwordx4 v[100:103], v1, s[8:11], s40 offen offset:1024 sc0 sc1
    ds_read_b64_tr_b16 v[26:27], v11 offset:2048
    v_mfma_f32_16x16x32_bf16 v[172:175], v[28:31], v[104:107], v[172:175]
    buffer_load_dwordx4 v[104:107], v2, s[8:11], s40 offen offset:0 sc0 sc1
    v_mfma_f32_16x16x32_bf16 v[188:191], v[28:31], v[108:111], v[188:191]
    buffer_load_dwordx4 v[108:111], v2, s[8:11], s40 offen offset:1024 sc0 sc1
    v_mfma_f32_16x16x32_bf16 v[204:207], v[28:31], v[112:115], v[204:207]
    buffer_load_dwordx4 v[112:115], v3, s[8:11], s40 offen offset:0 sc0 sc1
    v_mfma_f32_16x16x32_bf16 v[220:223], v[28:31], v[116:119], v[220:223]
    buffer_load_dwordx4 v[116:119], v3, s[8:11], s40 offen offset:1024 sc0 sc1
    v_mfma_f32_16x16x32_bf16 v[236:239], v[28:31], v[120:123], v[236:239]
    buffer_load_dwordx4 v[120:123], v4, s[8:11], s40 offen offset:0 sc0 sc1
    v_mfma_f32_16x16x32_bf16 v[252:255], v[28:31], v[124:127], v[252:255]
    buffer_load_dwordx4 v[124:127], v4, s[8:11], s40 offen offset:1024 sc0 sc1
    s_waitcnt vmcnt(16) lgkmcnt(4)
    ds_read_b64_tr_b16 v[28:29], v12 offset:0
    ds_read_b64_tr_b16 v[30:31], v12 offset:2048
    s_add_u32 s40, s40, 524288
    v_mfma_f32_16x16x32_bf16 v[128:131], v[16:19], v[32:35], v[128:131]
    v_mfma_f32_16x16x32_bf16 v[144:147], v[16:19], v[36:39], v[144:147]
    v_mfma_f32_16x16x32_bf16 v[160:163], v[16:19], v[40:43], v[160:163]
    v_mfma_f32_16x16x32_bf16 v[176:179], v[16:19], v[44:47], v[176:179]
    v_mfma_f32_16x16x32_bf16 v[192:195], v[16:19], v[48:51], v[192:195]
    v_mfma_f32_16x16x32_bf16 v[208:211], v[16:19], v[52:55], v[208:211]
    v_mfma_f32_16x16x32_bf16 v[224:227], v[16:19], v[56:59], v[224:227]
    v_mfma_f32_16x16x32_bf16 v[240:243], v[16:19], v[60:63], v[240:243]
    s_waitcnt lgkmcnt(4)
    v_mfma_f32_16x16x32_bf16 v[132:135], v[20:23], v[32:35], v[132:135]
    ds_read_b64_tr_b16 v[16:17], v9 offset:4096
    v_mfma_f32_16x16x32_bf16 v[148:151], v[20:23], v[36:39], v[148:151]
    ds_read_b64_tr_b16 v[18:19], v9 offset:6144
    v_mfma_f32_16x16x32_bf16 v[164:167], v[20:23], v[40:43], v[164:167]
    v_mfma_f32_16x16x32_bf16 v[180:183], v[20:23], v[44:47], v[180:183]
    v_mfma_f32_16x16x32_bf16 v[196:199], v[20:23], v[48:51], v[196:199]
    v_mfma_f32_16x16x32_bf16 v[212:215], v[20:23], v[52:55], v[212:215]
    v_mfma_f32_16x16x32_bf16 v[228:231], v[20:23], v[56:59], v[228:231]
    v_mfma_f32_16x16x32_bf16 v[244:247], v[20:23], v[60:63], v[244:247]
    s_waitcnt lgkmcnt(4)
    v_mfma_f32_16x16x32_bf16 v[136:139], v[24:27], v[32:35], v[136:139]
    ds_read_b64_tr_b16 v[20:21], v10 offset:4096
    v_mfma_f32_16x16x32_bf16 v[152:155], v[24:27], v[36:39], v[152:155]
    ds_read_b64_tr_b16 v[22:23], v10 offset:6144
    v_mfma_f32_16x16x32_bf16 v[168:171], v[24:27], v[40:43], v[168:171]
    v_mfma_f32_16x16x32_bf16 v[184:187], v[24:27], v[44:47], v[184:187]
    v_mfma_f32_16x16x32_bf16 v[200:203], v[24:27], v[48:51], v[200:203]
    v_mfma_f32_16x16x32_bf16 v[216:219], v[24:27], v[52:55], v[216:219]
    v_mfma_f32_16x16x32_bf16 v[232:235], v[24:27], v[56:59], v[232:235]
    v_mfma_f32_16x16x32_bf16 v[248:251], v[24:27], v[60:63], v[248:251]
    s_waitcnt lgkmcnt(4)
    v_mfma_f32_16x16x32_bf16 v[140:143], v[28:31], v[32:35], v[140:143]
    buffer_load_dwordx4 v[32:35], v1, s[8:11], s40 offen offset:0 sc0 sc1
    ds_read_b64_tr_b16 v[24:25], v11 offset:4096
    v_mfma_f32_16x16x32_bf16 v[156:159], v[28:31], v[36:39], v[156:159]
    buffer_load_dwordx4 v[36:39], v1, s[8:11], s40 offen offset:1024 sc0 sc1
    ds_read_b64_tr_b16 v[26:27], v11 offset:6144
    v_mfma_f32_16x16x32_bf16 v[172:175], v[28:31], v[40:43], v[172:175]
    buffer_load_dwordx4 v[40:43], v2, s[8:11], s40 offen offset:0 sc0 sc1
    v_mfma_f32_16x16x32_bf16 v[188:191], v[28:31], v[44:47], v[188:191]
    buffer_load_dwordx4 v[44:47], v2, s[8:11], s40 offen offset:1024 sc0 sc1
    v_mfma_f32_16x16x32_bf16 v[204:207], v[28:31], v[48:51], v[204:207]
    buffer_load_dwordx4 v[48:51], v3, s[8:11], s40 offen offset:0 sc0 sc1
    v_mfma_f32_16x16x32_bf16 v[220:223], v[28:31], v[52:55], v[220:223]
    buffer_load_dwordx4 v[52:55], v3, s[8:11], s40 offen offset:1024 sc0 sc1
    v_mfma_f32_16x16x32_bf16 v[236:239], v[28:31], v[56:59], v[236:239]
    buffer_load_dwordx4 v[56:59], v4, s[8:11], s40 offen offset:0 sc0 sc1
    v_mfma_f32_16x16x32_bf16 v[252:255], v[28:31], v[60:63], v[252:255]
    buffer_load_dwordx4 v[60:63], v4, s[8:11], s40 offen offset:1024 sc0 sc1
    s_waitcnt vmcnt(16) lgkmcnt(4)
    ds_read_b64_tr_b16 v[28:29], v12 offset:4096
    ds_read_b64_tr_b16 v[30:31], v12 offset:6144
    s_add_u32 s40, s40, 524288
    v_mfma_f32_16x16x32_bf16 v[128:131], v[16:19], v[64:67], v[128:131]
    v_mfma_f32_16x16x32_bf16 v[144:147], v[16:19], v[68:71], v[144:147]
    v_mfma_f32_16x16x32_bf16 v[160:163], v[16:19], v[72:75], v[160:163]
    v_mfma_f32_16x16x32_bf16 v[176:179], v[16:19], v[76:79], v[176:179]
    v_mfma_f32_16x16x32_bf16 v[192:195], v[16:19], v[80:83], v[192:195]
    v_mfma_f32_16x16x32_bf16 v[208:211], v[16:19], v[84:87], v[208:211]
    v_mfma_f32_16x16x32_bf16 v[224:227], v[16:19], v[88:91], v[224:227]
    v_mfma_f32_16x16x32_bf16 v[240:243], v[16:19], v[92:95], v[240:243]
    s_waitcnt lgkmcnt(4)
    v_mfma_f32_16x16x32_bf16 v[132:135], v[20:23], v[64:67], v[132:135]
    ds_read_b64_tr_b16 v[16:17], v9 offset:8192
    v_mfma_f32_16x16x32_bf16 v[148:151], v[20:23], v[68:71], v[148:151]
    ds_read_b64_tr_b16 v[18:19], v9 offset:10240
    v_mfma_f32_16x16x32_bf16 v[164:167], v[20:23], v[72:75], v[164:167]
    v_mfma_f32_16x16x32_bf16 v[180:183], v[20:23], v[76:79], v[180:183]
    v_mfma_f32_16x16x32_bf16 v[196:199], v[20:23], v[80:83], v[196:199]
    v_mfma_f32_16x16x32_bf16 v[212:215], v[20:23], v[84:87], v[212:215]
    v_mfma_f32_16x16x32_bf16 v[228:231], v[20:23], v[88:91], v[228:231]
    v_mfma_f32_16x16x32_bf16 v[244:247], v[20:23], v[92:95], v[244:247]
    s_waitcnt lgkmcnt(4)
    v_mfma_f32_16x16x32_bf16 v[136:139], v[24:27], v[64:67], v[136:139]
    ds_read_b64_tr_b16 v[20:21], v10 offset:8192
    v_mfma_f32_16x16x32_bf16 v[152:155], v[24:27], v[68:71], v[152:155]
    ds_read_b64_tr_b16 v[22:23], v10 offset:10240
    v_mfma_f32_16x16x32_bf16 v[168:171], v[24:27], v[72:75], v[168:171]
    v_mfma_f32_16x16x32_bf16 v[184:187], v[24:27], v[76:79], v[184:187]
    v_mfma_f32_16x16x32_bf16 v[200:203], v[24:27], v[80:83], v[200:203]
    v_mfma_f32_16x16x32_bf16 v[216:219], v[24:27], v[84:87], v[216:219]
    v_mfma_f32_16x16x32_bf16 v[232:235], v[24:27], v[88:91], v[232:235]
    v_mfma_f32_16x16x32_bf16 v[248:251], v[24:27], v[92:95], v[248:251]
    s_waitcnt lgkmcnt(4)
    v_mfma_f32_16x16x32_bf16 v[140:143], v[28:31], v[64:67], v[140:143]
    buffer_load_dwordx4 v[64:67], v1, s[8:11], s40 offen offset:0 sc0 sc1
    ds_read_b64_tr_b16 v[24:25], v11 offset:8192
    v_mfma_f32_16x16x32_bf16 v[156:159], v[28:31], v[68:71], v[156:159]
    buffer_load_dwordx4 v[68:71], v1, s[8:11], s40 offen offset:1024 sc0 sc1
    ds_read_b64_tr_b16 v[26:27], v11 offset:10240
    v_mfma_f32_16x16x32_bf16 v[172:175], v[28:31], v[72:75], v[172:175]
    buffer_load_dwordx4 v[72:75], v2, s[8:11], s40 offen offset:0 sc0 sc1
    v_mfma_f32_16x16x32_bf16 v[188:191], v[28:31], v[76:79], v[188:191]
    buffer_load_dwordx4 v[76:79], v2, s[8:11], s40 offen offset:1024 sc0 sc1
    v_mfma_f32_16x16x32_bf16 v[204:207], v[28:31], v[80:83], v[204:207]
    buffer_load_dwordx4 v[80:83], v3, s[8:11], s40 offen offset:0 sc0 sc1
    v_mfma_f32_16x16x32_bf16 v[220:223], v[28:31], v[84:87], v[220:223]
    buffer_load_dwordx4 v[84:87], v3, s[8:11], s40 offen offset:1024 sc0 sc1
    v_mfma_f32_16x16x32_bf16 v[236:239], v[28:31], v[88:91], v[236:239]
    buffer_load_dwordx4 v[88:91], v4, s[8:11], s40 offen offset:0 sc0 sc1
    v_mfma_f32_16x16x32_bf16 v[252:255], v[28:31], v[92:95], v[252:255]
    buffer_load_dwordx4 v[92:95], v4, s[8:11], s40 offen offset:1024 sc0 sc1
    s_waitcnt vmcnt(16) lgkmcnt(4)
    ds_read_b64_tr_b16 v[28:29], v12 offset:8192
    ds_read_b64_tr_b16 v[30:31], v12 offset:10240
    s_add_u32 s40, s40, 524288
    v_mfma_f32_16x16x32_bf16 v[128:131], v[16:19], v[96:99], v[128:131]
    v_subrev_u32 v9, s44, v9
    v_mfma_f32_16x16x32_bf16 v[144:147], v[16:19], v[100:103], v[144:147]
    v_subrev_u32 v10, s44, v10
    v_mfma_f32_16x16x32_bf16 v[160:163], v[16:19], v[104:107], v[160:163]
    v_subrev_u32 v11, s44, v11
    v_mfma_f32_16x16x32_bf16 v[176:179], v[16:19], v[108:111], v[176:179]
    v_subrev_u32 v12, s44, v12
    v_mfma_f32_16x16x32_bf16 v[192:195], v[16:19], v[112:115], v[192:195]
    v_mfma_f32_16x16x32_bf16 v[208:211], v[16:19], v[116:119], v[208:211]
    v_mfma_f32_16x16x32_bf16 v[224:227], v[16:19], v[120:123], v[224:227]
    v_mfma_f32_16x16x32_bf16 v[240:243], v[16:19], v[124:127], v[240:243]
    s_waitcnt lgkmcnt(4)
    v_mfma_f32_16x16x32_bf16 v[132:135], v[20:23], v[96:99], v[132:135]
    ds_read_b64_tr_b16 v[16:17], v9 offset:0
    v_mfma_f32_16x16x32_bf16 v[148:151], v[20:23], v[100:103], v[148:151]
    ds_read_b64_tr_b16 v[18:19], v9 offset:2048
    v_mfma_f32_16x16x32_bf16 v[164:167], v[20:23], v[104:107], v[164:167]
    v_mfma_f32_16x16x32_bf16 v[180:183], v[20:23], v[108:111], v[180:183]
    v_mfma_f32_16x16x32_bf16 v[196:199], v[20:23], v[112:115], v[196:199]
    v_mfma_f32_16x16x32_bf16 v[212:215], v[20:23], v[116:119], v[212:215]
    v_mfma_f32_16x16x32_bf16 v[228:231], v[20:23], v[120:123], v[228:231]
    v_mfma_f32_16x16x32_bf16 v[244:247], v[20:23], v[124:127], v[244:247]
    s_waitcnt lgkmcnt(4)
    v_mfma_f32_16x16x32_bf16 v[136:139], v[24:27], v[96:99], v[136:139]
    ds_read_b64_tr_b16 v[20:21], v10 offset:0
    v_mfma_f32_16x16x32_bf16 v[152:155], v[24:27], v[100:103], v[152:155]
    ds_read_b64_tr_b16 v[22:23], v10 offset:2048
    v_mfma_f32_16x16x32_bf16 v[168:171], v[24:27], v[104:107], v[168:171]
    v_mfma_f32_16x16x32_bf16 v[184:187], v[24:27], v[108:111], v[184:187]
    v_mfma_f32_16x16x32_bf16 v[200:203], v[24:27], v[112:115], v[200:203]
    v_mfma_f32_16x16x32_bf16 v[216:219], v[24:27], v[116:119], v[216:219]
    v_mfma_f32_16x16x32_bf16 v[232:235], v[24:27], v[120:123], v[232:235]
    v_mfma_f32_16x16x32_bf16 v[248:251], v[24:27], v[124:127], v[248:251]
    s_waitcnt lgkmcnt(4)
    v_mfma_f32_16x16x32_bf16 v[140:143], v[28:31], v[96:99], v[140:143]
    ds_read_b64_tr_b16 v[24:25], v11 offset:0
    v_mfma_f32_16x16x32_bf16 v[156:159], v[28:31], v[100:103], v[156:159]
    ds_read_b64_tr_b16 v[26:27], v11 offset:2048
    v_mfma_f32_16x16x32_bf16 v[172:175], v[28:31], v[104:107], v[172:175]
    buffer_load_dwordx4 v[104:107], v2, s[8:11], s40 offen offset:0 sc0 sc1
    v_mfma_f32_16x16x32_bf16 v[188:191], v[28:31], v[108:111], v[188:191]
    buffer_load_dwordx4 v[108:111], v2, s[8:11], s40 offen offset:1024 sc0 sc1
    v_mfma_f32_16x16x32_bf16 v[204:207], v[28:31], v[112:115], v[204:207]
    buffer_load_dwordx4 v[112:115], v3, s[8:11], s40 offen offset:0 sc0 sc1
    v_mfma_f32_16x16x32_bf16 v[220:223], v[28:31], v[116:119], v[220:223]
    buffer_load_dwordx4 v[116:119], v3, s[8:11], s40 offen offset:1024 sc0 sc1
    v_mfma_f32_16x16x32_bf16 v[236:239], v[28:31], v[120:123], v[236:239]
    buffer_load_dwordx4 v[120:123], v4, s[8:11], s40 offen offset:0 sc0 sc1
    v_mfma_f32_16x16x32_bf16 v[252:255], v[28:31], v[124:127], v[252:255]
    buffer_load_dwordx4 v[124:127], v4, s[8:11], s40 offen offset:1024 sc0 sc1
    buffer_load_dwordx4 v[96:99], v1, s[8:11], s40 offen offset:0 sc0 sc1
    buffer_load_dwordx4 v[100:103], v1, s[8:11], s40 offen offset:1024 sc0 sc1
    s_waitcnt vmcnt(16) lgkmcnt(4)
    ds_read_b64_tr_b16 v[28:29], v12 offset:0
    ds_read_b64_tr_b16 v[30:31], v12 offset:2048
    s_add_u32 s40, s40, 524288
    v_mfma_f32_16x16x32_bf16 v[128:131], v[16:19], v[32:35], v[128:131]
    v_mfma_f32_16x16x32_bf16 v[144:147], v[16:19], v[36:39], v[144:147]
    v_mfma_f32_16x16x32_bf16 v[160:163], v[16:19], v[40:43], v[160:163]
    v_mfma_f32_16x16x32_bf16 v[176:179], v[16:19], v[44:47], v[176:179]
    v_mfma_f32_16x16x32_bf16 v[192:195], v[16:19], v[48:51], v[192:195]
    v_mfma_f32_16x16x32_bf16 v[208:211], v[16:19], v[52:55], v[208:211]
    v_mfma_f32_16x16x32_bf16 v[224:227], v[16:19], v[56:59], v[224:227]
    v_mfma_f32_16x16x32_bf16 v[240:243], v[16:19], v[60:63], v[240:243]
    s_waitcnt lgkmcnt(4)
    v_mfma_f32_16x16x32_bf16 v[132:135], v[20:23], v[32:35], v[132:135]
    ds_read_b64_tr_b16 v[16:17], v9 offset:16384
    v_mfma_f32_16x16x32_bf16 v[148:151], v[20:23], v[36:39], v[148:151]
    ds_read_b64_tr_b16 v[18:19], v9 offset:18432
    v_mfma_f32_16x16x32_bf16 v[164:167], v[20:23], v[40:43], v[164:167]
    v_mfma_f32_16x16x32_bf16 v[180:183], v[20:23], v[44:47], v[180:183]
    v_mfma_f32_16x16x32_bf16 v[196:199], v[20:23], v[48:51], v[196:199]
    v_mfma_f32_16x16x32_bf16 v[212:215], v[20:23], v[52:55], v[212:215]
    v_mfma_f32_16x16x32_bf16 v[228:231], v[20:23], v[56:59], v[228:231]
    v_mfma_f32_16x16x32_bf16 v[244:247], v[20:23], v[60:63], v[244:247]
    s_waitcnt lgkmcnt(4)
    v_mfma_f32_16x16x32_bf16 v[136:139], v[24:27], v[32:35], v[136:139]
    ds_read_b64_tr_b16 v[20:21], v10 offset:16384
    v_mfma_f32_16x16x32_bf16 v[152:155], v[24:27], v[36:39], v[152:155]
    ds_read_b64_tr_b16 v[22:23], v10 offset:18432
    v_mfma_f32_16x16x32_bf16 v[168:171], v[24:27], v[40:43], v[168:171]
    v_mfma_f32_16x16x32_bf16 v[184:187], v[24:27], v[44:47], v[184:187]
    v_mfma_f32_16x16x32_bf16 v[200:203], v[24:27], v[48:51], v[200:203]
    v_mfma_f32_16x16x32_bf16 v[216:219], v[24:27], v[52:55], v[216:219]
    v_mfma_f32_16x16x32_bf16 v[232:235], v[24:27], v[56:59], v[232:235]
    v_mfma_f32_16x16x32_bf16 v[248:251], v[24:27], v[60:63], v[248:251]
    s_waitcnt lgkmcnt(4)
    v_mfma_f32_16x16x32_bf16 v[140:143], v[28:31], v[32:35], v[140:143]
    ds_read_b64_tr_b16 v[24:25], v11 offset:16384
    v_mfma_f32_16x16x32_bf16 v[156:159], v[28:31], v[36:39], v[156:159]
    ds_read_b64_tr_b16 v[26:27], v11 offset:18432
    v_mfma_f32_16x16x32_bf16 v[172:175], v[28:31], v[40:43], v[172:175]
    v_mfma_f32_16x16x32_bf16 v[188:191], v[28:31], v[44:47], v[188:191]
    v_mfma_f32_16x16x32_bf16 v[204:207], v[28:31], v[48:51], v[204:207]
    v_mfma_f32_16x16x32_bf16 v[220:223], v[28:31], v[52:55], v[220:223]
    v_mfma_f32_16x16x32_bf16 v[236:239], v[28:31], v[56:59], v[236:239]
    v_mfma_f32_16x16x32_bf16 v[252:255], v[28:31], v[60:63], v[252:255]
    s_waitcnt vmcnt(8) lgkmcnt(4)
    ds_read_b64_tr_b16 v[28:29], v12 offset:16384
    ds_read_b64_tr_b16 v[30:31], v12 offset:18432
    v_mfma_f32_16x16x32_bf16 v[128:131], v[16:19], v[64:67], v[128:131]
    s_barrier
    v_lshlrev_b32 v13, 4, v0
    v_mfma_f32_16x16x32_bf16 v[144:147], v[16:19], v[68:71], v[144:147]
    v_mfma_f32_16x16x32_bf16 v[160:163], v[16:19], v[72:75], v[160:163]
    s_add_u32 s65, s64, 1
    s_and_b32 s65, s65, 3
    s_mul_i32 s65, s65, 24576
    v_mfma_f32_16x16x32_bf16 v[176:179], v[16:19], v[76:79], v[176:179]
    s_add_u32 s65, s65, 65536
    v_add_u32 v1, s65, v13
    v_mfma_f32_16x16x32_bf16 v[192:195], v[16:19], v[80:83], v[192:195]
    s_add_u32 s65, s64, 2
    s_and_b32 s65, s65, 3
    s_mul_i32 s65, s65, 24576
    v_mfma_f32_16x16x32_bf16 v[208:211], v[16:19], v[84:87], v[208:211]
    s_add_u32 s65, s65, 73728
    v_add_u32 v2, s65, v13
    v_mfma_f32_16x16x32_bf16 v[224:227], v[16:19], v[88:91], v[224:227]
    s_add_u32 s65, s64, 3
    s_and_b32 s65, s65, 3
    s_mul_i32 s65, s65, 24576
    v_mfma_f32_16x16x32_bf16 v[240:243], v[16:19], v[92:95], v[240:243]
    s_waitcnt lgkmcnt(4)
    s_add_u32 s65, s65, 81920
    v_add_u32 v3, s65, v13
    v_mfma_f32_16x16x32_bf16 v[132:135], v[20:23], v[64:67], v[132:135]
    ds_read_b64_tr_b16 v[16:17], v9 offset:32768
    v_mfma_f32_16x16x32_bf16 v[148:151], v[20:23], v[68:71], v[148:151]
    ds_read_b64_tr_b16 v[18:19], v9 offset:34816
    v_mfma_f32_16x16x32_bf16 v[164:167], v[20:23], v[72:75], v[164:167]
    v_mfma_f32_16x16x32_bf16 v[180:183], v[20:23], v[76:79], v[180:183]
    v_mfma_f32_16x16x32_bf16 v[196:199], v[20:23], v[80:83], v[196:199]
    v_mfma_f32_16x16x32_bf16 v[212:215], v[20:23], v[84:87], v[212:215]
    v_mfma_f32_16x16x32_bf16 v[228:231], v[20:23], v[88:91], v[228:231]
    v_mfma_f32_16x16x32_bf16 v[244:247], v[20:23], v[92:95], v[244:247]
    s_waitcnt lgkmcnt(4)
    v_mfma_f32_16x16x32_bf16 v[136:139], v[24:27], v[64:67], v[136:139]
    ds_read_b64_tr_b16 v[20:21], v10 offset:32768
    v_mfma_f32_16x16x32_bf16 v[152:155], v[24:27], v[68:71], v[152:155]
    ds_read_b64_tr_b16 v[22:23], v10 offset:34816
    v_mfma_f32_16x16x32_bf16 v[168:171], v[24:27], v[72:75], v[168:171]
    v_mfma_f32_16x16x32_bf16 v[184:187], v[24:27], v[76:79], v[184:187]
    v_mfma_f32_16x16x32_bf16 v[200:203], v[24:27], v[80:83], v[200:203]
    v_mfma_f32_16x16x32_bf16 v[216:219], v[24:27], v[84:87], v[216:219]
    v_mfma_f32_16x16x32_bf16 v[232:235], v[24:27], v[88:91], v[232:235]
    v_mfma_f32_16x16x32_bf16 v[248:251], v[24:27], v[92:95], v[248:251]
    s_waitcnt lgkmcnt(4)
    v_mfma_f32_16x16x32_bf16 v[140:143], v[28:31], v[64:67], v[140:143]
    ds_read_b64_tr_b16 v[24:25], v11 offset:32768
    v_mfma_f32_16x16x32_bf16 v[156:159], v[28:31], v[68:71], v[156:159]
    ds_read_b64_tr_b16 v[26:27], v11 offset:34816
    v_mfma_f32_16x16x32_bf16 v[172:175], v[28:31], v[72:75], v[172:175]
    v_mfma_f32_16x16x32_bf16 v[188:191], v[28:31], v[76:79], v[188:191]
    v_mfma_f32_16x16x32_bf16 v[204:207], v[28:31], v[80:83], v[204:207]
    v_mfma_f32_16x16x32_bf16 v[220:223], v[28:31], v[84:87], v[220:223]
    v_mfma_f32_16x16x32_bf16 v[236:239], v[28:31], v[88:91], v[236:239]
    v_mfma_f32_16x16x32_bf16 v[252:255], v[28:31], v[92:95], v[252:255]
    s_waitcnt vmcnt(6) lgkmcnt(4)
    ds_read_b64_tr_b16 v[28:29], v12 offset:32768
    ds_read_b64_tr_b16 v[30:31], v12 offset:34816
    v_mfma_f32_16x16x32_bf16 v[160:163], v[16:19], v[104:107], v[160:163]
    v_mfma_f32_16x16x32_bf16 v[176:179], v[16:19], v[108:111], v[176:179]
    s_waitcnt lgkmcnt(4)
    v_mfma_f32_16x16x32_bf16 v[164:167], v[20:23], v[104:107], v[164:167]
    v_mfma_f32_16x16x32_bf16 v[180:183], v[20:23], v[108:111], v[180:183]
    s_waitcnt lgkmcnt(2)
    v_mfma_f32_16x16x32_bf16 v[168:171], v[24:27], v[104:107], v[168:171]
    v_mfma_f32_16x16x32_bf16 v[184:187], v[24:27], v[108:111], v[184:187]
    s_waitcnt lgkmcnt(0)
    v_mfma_f32_16x16x32_bf16 v[172:175], v[28:31], v[104:107], v[172:175]
    v_mfma_f32_16x16x32_bf16 v[188:191], v[28:31], v[108:111], v[188:191]
    s_waitcnt vmcnt(4)
    v_mfma_f32_16x16x32_bf16 v[192:195], v[16:19], v[112:115], v[192:195]
    v_mfma_f32_16x16x32_bf16 v[208:211], v[16:19], v[116:119], v[208:211]
    ds_write_b128 v1, v[160:163] offset:0
    v_mfma_f32_16x16x32_bf16 v[196:199], v[20:23], v[112:115], v[196:199]
    ds_write_b128 v1, v[176:179] offset:4096
    v_mfma_f32_16x16x32_bf16 v[212:215], v[20:23], v[116:119], v[212:215]
    ds_write_b128 v1, v[164:167] offset:1024
    v_mfma_f32_16x16x32_bf16 v[200:203], v[24:27], v[112:115], v[200:203]
    ds_write_b128 v1, v[180:183] offset:5120
    v_mfma_f32_16x16x32_bf16 v[216:219], v[24:27], v[116:119], v[216:219]
    ds_write_b128 v1, v[168:171] offset:2048
    v_mfma_f32_16x16x32_bf16 v[204:207], v[28:31], v[112:115], v[204:207]
    ds_write_b128 v1, v[184:187] offset:6144
    v_mfma_f32_16x16x32_bf16 v[220:223], v[28:31], v[116:119], v[220:223]
    ds_write_b128 v1, v[172:175] offset:3072
    ds_write_b128 v1, v[188:191] offset:7168
    s_waitcnt vmcnt(2)
    v_mfma_f32_16x16x32_bf16 v[224:227], v[16:19], v[120:123], v[224:227]
    v_mfma_f32_16x16x32_bf16 v[240:243], v[16:19], v[124:127], v[240:243]
    ds_write_b128 v2, v[192:195] offset:0
    v_mfma_f32_16x16x32_bf16 v[228:231], v[20:23], v[120:123], v[228:231]
    ds_write_b128 v2, v[208:211] offset:4096
    v_mfma_f32_16x16x32_bf16 v[244:247], v[20:23], v[124:127], v[244:247]
    ds_write_b128 v2, v[196:199] offset:1024
    v_mfma_f32_16x16x32_bf16 v[232:235], v[24:27], v[120:123], v[232:235]
    ds_write_b128 v2, v[212:215] offset:5120
    v_mfma_f32_16x16x32_bf16 v[248:251], v[24:27], v[124:127], v[248:251]
    ds_write_b128 v2, v[200:203] offset:2048
    v_mfma_f32_16x16x32_bf16 v[236:239], v[28:31], v[120:123], v[236:239]
    ds_write_b128 v2, v[216:219] offset:6144
    v_mfma_f32_16x16x32_bf16 v[252:255], v[28:31], v[124:127], v[252:255]
    ds_write_b128 v2, v[204:207] offset:3072
    ds_write_b128 v2, v[220:223] offset:7168
    s_waitcnt vmcnt(0)
    v_mfma_f32_16x16x32_bf16 v[128:131], v[16:19], v[96:99], v[128:131]
    v_mfma_f32_16x16x32_bf16 v[144:147], v[16:19], v[100:103], v[144:147]
    ds_write_b128 v3, v[224:227] offset:0
    v_mfma_f32_16x16x32_bf16 v[132:135], v[20:23], v[96:99], v[132:135]
    ds_write_b128 v3, v[240:243] offset:4096
    v_mfma_f32_16x16x32_bf16 v[148:151], v[20:23], v[100:103], v[148:151]
    ds_write_b128 v3, v[228:231] offset:1024
    v_mfma_f32_16x16x32_bf16 v[136:139], v[24:27], v[96:99], v[136:139]
    ds_write_b128 v3, v[244:247] offset:5120
    v_mfma_f32_16x16x32_bf16 v[152:155], v[24:27], v[100:103], v[152:155]
    ds_write_b128 v3, v[232:235] offset:2048
    v_mfma_f32_16x16x32_bf16 v[140:143], v[28:31], v[96:99], v[140:143]
    ds_write_b128 v3, v[248:251] offset:6144
    v_mfma_f32_16x16x32_bf16 v[156:159], v[28:31], v[100:103], v[156:159]
    ds_write_b128 v3, v[236:239] offset:3072
    ds_write_b128 v3, v[252:255] offset:7168
    v_lshlrev_b32 v13, 4, v0
    v_lshrrev_b32 v19, 4, v0
    v_and_b32 v20, 15, v0
    v_add_u32 v4, s42, v13
    v_and_b32 v5, 1, v19
    v_lshlrev_b32 v5, 5, v5
    v_lshrrev_b32 v6, 1, v19
    v_lshl_add_u32 v5, v6, 4, v5
    v_lshl_add_u32 v5, v20, 11, v5
    v_add_u32 v6, 32768, v5
    s_waitcnt lgkmcnt(0)
    s_barrier
    ds_read_b128 v[32:35], v4 offset:0
    ds_read_b128 v[36:39], v4 offset:8192
    ds_read_b128 v[40:43], v4 offset:16384
    ds_read_b128 v[44:47], v4 offset:1024
    ds_read_b128 v[48:51], v4 offset:9216
    ds_read_b128 v[52:55], v4 offset:17408
    ds_read_b128 v[56:59], v4 offset:2048
    ds_read_b128 v[60:63], v4 offset:10240
    ds_read_b128 v[64:67], v4 offset:18432
    ds_read_b128 v[68:71], v4 offset:3072
    ds_read_b128 v[72:75], v4 offset:11264
    ds_read_b128 v[76:79], v4 offset:19456
    ds_read_b128 v[80:83], v4 offset:4096
    ds_read_b128 v[84:87], v4 offset:12288
    ds_read_b128 v[88:91], v4 offset:20480
    ds_read_b128 v[92:95], v4 offset:5120
    ds_read_b128 v[96:99], v4 offset:13312
    ds_read_b128 v[100:103], v4 offset:21504
    ds_read_b128 v[104:107], v4 offset:6144
    ds_read_b128 v[108:111], v4 offset:14336
    ds_read_b128 v[112:115], v4 offset:22528
    ds_read_b128 v[116:119], v4 offset:7168
    ds_read_b128 v[120:123], v4 offset:15360
    ds_read_b128 v[124:127], v4 offset:23552
    s_waitcnt lgkmcnt(15)
    v_add_f32 v32, v32, v36
    v_add_f32 v128, v128, v40
    v_add_f32 v33, v33, v37
    v_add_f32 v129, v129, v41
    v_add_f32 v34, v34, v38
    v_add_f32 v130, v130, v42
    v_add_f32 v35, v35, v39
    v_add_f32 v131, v131, v43
    v_add_f32 v128, v128, v32
    v_add_f32 v129, v129, v33
    v_add_f32 v130, v130, v34
    v_add_f32 v131, v131, v35
    v_cvt_pk_bf16_f32 v8, v128, v129
    v_cvt_pk_bf16_f32 v9, v130, v131
    s_waitcnt lgkmcnt(15)
    v_add_f32 v44, v44, v48
    v_add_f32 v132, v132, v52
    v_add_f32 v45, v45, v49
    v_add_f32 v133, v133, v53
    v_add_f32 v46, v46, v50
    v_add_f32 v134, v134, v54
    v_add_f32 v47, v47, v51
    v_add_f32 v135, v135, v55
    v_add_f32 v132, v132, v44
    v_add_f32 v133, v133, v45
    v_add_f32 v134, v134, v46
    v_add_f32 v135, v135, v47
    v_cvt_pk_bf16_f32 v10, v132, v133
    v_cvt_pk_bf16_f32 v11, v134, v135
    s_nop 1
    v_permlane16_swap_b32 v8, v10
    v_permlane16_swap_b32 v9, v11
    buffer_store_dwordx4 v[8:11], v5, s[24:27], s67 offen offset:0 sc0 sc1
    s_waitcnt lgkmcnt(15)
    v_add_f32 v56, v56, v60
    v_add_f32 v136, v136, v64
    v_add_f32 v57, v57, v61
    v_add_f32 v137, v137, v65
    v_add_f32 v58, v58, v62
    v_add_f32 v138, v138, v66
    v_add_f32 v59, v59, v63
    v_add_f32 v139, v139, v67
    v_add_f32 v136, v136, v56
    v_add_f32 v137, v137, v57
    v_add_f32 v138, v138, v58
    v_add_f32 v139, v139, v59
    v_cvt_pk_bf16_f32 v12, v136, v137
    v_cvt_pk_bf16_f32 v13, v138, v139
    s_waitcnt lgkmcnt(12)
    v_add_f32 v68, v68, v72
    v_add_f32 v140, v140, v76
    v_add_f32 v69, v69, v73
    v_add_f32 v141, v141, v77
    v_add_f32 v70, v70, v74
    v_add_f32 v142, v142, v78
    v_add_f32 v71, v71, v75
    v_add_f32 v143, v143, v79
    v_add_f32 v140, v140, v68
    v_add_f32 v141, v141, v69
    v_add_f32 v142, v142, v70
    v_add_f32 v143, v143, v71
    v_cvt_pk_bf16_f32 v14, v140, v141
    v_cvt_pk_bf16_f32 v15, v142, v143
    s_nop 1
    v_permlane16_swap_b32 v12, v14
    v_permlane16_swap_b32 v13, v15
    buffer_store_dwordx4 v[12:15], v5, s[24:27], s67 offen offset:64 sc0 sc1
    s_waitcnt lgkmcnt(9)
    v_add_f32 v80, v80, v84
    v_add_f32 v144, v144, v88
    v_add_f32 v81, v81, v85
    v_add_f32 v145, v145, v89
    v_add_f32 v82, v82, v86
    v_add_f32 v146, v146, v90
    v_add_f32 v83, v83, v87
    v_add_f32 v147, v147, v91
    v_add_f32 v144, v144, v80
    v_add_f32 v145, v145, v81
    v_add_f32 v146, v146, v82
    v_add_f32 v147, v147, v83
    v_cvt_pk_bf16_f32 v16, v144, v145
    v_cvt_pk_bf16_f32 v17, v146, v147
    s_waitcnt lgkmcnt(6)
    v_add_f32 v92, v92, v96
    v_add_f32 v148, v148, v100
    v_add_f32 v93, v93, v97
    v_add_f32 v149, v149, v101
    v_add_f32 v94, v94, v98
    v_add_f32 v150, v150, v102
    v_add_f32 v95, v95, v99
    v_add_f32 v151, v151, v103
    v_add_f32 v148, v148, v92
    v_add_f32 v149, v149, v93
    v_add_f32 v150, v150, v94
    v_add_f32 v151, v151, v95
    v_cvt_pk_bf16_f32 v18, v148, v149
    v_cvt_pk_bf16_f32 v19, v150, v151
    s_nop 1
    v_permlane16_swap_b32 v16, v18
    v_permlane16_swap_b32 v17, v19
    buffer_store_dwordx4 v[16:19], v6, s[24:27], s67 offen offset:0 sc0 sc1
    s_waitcnt lgkmcnt(3)
    v_add_f32 v104, v104, v108
    v_add_f32 v152, v152, v112
    v_add_f32 v105, v105, v109
    v_add_f32 v153, v153, v113
    v_add_f32 v106, v106, v110
    v_add_f32 v154, v154, v114
    v_add_f32 v107, v107, v111
    v_add_f32 v155, v155, v115
    v_add_f32 v152, v152, v104
    v_add_f32 v153, v153, v105
    v_add_f32 v154, v154, v106
    v_add_f32 v155, v155, v107
    v_cvt_pk_bf16_f32 v20, v152, v153
    v_cvt_pk_bf16_f32 v21, v154, v155
    s_waitcnt lgkmcnt(0)
    v_add_f32 v116, v116, v120
    v_add_f32 v156, v156, v124
    v_add_f32 v117, v117, v121
    v_add_f32 v157, v157, v125
    v_add_f32 v118, v118, v122
    v_add_f32 v158, v158, v126
    v_add_f32 v119, v119, v123
    v_add_f32 v159, v159, v127
    v_add_f32 v156, v156, v116
    v_add_f32 v157, v157, v117
    v_add_f32 v158, v158, v118
    v_add_f32 v159, v159, v119
    v_cvt_pk_bf16_f32 v22, v156, v157
    v_cvt_pk_bf16_f32 v23, v158, v159
    s_nop 1
    v_permlane16_swap_b32 v20, v22
    v_permlane16_swap_b32 v21, v23
    buffer_store_dwordx4 v[20:23], v6, s[24:27], s67 offen offset:64 sc0 sc1
    s_endpgm
.section .rodata,"a"
.p2align 6
.amdhsa_kernel gemm1_kernel
  .amdhsa_next_free_vgpr 488
  .amdhsa_next_free_sgpr 84
  .amdhsa_accum_offset 256
  .amdhsa_group_segment_fixed_size 0
  .amdhsa_kernarg_size 80
  .amdhsa_user_sgpr_count 2
  .amdhsa_user_sgpr_kernarg_segment_ptr 1
  .amdhsa_system_sgpr_workgroup_id_x 1
  .amdhsa_float_denorm_mode_32 3
.end_amdhsa_kernel
.section .rodata,"a"
.p2align 6
.amdhsa_kernel parallel_sum__softmax_full_mha__glu_gated_bilinear__prompt_kernel
  .amdhsa_next_free_vgpr 256
  .amdhsa_next_free_sgpr 80
  .amdhsa_accum_offset 256
  .amdhsa_group_segment_fixed_size 0
  .amdhsa_kernarg_size 80
  .amdhsa_user_sgpr_count 2
  .amdhsa_user_sgpr_kernarg_segment_ptr 1
  .amdhsa_system_sgpr_workgroup_id_x 1
  .amdhsa_float_denorm_mode_32 3
.end_amdhsa_kernel
```
